```python
import torch

def _softmax(x, axis=-1):
    return torch.softmax(x, dim=axis)
def _gelu(x):
    return torch.nn.functional.gelu(x, approximate="tanh")
def _silu(x):
    return torch.nn.functional.silu(x)
def _sigmoid(x):
    return torch.sigmoid(x)
def _layernorm(x, axis=-1, eps=1e-5):
    m = x.mean(dim=axis, keepdim=True)
    v = x.var(dim=axis, keepdim=True, unbiased=False)
    return (x - m) / torch.sqrt(v + eps)
def _scatter_add(tgt, idx, src, axis=0):
    return tgt.clone().index_add_(axis, idx, src)
def _segment_sum(src, seg, n):
    out = torch.zeros((n,) + src.shape[1:], dtype=src.dtype)
    return out.index_add_(0, seg, src)
def _pad(x, pw):
    flat = tuple(v for pair in reversed(pw) for v in pair)
    return torch.nn.functional.pad(x, flat)

kernel_name = 'parallel_sum__spectral_gfnet__glu_gated_reglu__prompt'

def setup_inputs():

    _w = (lambda a: (lambda t: t.to(torch.bfloat16) if t.is_floating_point() else t)(torch.as_tensor(a)))
    def _A_setup():
        B, S, D = 1, 2048, 640
        Df = D // 2 + 1
        return {
            "x": _w((lambda *s: torch.randn(*s, dtype=torch.bfloat16) * 0.05)(B, S, D)),
            "w_r": _w((lambda *s: torch.randn(*s, dtype=torch.bfloat16) * 0.4)(S, Df) * 0.02),
            "w_i": _w((lambda *s: torch.randn(*s, dtype=torch.bfloat16) * 0.4)(S, Df) * 0.02),
        }
    _A_in = _A_setup()

    def _B_setup():
        B, S, D, F = 1, 2048, 640, 1536
        return {
            "x": _w((lambda *s: torch.randn(*s, dtype=torch.bfloat16) * 0.05)(B, S, D)),
            "W_gate": _w((lambda *s: torch.randn(*s, dtype=torch.bfloat16) * 0.2)(D, F) * (2.0 / D) ** 0.5),
            "W_up": _w((lambda *s: torch.randn(*s, dtype=torch.bfloat16) * 0.2)(D, F) * (2.0 / D) ** 0.5),
            "W_down": _w((lambda *s: torch.randn(*s, dtype=torch.bfloat16) * 0.2)(F, D) * (1.0 / F) ** 0.5),
        }
    _B_in = _B_setup()

    return {
        "A_x": _A_in["x"],
        "A_w_r": _A_in["w_r"],
        "A_w_i": _A_in["w_i"],
        "B_x": _B_in["x"],
        "B_W_gate": _B_in["W_gate"],
        "B_W_up": _B_in["W_up"],
        "B_W_down": _B_in["W_down"],
    }

def reference(A_x, A_w_r, A_w_i, B_x, B_W_gate, B_W_up, B_W_down):
    def _A_ref(x, w_r, w_i):
        B, S, D = x.shape
        X = (lambda x, axes=(-2,-1): torch.fft.rfft2(x.float(), dim=axes))(x, axes=(-2, -1))
        W = w_r + 1j * w_i
        X = X * W
        y = (lambda x, s, axes=(-2,-1): torch.fft.irfft2(x, s=s, dim=axes).to(torch.bfloat16))(X, (S, D), axes=(-2, -1))
        return y

    def _B_ref(x, W_gate, W_up, W_down):
        gate = torch.einsum("bsd,df->bsf", x, W_gate)
        up = torch.einsum("bsd,df->bsf", x, W_up)
        gate = gate * (lambda x, dt: x.to(dt))(gate > 0, gate.dtype)
        h = gate * up
        return torch.einsum("bsf,fd->bsd", h, W_down)

    x = A_x
    xn = _layernorm(x, axis=-1)
    return x + _A_ref(xn, A_w_r, A_w_i) + _B_ref(xn, B_W_gate, B_W_up, B_W_down)
```

```asm
; @launch grid=(256,1,1) block=(256,1,1) lds=163840
.amdgcn_target "amdgcn-amd-amdhsa--gfx950"
.text
.globl parallel_sum__spectral_gfnet__glu_gated_reglu__prompt_kernel
.p2align 8
.type parallel_sum__spectral_gfnet__glu_gated_reglu__prompt_kernel,@function
parallel_sum__spectral_gfnet__glu_gated_reglu__prompt_kernel:
  s_cmp_ge_u32 s2, 256
  s_cbranch_scc1 L_end
  s_load_dwordx16 s[8:23], s[0:1], 0
  s_load_dwordx4 s[24:27], s[0:1], 64
  v_lshrrev_b32 v1, 6, v0
  v_and_b32 v0, 63, v0
  v_readfirstlane_b32 s60, v1
  v_mov_b32 v254, 2147483392
  v_mov_b32 v253, 1
  s_and_b32 s81, s2, 7
  s_lshr_b32 s4, s2, 3
  s_getpc_b64 s[48:49]
L_pc:
  s_mov_b32 s50, L_end-L_pc
  s_mov_b32 s51, 0x20000
  s_lshl_b32 s5, s4, 2
  s_add_u32 s5, s5, s60
  s_mul_i32 s5, s5, 384
  v_cmp_gt_u32 vcc, 3, v0
  v_lshl_add_u32 v34, v0, 7, s5
  v_lshlrev_b32 v10, 4, v0
  v_cndmask_b32 v34, v254, v34, vcc
  buffer_load_dword v255, v34, s[48:51], 0 offen  sc1
  s_and_b32 s5, s81, 3
  s_lshl_b32 s5, s5, 2
  s_and_b32 s6, s4, 3
  s_add_u32 s61, s5, s6
  s_lshr_b32 s5, s81, 2
  s_lshl_b32 s5, s5, 3
  s_lshr_b32 s6, s4, 2
  s_add_u32 s62, s5, s6
  s_lshl_b32 s63, s61, 2
  s_add_u32 s63, s63, s60
  s_lshl_b32 s3, s2, 2
  s_add_u32 s3, s3, s60
  s_mul_i32 s70, s60, 12288
  s_add_u32 s70, s70, 40960
  v_cmp_gt_u32 vcc, 15, v0
  s_mul_i32 s5, s3, 1920
  v_lshl_add_u32 v33, v0, 7, s5
  v_cndmask_b32 v228, v254, v33, vcc
  v_lshrrev_b32 v28, 3, v0
  v_lshlrev_b32 v28, 6, v28
  v_add_u32 v28, s63, v28
  v_mul_u32_u24 v28, 1280, v28
  v_and_b32 v29, 7, v0
  v_lshrrev_b32 v30, 4, v0
  v_xor_b32 v31, v29, v30
  v_xor_b32 v32, 4, v31
  v_lshl_add_u32 v2, v31, 4, v28
  v_lshl_add_u32 v3, v32, 4, v28
  v_add_u32 v3, 654336, v3
  v_lshl_add_u32 v4, v31, 4, v28
  v_add_u32 v4, 1308672, v4
  v_lshl_add_u32 v5, v32, 4, v28
  v_add_u32 v5, 1963008, v5
  s_and_b32 s5, s62, 7
  s_lshr_b32 s6, s5, 2
  s_add_u32 s5, s5, s6
  s_lshl_b32 s68, s5, 7
  s_lshl_b32 s78, s5, 6
  s_mul_i32 s69, s5, 196608
  s_waitcnt lgkmcnt(0)
  s_mov_b64 s[28:29], s[8:9]
  s_mov_b32 s30, 2621440
  s_mov_b32 s31, 0x20000
  s_add_u32 m0, s70, 0
  s_nop 0
  buffer_load_dwordx4 v2, s[28:31], s68 offen offset:0 lds
  buffer_load_dwordx4 v3, s[28:31], s68 offen offset:1024 lds
  buffer_load_dwordx4 v4, s[28:31], s68 offen offset:2048 lds
  buffer_load_dwordx4 v5, s[28:31], s68 offen offset:3072 lds
  s_add_u32 s68, s68, 128
  s_cmpk_eq_u32 s68, 1280
  s_cselect_b32 s68, 0, s68
  s_add_u32 m0, s70, 4096
  s_nop 0
  buffer_load_dwordx4 v2, s[28:31], s68 offen offset:0 lds
  buffer_load_dwordx4 v3, s[28:31], s68 offen offset:1024 lds
  buffer_load_dwordx4 v4, s[28:31], s68 offen offset:2048 lds
  buffer_load_dwordx4 v5, s[28:31], s68 offen offset:3072 lds
  s_add_u32 s68, s68, 128
  s_cmpk_eq_u32 s68, 1280
  s_cselect_b32 s68, 0, s68
  s_mov_b64 s[32:33], s[16:17]
  s_mov_b32 s34, 1966080
  s_mov_b32 s35, 0x20000
  s_mov_b64 s[36:37], s[18:19]
  s_mov_b64 s[38:39], s[34:35]
  s_sub_u32 s36, s36, 1024
  s_subb_u32 s37, s37, 0
  s_add_u32 s38, s38, 1024
  s_mov_b64 s[44:45], s[26:27]
  s_mov_b32 s46, 268435456
  s_mov_b32 s47, 0x20000
  s_mov_b64 s[40:41], s[20:21]
  s_mov_b64 s[42:43], s[34:35]
  s_mov_b64 s[48:49], s[22:23]
  s_mov_b64 s[50:51], s[30:31]
  s_mov_b64 s[52:53], s[10:11]
  s_mov_b32 s54, 1314816
  s_mov_b32 s55, 0x20000
  s_mov_b64 s[56:57], s[12:13]
  s_mov_b64 s[58:59], s[54:55]
  s_mov_b64 s[8:9], s[24:25]
  s_mov_b32 s10, 256
  s_mov_b32 s11, 0x20000
  s_and_b32 s24, s60, 1
  s_lshr_b32 s25, s60, 1
  s_mov_b32 s64, s62
  s_and_b32 s7, s61, 1
  s_lshl_b32 s7, s7, 3
  s_xor_b32 s7, s7, s62
  s_lshr_b32 s5, s7, 2
  s_add_u32 s5, s5, 16
  s_and_b32 s6, s7, 3
  s_cmp_eq_u32 s6, 0
  s_cselect_b32 s65, s5, 0
  s_cmp_eq_u32 s7, 1
  s_cselect_b32 s65, 20, s65
  s_mov_b32 s72, 0x3f803f80
  v_and_b32 v28, 15, v0
  s_lshl_b32 s5, s64, 4
  v_add_u32 v28, s5, v28
  v_cmp_ge_u32 vcc, 320, v28
  v_cvt_f32_u32 v29, v28
  v_mul_f32 v29, 0x3acccccd, v29
  v_cndmask_b32 v34, 0, 1.0, vcc
  v_cos_f32 v36, v29
  v_lshrrev_b32 v30, 4, v0
  s_mul_i32 s5, s25, 160
  s_add_u32 s5, s5, s78
  v_lshl_add_u32 v30, v30, 3, s5
  v_mul_u32_u24 v30, v30, v28
  v_cvt_f32_u32 v30, v30
  v_mul_f32 v30, 0x3acccccd, v30
  v_fract_f32 v30, v30
  v_add_f32 v36, v36, v36
  s_mul_i32 s5, s24, 1048576000
  v_add_f32 v30, s5, v30
  v_mul_f32 v32, 0x42000000, v29
  v_fract_f32 v32, v32
  s_mul_i32 s5, s25, 10
  s_add_u32 s5, s5, s24
  s_lshl_b32 s5, s5, 10
  v_add_u32 v35, s5, v10
  v_add_f32 v125, v30, v29
  v_cos_f32 v124, v30
  v_cos_f32 v125, v125
  v_add_f32 v30, v30, v32
  v_add_f32 v133, v30, v29
  v_cos_f32 v132, v30
  v_cos_f32 v133, v133
  v_add_f32 v30, v30, v32
  v_add_f32 v141, v30, v29
  v_cos_f32 v140, v30
  v_cos_f32 v141, v141
  v_add_f32 v30, v30, v32
  v_add_f32 v149, v30, v29
  v_cos_f32 v148, v30
  v_cos_f32 v149, v149
  v_add_f32 v30, v30, v32
  v_add_f32 v157, v30, v29
  v_cos_f32 v156, v30
  v_cos_f32 v157, v157
  v_pk_mul_f32 v[124:125], v[124:125], v[34:35] op_sel_hi:[1,0]
  v_pk_mul_f32 v[132:133], v[132:133], v[34:35] op_sel_hi:[1,0]
  v_pk_mul_f32 v[140:141], v[140:141], v[34:35] op_sel_hi:[1,0]
  v_pk_mul_f32 v[148:149], v[148:149], v[34:35] op_sel_hi:[1,0]
  v_pk_mul_f32 v[156:157], v[156:157], v[34:35] op_sel_hi:[1,0]
  v_fma_f32 v126, v36, v125, -v124
  v_fma_f32 v134, v36, v133, -v132
  v_fma_f32 v142, v36, v141, -v140
  v_fma_f32 v150, v36, v149, -v148
  v_fma_f32 v158, v36, v157, -v156
  v_fma_f32 v127, v36, v126, -v125
  v_fma_f32 v135, v36, v134, -v133
  v_fma_f32 v143, v36, v142, -v141
  v_fma_f32 v151, v36, v150, -v149
  v_fma_f32 v159, v36, v158, -v157
  v_fma_f32 v128, v36, v127, -v126
  v_fma_f32 v136, v36, v135, -v134
  v_fma_f32 v144, v36, v143, -v142
  v_fma_f32 v152, v36, v151, -v150
  v_fma_f32 v160, v36, v159, -v158
  v_fma_f32 v129, v36, v128, -v127
  v_fma_f32 v137, v36, v136, -v135
  v_fma_f32 v145, v36, v144, -v143
  v_fma_f32 v153, v36, v152, -v151
  v_fma_f32 v161, v36, v160, -v159
  v_fma_f32 v130, v36, v129, -v128
  v_fma_f32 v138, v36, v137, -v136
  v_fma_f32 v146, v36, v145, -v144
  v_fma_f32 v154, v36, v153, -v152
  v_fma_f32 v162, v36, v161, -v160
  v_fma_f32 v131, v36, v130, -v129
  v_fma_f32 v139, v36, v138, -v137
  v_fma_f32 v147, v36, v146, -v145
  v_fma_f32 v155, v36, v154, -v153
  v_fma_f32 v163, v36, v162, -v161
  v_cvt_pk_bf16_f32 v76, v124, v125
  v_cvt_pk_bf16_f32 v77, v126, v127
  v_cvt_pk_bf16_f32 v78, v128, v129
  v_cvt_pk_bf16_f32 v79, v130, v131
  ds_write_b128 v35, v[76:79] offset:0
  v_cvt_pk_bf16_f32 v80, v132, v133
  v_cvt_pk_bf16_f32 v81, v134, v135
  v_cvt_pk_bf16_f32 v82, v136, v137
  v_cvt_pk_bf16_f32 v83, v138, v139
  ds_write_b128 v35, v[80:83] offset:2048
  v_cvt_pk_bf16_f32 v84, v140, v141
  v_cvt_pk_bf16_f32 v85, v142, v143
  v_cvt_pk_bf16_f32 v86, v144, v145
  v_cvt_pk_bf16_f32 v87, v146, v147
  ds_write_b128 v35, v[84:87] offset:4096
  v_cvt_pk_bf16_f32 v88, v148, v149
  v_cvt_pk_bf16_f32 v89, v150, v151
  v_cvt_pk_bf16_f32 v90, v152, v153
  v_cvt_pk_bf16_f32 v91, v154, v155
  ds_write_b128 v35, v[88:91] offset:6144
  v_cvt_pk_bf16_f32 v92, v156, v157
  v_cvt_pk_bf16_f32 v93, v158, v159
  v_cvt_pk_bf16_f32 v94, v160, v161
  v_cvt_pk_bf16_f32 v95, v162, v163
  ds_write_b128 v35, v[92:95] offset:8192
  buffer_load_dword v255, v228, s[32:35], 0 offen  sc1
  buffer_load_dword v255, v228, s[36:39], 0 offen offset:1024 sc1
  s_cmp_eq_u32 s65, 0
  s_cbranch_scc1 L_notab1
  v_and_b32 v28, 15, v0
  s_lshl_b32 s5, s65, 4
  v_add_u32 v28, s5, v28
  v_cmp_ge_u32 vcc, 320, v28
  v_cvt_f32_u32 v29, v28
  v_mul_f32 v29, 0x3acccccd, v29
  v_cndmask_b32 v34, 0, 1.0, vcc
  v_cos_f32 v36, v29
  v_lshrrev_b32 v30, 4, v0
  s_mul_i32 s5, s25, 160
  s_add_u32 s5, s5, s78
  v_lshl_add_u32 v30, v30, 3, s5
  v_mul_u32_u24 v30, v30, v28
  v_cvt_f32_u32 v30, v30
  v_mul_f32 v30, 0x3acccccd, v30
  v_fract_f32 v30, v30
  v_add_f32 v36, v36, v36
  s_mul_i32 s5, s24, 1048576000
  v_add_f32 v30, s5, v30
  v_mul_f32 v32, 0x42000000, v29
  v_fract_f32 v32, v32
  s_mul_i32 s5, s25, 10
  s_add_u32 s5, s5, s24
  s_lshl_b32 s5, s5, 10
  v_add_u32 v35, s5, v10
  v_add_f32 v125, v30, v29
  v_cos_f32 v124, v30
  v_cos_f32 v125, v125
  v_add_f32 v30, v30, v32
  v_add_f32 v133, v30, v29
  v_cos_f32 v132, v30
  v_cos_f32 v133, v133
  v_add_f32 v30, v30, v32
  v_add_f32 v141, v30, v29
  v_cos_f32 v140, v30
  v_cos_f32 v141, v141
  v_add_f32 v30, v30, v32
  v_add_f32 v149, v30, v29
  v_cos_f32 v148, v30
  v_cos_f32 v149, v149
  v_add_f32 v30, v30, v32
  v_add_f32 v157, v30, v29
  v_cos_f32 v156, v30
  v_cos_f32 v157, v157
  v_pk_mul_f32 v[124:125], v[124:125], v[34:35] op_sel_hi:[1,0]
  v_pk_mul_f32 v[132:133], v[132:133], v[34:35] op_sel_hi:[1,0]
  v_pk_mul_f32 v[140:141], v[140:141], v[34:35] op_sel_hi:[1,0]
  v_pk_mul_f32 v[148:149], v[148:149], v[34:35] op_sel_hi:[1,0]
  v_pk_mul_f32 v[156:157], v[156:157], v[34:35] op_sel_hi:[1,0]
  v_fma_f32 v126, v36, v125, -v124
  v_fma_f32 v134, v36, v133, -v132
  v_fma_f32 v142, v36, v141, -v140
  v_fma_f32 v150, v36, v149, -v148
  v_fma_f32 v158, v36, v157, -v156
  v_fma_f32 v127, v36, v126, -v125
  v_fma_f32 v135, v36, v134, -v133
  v_fma_f32 v143, v36, v142, -v141
  v_fma_f32 v151, v36, v150, -v149
  v_fma_f32 v159, v36, v158, -v157
  v_fma_f32 v128, v36, v127, -v126
  v_fma_f32 v136, v36, v135, -v134
  v_fma_f32 v144, v36, v143, -v142
  v_fma_f32 v152, v36, v151, -v150
  v_fma_f32 v160, v36, v159, -v158
  v_fma_f32 v129, v36, v128, -v127
  v_fma_f32 v137, v36, v136, -v135
  v_fma_f32 v145, v36, v144, -v143
  v_fma_f32 v153, v36, v152, -v151
  v_fma_f32 v161, v36, v160, -v159
  v_fma_f32 v130, v36, v129, -v128
  v_fma_f32 v138, v36, v137, -v136
  v_fma_f32 v146, v36, v145, -v144
  v_fma_f32 v154, v36, v153, -v152
  v_fma_f32 v162, v36, v161, -v160
  v_fma_f32 v131, v36, v130, -v129
  v_fma_f32 v139, v36, v138, -v137
  v_fma_f32 v147, v36, v146, -v145
  v_fma_f32 v155, v36, v154, -v153
  v_fma_f32 v163, v36, v162, -v161
  v_cvt_pk_bf16_f32 v76, v124, v125
  v_cvt_pk_bf16_f32 v77, v126, v127
  v_cvt_pk_bf16_f32 v78, v128, v129
  v_cvt_pk_bf16_f32 v79, v130, v131
  ds_write_b128 v35, v[76:79] offset:20480
  v_cvt_pk_bf16_f32 v80, v132, v133
  v_cvt_pk_bf16_f32 v81, v134, v135
  v_cvt_pk_bf16_f32 v82, v136, v137
  v_cvt_pk_bf16_f32 v83, v138, v139
  ds_write_b128 v35, v[80:83] offset:22528
  v_cvt_pk_bf16_f32 v84, v140, v141
  v_cvt_pk_bf16_f32 v85, v142, v143
  v_cvt_pk_bf16_f32 v86, v144, v145
  v_cvt_pk_bf16_f32 v87, v146, v147
  ds_write_b128 v35, v[84:87] offset:24576
  v_cvt_pk_bf16_f32 v88, v148, v149
  v_cvt_pk_bf16_f32 v89, v150, v151
  v_cvt_pk_bf16_f32 v90, v152, v153
  v_cvt_pk_bf16_f32 v91, v154, v155
  ds_write_b128 v35, v[88:91] offset:26624
  v_cvt_pk_bf16_f32 v92, v156, v157
  v_cvt_pk_bf16_f32 v93, v158, v159
  v_cvt_pk_bf16_f32 v94, v160, v161
  v_cvt_pk_bf16_f32 v95, v162, v163
  ds_write_b128 v35, v[92:95] offset:28672
  s_branch L_tabs
L_notab1:
  v_and_b32 v30, 15, v0
  v_cvt_f32_u32 v31, v30
  v_mul_f32 v31, 0x3c800000, v31
  v_lshrrev_b32 v28, 4, v0
  s_lshl_b32 s5, s60, 4
  v_lshl_add_u32 v32, v28, 2, s5
  v_cvt_f32_u32 v32, v32
  v_mul_f32 v32, v32, v31
  v_cos_f32 v36, v32
  v_sin_f32 v37, v32
  v_add_f32 v32, v32, v31
  v_cos_f32 v38, v32
  v_sin_f32 v39, v32
  v_add_f32 v32, v32, v31
  v_cos_f32 v40, v32
  v_sin_f32 v41, v32
  v_add_f32 v32, v32, v31
  v_cos_f32 v42, v32
  v_sin_f32 v43, v32
  s_lshl_b32 s5, s60, 10
  v_add_u32 v30, s5, v10
  v_cvt_pk_bf16_f32 v76, v36, v37
  v_cvt_pk_bf16_f32 v77, v38, v39
  v_cvt_pk_bf16_f32 v78, v40, v41
  v_cvt_pk_bf16_f32 v79, v42, v43
  ds_write_b128 v30, v[76:79] offset:20480
  v_cvt_pk_bf16_f32 v80, v36, v37
  v_cvt_pk_bf16_f32 v81, -v39, v38
  v_cvt_pk_bf16_f32 v82, -v40, -v41
  v_cvt_pk_bf16_f32 v83, v43, -v42
  ds_write_b128 v30, v[80:83] offset:24576
  v_cvt_pk_bf16_f32 v84, v36, v37
  v_cvt_pk_bf16_f32 v85, -v38, -v39
  v_cvt_pk_bf16_f32 v86, v40, v41
  v_cvt_pk_bf16_f32 v87, -v42, -v43
  ds_write_b128 v30, v[84:87] offset:28672
  v_cvt_pk_bf16_f32 v88, v36, v37
  v_cvt_pk_bf16_f32 v89, v39, -v38
  v_cvt_pk_bf16_f32 v90, -v40, -v41
  v_cvt_pk_bf16_f32 v91, -v43, v42
  ds_write_b128 v30, v[88:91] offset:32768
L_tabs:
  s_cmp_lg_u32 s2, 0
  s_cbranch_scc1 L_noclr
  v_mov_b32 v52, 0
  v_mov_b32 v53, 0
  v_mov_b32 v54, 0
  v_mov_b32 v55, 0
  s_lshl_b32 s5, s60, 12
  s_add_u32 s5, s5, 16252928
  buffer_store_dwordx4 v[52:55], v10, s[44:47], s5 offen offset:0 sc1
  buffer_store_dwordx4 v[52:55], v10, s[44:47], s5 offen offset:1024 sc1
  buffer_store_dwordx4 v[52:55], v10, s[44:47], s5 offen offset:2048 sc1
  buffer_store_dwordx4 v[52:55], v10, s[44:47], s5 offen offset:3072 sc1
L_noclr:
  v_and_b32 v57, 15, v0
  v_lshrrev_b32 v58, 4, v0
  v_cvt_f32_u32 v28, v57
  v_mul_f32 v28, 0x3a000000, v28
  v_add_f32 v29, 0x3c000000, v28
  v_lshl_add_u32 v30, v58, 8, s63
  v_cvt_f32_u32 v30, v30
  v_and_b32 v31, 1, v0
  v_mul_u32_u24 v31, 0x8000, v31
  v_lshl_or_b32 v31, v31, 16, v31
  v_mul_f32 v32, v30, v28
  v_mul_f32 v33, 0x42800000, v28
  v_cos_f32 v36, v32
  v_sin_f32 v40, v32
  v_add_f32 v32, v32, v33
  v_cos_f32 v37, v32
  v_sin_f32 v41, v32
  v_add_f32 v32, v32, v33
  v_cos_f32 v38, v32
  v_sin_f32 v42, v32
  v_add_f32 v32, v32, v33
  v_cos_f32 v39, v32
  v_sin_f32 v43, v32
  v_cvt_pk_bf16_f32 v60, v36, v37
  v_cvt_pk_bf16_f32 v61, v38, v39
  v_xor_b32 v62, v31, v60
  v_xor_b32 v63, v31, v61
  v_cvt_pk_bf16_f32 v68, v40, v41
  v_cvt_pk_bf16_f32 v69, v42, v43
  v_xor_b32 v70, v31, v68
  v_xor_b32 v71, v31, v69
  v_mul_f32 v32, v30, v29
  v_mul_f32 v33, 0x42800000, v29
  v_cos_f32 v36, v32
  v_sin_f32 v40, v32
  v_add_f32 v32, v32, v33
  v_cos_f32 v37, v32
  v_sin_f32 v41, v32
  v_add_f32 v32, v32, v33
  v_cos_f32 v38, v32
  v_sin_f32 v42, v32
  v_add_f32 v32, v32, v33
  v_cos_f32 v39, v32
  v_sin_f32 v43, v32
  v_cvt_pk_bf16_f32 v64, v36, v37
  v_cvt_pk_bf16_f32 v65, v38, v39
  v_xor_b32 v66, v31, v64
  v_xor_b32 v67, v31, v65
  v_cvt_pk_bf16_f32 v72, v40, v41
  v_cvt_pk_bf16_f32 v73, v42, v43
  v_xor_b32 v74, v31, v72
  v_xor_b32 v75, v31, v73
  s_mul_i32 s5, s62, 96
  s_and_b32 s6, s62, 1
  s_lshl_b32 s7, s6, 5
  s_add_u32 s66, s5, s7
  s_xor_b32 s6, s6, 1
  s_lshl_b32 s6, s6, 6
  s_add_u32 s67, s5, s6
  s_mul_hi_u32 s75, s2, 858993460
  s_mul_i32 s5, s75, 5
  s_sub_u32 s76, s2, s5
  s_lshl_b32 s71, s60, 11
  s_add_u32 s71, s71, 90112
  v_lshrrev_b32 v28, 1, v57
  v_xor_b32 v28, v28, v58
  v_lshl_add_u32 v29, v57, 7, s70
  v_lshl_add_u32 v6, v28, 4, v29
  v_xor_b32 v28, 4, v28
  v_lshl_add_u32 v7, v28, 4, v29
  v_lshrrev_b32 v35, 2, v0
  s_lshl_b32 s5, s75, 5
  v_add_u32 v28, s5, v35
  v_mul_u32_u24 v28, 1280, v28
  v_and_b32 v34, 3, v0
  v_lshl_add_u32 v28, v34, 4, v28
  s_lshl_b32 s5, s76, 8
  s_lshl_b32 s6, s60, 6
  s_add_u32 s5, s5, s6
  v_add_u32 v1, s5, v28
  v_bfe_u32 v28, v0, 3, 2
  v_lshrrev_b32 v29, 5, v0
  v_lshl_add_u32 v28, v29, 3, v28
  s_lshl_b32 s5, s25, 4
  s_lshl_b32 s6, s24, 2
  s_add_u32 s5, s5, s6
  v_add_u32 v28, s5, v28
  v_mul_u32_u24 v28, 3072, v28
  v_bfe_u32 v29, v0, 1, 2
  v_xor_b32 v30, v29, v58
  v_and_b32 v31, 1, v0
  v_lshlrev_b32 v31, 4, v31
  v_lshl_add_u32 v30, v30, 5, v31
  s_lshl_b32 s5, s66, 1
  v_add3_u32 v11, v28, v30, s5
  s_lshl_b32 s5, s60, 4
  v_add_u32 v28, s5, v35
  v_mul_u32_u24 v28, 3072, v28
  v_and_b32 v29, 1, v29
  v_lshrrev_b32 v30, 5, v0
  v_xor_b32 v29, v29, v30
  v_lshl_add_u32 v29, v29, 5, v31
  s_lshl_b32 s5, s67, 1
  v_add3_u32 v12, v28, v29, s5
  v_bfe_u32 v28, v0, 2, 3
  v_lshrrev_b32 v29, 1, v28
  v_lshlrev_b32 v28, 7, v28
  v_lshl_add_u32 v28, v34, 3, v28
  v_lshl_add_u32 v28, v30, 12, v28
  s_lshl_b32 s5, s25, 10
  s_add_u32 s6, s5, 90112
  s_xor_b32 s5, s5, 1024
  s_add_u32 s7, s5, 90112
  s_lshl_b32 s5, s24, 1
  v_xor_b32 v29, s5, v29
  v_xor_b32 v31, 0, v29
  v_lshl_add_u32 v31, v31, 5, v28
  v_add_u32 v220, s6, v31
  v_add_u32 v224, s7, v31
  v_xor_b32 v31, 1, v29
  v_lshl_add_u32 v31, v31, 5, v28
  v_add_u32 v221, s6, v31
  v_add_u32 v225, s7, v31
  v_xor_b32 v31, 2, v29
  v_lshl_add_u32 v31, v31, 5, v28
  v_add_u32 v222, s6, v31
  v_add_u32 v226, s7, v31
  v_xor_b32 v31, 3, v29
  v_lshl_add_u32 v31, v31, 5, v28
  v_add_u32 v223, s6, v31
  v_add_u32 v227, s7, v31
  v_mov_b32 v244, s72
  v_mov_b32 v245, s72
  v_mov_b32 v246, s72
  v_mov_b32 v247, s72
  v_lshlrev_b32 v28, 2, v58
  v_lshl_add_u32 v28, v57, 4, v28
  s_lshl_b32 s5, s60, 9
  s_add_u32 s5, s5, 40960
  v_add_u32 v23, s5, v28
  v_add_u32 v8, s70, v10
  s_lshl_b32 s5, s60, 3
  v_add_u32 v28, s5, v58
  v_mul_u32_u24 v28, 86016, v28
  v_lshl_add_u32 v9, v57, 4, v28
  s_lshl_b32 s5, s64, 4
  s_add_u32 s5, s5, s61
  s_lshl_b32 s5, s5, 8
  s_add_u32 s14, s5, 0
  s_lshl_b32 s5, s65, 4
  s_add_u32 s5, s5, s61
  s_lshl_b32 s5, s5, 8
  s_add_u32 s5, s5, 0
  s_cmp_eq_u32 s65, 0
  s_cselect_b32 s15, 2147483392, s5
  v_cmp_eq_u32 vcc, 0, v57
  v_and_b32 v32, 1, v0
  v_lshlrev_b32 v32, 31, v32
  v_or_b32 v14, 0x3f800000, v32
  s_cmp_eq_u32 s64, 0
  s_cselect_b32 s5, 0xc4200000, 0
  v_mov_b32 v32, s5
  v_cndmask_b32 v15, 0, v32, vcc
  s_add_u32 s5, s70, 12032
  v_lshl_add_u32 v21, v58, 4, s5
  s_lshl_b32 s5, s2, 2
  s_add_u32 s5, s5, 16252928
  s_cmp_eq_u32 s60, 0
  s_cselect_b32 s5, s5, 2147483392
  v_cmp_eq_u32 vcc, 0, v0
  v_mov_b32 v32, s5
  s_nop 0
  v_cndmask_b32 v13, v254, v32, vcc
  s_mul_hi_u32 s5, s3, 107374183
  s_mul_i32 s6, s5, 40
  s_sub_u32 s6, s3, s6
  s_lshl_b32 s6, s6, 4
  v_add_u32 v28, s6, v57
  s_lshl_b32 s5, s5, 4
  v_lshl_add_u32 v29, v58, 2, s5
  v_cmp_eq_u32 vcc, 0, v29
  v_mov_b32 v36, 0x35cccccd
  v_mov_b32 v31, 0x354ccccd
  v_mul_u32_u24 v37, v29, v28
  v_cvt_f32_u32 v37, v37
  v_cndmask_b32 v32, v36, v31, vcc
  v_mul_f32 v37, 0x3acccccd, v37
  v_fract_f32 v37, v37
  v_cvt_f32_u32 v28, v28
  v_mul_f32 v28, 0x3acccccd, v28
  v_cos_f32 v38, v37
  v_sin_f32 v39, v37
  v_add_f32 v37, v37, v28
  v_cos_f32 v40, v37
  v_sin_f32 v41, v37
  v_add_f32 v37, v37, v28
  v_cos_f32 v42, v37
  v_sin_f32 v43, v37
  v_add_f32 v37, v37, v28
  v_cos_f32 v44, v37
  v_sin_f32 v45, v37
  v_cndmask_b32 v39, v39, -v14, vcc
  v_pk_mul_f32 v[38:39], v[38:39], v[32:33] op_sel_hi:[1,0]
  v_pk_mul_f32 v[40:41], v[40:41], v[36:37] op_sel_hi:[1,0]
  v_pk_mul_f32 v[42:43], v[42:43], v[36:37] op_sel_hi:[1,0]
  v_pk_mul_f32 v[44:45], v[44:45], v[36:37] op_sel_hi:[1,0]
  v_cvt_pk_bf16_f32 v172, v38, -v39
  v_cvt_pk_bf16_f32 v173, v40, -v41
  v_cvt_pk_bf16_f32 v174, v42, -v43
  v_cvt_pk_bf16_f32 v175, v44, -v45
  s_add_u32 m0, s70, 8192
  s_nop 0
  buffer_load_dwordx4 v2, s[28:31], s68 offen offset:0 lds
  buffer_load_dwordx4 v3, s[28:31], s68 offen offset:1024 lds
  buffer_load_dwordx4 v4, s[28:31], s68 offen offset:2048 lds
  buffer_load_dwordx4 v5, s[28:31], s68 offen offset:3072 lds
  s_add_u32 s68, s68, 128
  s_cmpk_eq_u32 s68, 1280
  s_cselect_b32 s68, 0, s68
  v_bfe_u32 v30, v0, 2, 2
  v_bfe_u32 v31, v0, 4, 1
  v_lshl_add_u32 v30, v31, 3, v30
  v_lshlrev_b32 v30, 6, v30
  v_and_b32 v32, 3, v0
  v_lshl_add_u32 v30, v32, 3, v30
  v_lshrrev_b32 v32, 5, v0
  v_lshl_add_u32 v30, v32, 11, v30
  v_xor_b32 v31, s24, v31
  s_lshl_b32 s5, s25, 10
  s_add_u32 s6, s5, 90112
  v_lshl_add_u32 v32, v31, 5, v30
  v_xor_b32 v31, 1, v31
  v_lshl_add_u32 v30, v31, 5, v30
  v_add_u32 v248, s6, v32
  v_add_u32 v249, s6, v30
  s_xor_b32 s5, s5, 1024
  s_add_u32 s6, s5, 90112
  v_add_u32 v250, s6, v32
  v_add_u32 v251, s6, v30
  s_mul_i32 s5, s63, 48
  s_lshr_b32 s6, s66, 5
  s_add_u32 s6, s6, s5
  s_add_u32 s6, s6, s24
  s_lshl_b32 s6, s6, 11
  s_add_u32 s73, s6, 6291456
  s_lshr_b32 s6, s67, 5
  s_add_u32 s6, s6, s5
  s_lshl_b32 s6, s6, 11
  s_add_u32 s74, s6, 6291456
  s_lshl_b32 s6, s63, 4
  s_add_u32 s6, s6, s62
  s_lshl_b32 s6, s6, 2
  s_add_u32 s6, s6, 16254976
  v_cmp_eq_u32 vcc, 0, v0
  v_mov_b32 v30, s6
  s_movk_i32 s27, 4096
  v_cndmask_b32 v252, v254, v30, vcc
  s_lshr_b32 s4, s2, 3
  s_lshr_b32 s5, s81, 1
  s_lshl_b32 s5, s5, 3
  s_and_b32 s6, s4, 7
  s_add_u32 s79, s5, s6
  s_and_b32 s5, s81, 1
  s_lshl_b32 s5, s5, 2
  s_lshr_b32 s6, s4, 3
  s_add_u32 s80, s5, s6
  s_mul_i32 s5, s60, 480
  s_mul_i32 s6, s80, 5
  s_add_u32 s5, s5, s6
  s_lshl_b32 s5, s5, 10
  s_add_u32 s16, s5, 12582912
  s_mul_i32 s5, s60, 200
  s_add_u32 s5, s5, s6
  s_lshl_b32 s5, s5, 10
  s_add_u32 s21, s5, 14680064
  s_lshl_b32 s5, s79, 1
  s_add_u32 s5, s5, s25
  s_mul_i32 s6, s5, 48
  s_mul_i32 s7, s60, 12
  s_add_u32 s6, s6, s7
  s_lshl_b32 s6, s6, 11
  s_add_u32 s19, s6, 6291456
  s_mul_i32 s6, s5, 21
  s_mul_i32 s7, s60, 5
  s_add_u32 s6, s6, s7
  s_lshl_b32 s6, s6, 11
  s_add_u32 s20, s6, 3145728
  s_cmp_eq_u32 s25, 0
  s_cselect_b32 s5, 1, -1
  s_mul_i32 s12, s5, 98304
  s_mul_i32 s13, s5, 43008
  s_lshl_b32 s5, s24, 10
  v_add_u32 v25, s5, v10
  v_xor_b32 v27, 1024, v25
  s_waitcnt vmcnt(10)
  ds_read_b128 a[0:3], v6 offset:0
  ds_read_b128 a[4:7], v6 offset:2048
  ds_read_b128 a[8:11], v7 offset:0
  ds_read_b128 a[12:15], v7 offset:2048
  s_waitcnt vmcnt(6)
  s_waitcnt lgkmcnt(0)
  ds_read_b128 a[16:19], v6 offset:4096
  ds_read_b128 a[20:23], v6 offset:6144
  ds_read_b128 a[24:27], v7 offset:4096
  ds_read_b128 a[28:31], v7 offset:6144
  s_add_u32 m0, s70, 0
  s_nop 0
  buffer_load_dwordx4 v2, s[28:31], s68 offen offset:0 lds
  buffer_load_dwordx4 v3, s[28:31], s68 offen offset:1024 lds
  buffer_load_dwordx4 v4, s[28:31], s68 offen offset:2048 lds
  buffer_load_dwordx4 v5, s[28:31], s68 offen offset:3072 lds
  s_add_u32 s68, s68, 128
  s_cmpk_eq_u32 s68, 1280
  s_cselect_b32 s68, 0, s68
  s_cmp_lg_u32 s2, 0
  s_cbranch_scc1 L_noclr2
  s_waitcnt vmcnt(8)
L_noclr2:
  s_barrier
  s_cmp_lg_u32 s3, 0
  s_cbranch_scc1 L_nogo
  v_mov_b32 v28, 0
  buffer_store_dword v253, v28, s[8:11], 0 offen sc1
L_nogo:
  ds_read_b128 v[108:111], v10 offset:0
  ds_read_b128 v[112:115], v10 offset:1024
  ds_read_b128 v[116:119], v10 offset:2048
  ds_read_b128 v[120:123], v10 offset:3072
  s_waitcnt lgkmcnt(3)
  v_mfma_f32_16x16x32_bf16 v[124:127], a[0:3], v[108:111], 0
  s_lshr_b32 s4, s2, 3
  s_mov_b32 s5, 4293984160
  v_mfma_f32_16x16x32_bf16 v[132:135], a[4:7], v[108:111], 0
  s_cmp_lt_u32 s81, 4
  s_cselect_b32 s5, s5, 4293984080
  s_waitcnt lgkmcnt(2)
  v_mfma_f32_16x16x32_bf16 v[128:131], a[0:3], v[112:115], 0
  s_waitcnt lgkmcnt(0)
  s_bfm_b32 s6, s4, 0
  v_mfma_f32_16x16x32_bf16 v[136:139], a[4:7], v[112:115], 0
  s_add_u32 m0, s70, 4096
  s_and_b32 s5, s5, s6
  v_mfma_f32_16x16x32_bf16 v[124:127], a[8:11], v[116:119], v[124:127]
  ds_read_b128 v[108:111], v10 offset:4096
  ds_read_b128 v[112:115], v10 offset:5120
  v_mfma_f32_16x16x32_bf16 v[132:135], a[12:15], v[116:119], v[132:135]
  buffer_load_dwordx4 v2, s[28:31], s68 offen offset:0 lds
  v_mfma_f32_16x16x32_bf16 v[128:131], a[8:11], v[120:123], v[128:131]
  buffer_load_dwordx4 v3, s[28:31], s68 offen offset:1024 lds
  v_mfma_f32_16x16x32_bf16 v[136:139], a[12:15], v[120:123], v[136:139]
  buffer_load_dwordx4 v4, s[28:31], s68 offen offset:2048 lds
  v_mfma_f32_16x16x32_bf16 v[76:79], v[244:247], a[0:3], 0
  buffer_load_dwordx4 v5, s[28:31], s68 offen offset:3072 lds
  v_mfma_f32_16x16x32_bf16 v[84:87], a[0:3], a[0:3], 0
  ds_read_b128 v[116:119], v10 offset:6144
  ds_read_b128 v[120:123], v10 offset:7168
  v_mfma_f32_16x16x32_bf16 v[80:83], v[244:247], a[4:7], 0
  s_add_u32 s68, s68, 128
  s_bcnt1_i32_b32 s82, s5
  v_mfma_f32_16x16x32_bf16 v[88:91], a[4:7], a[4:7], 0
  s_cmpk_eq_u32 s68, 1280
  s_cselect_b32 s68, 0, s68
  v_mfma_f32_16x16x32_bf16 v[76:79], v[244:247], a[8:11], v[76:79]
  s_waitcnt vmcnt(8)
  ds_read_b128 a[32:35], v6 offset:8192
  v_mfma_f32_16x16x32_bf16 v[84:87], a[8:11], a[8:11], v[84:87]
  ds_read_b128 a[36:39], v6 offset:10240
  ds_read_b128 a[40:43], v7 offset:8192
  v_mfma_f32_16x16x32_bf16 v[80:83], v[244:247], a[12:15], v[80:83]
  ds_read_b128 a[44:47], v7 offset:10240
  v_mfma_f32_16x16x32_bf16 v[88:91], a[12:15], a[12:15], v[88:91]
  s_cmp_lg_u32 s65, 0
  s_cselect_b32 s77, 31, s82
  s_waitcnt lgkmcnt(7)
  v_mfma_f32_16x16x32_bf16 v[124:127], a[16:19], v[108:111], v[124:127]
  s_lshl_b32 s83, s81, 2
  s_add_u32 s83, s83, s60
  v_mfma_f32_16x16x32_bf16 v[132:135], a[20:23], v[108:111], v[132:135]
  s_lshl_b32 s7, s4, 2
  s_add_u32 s7, s7, s60
  s_waitcnt lgkmcnt(6)
  v_mfma_f32_16x16x32_bf16 v[128:131], a[16:19], v[112:115], v[128:131]
  s_waitcnt lgkmcnt(0)
  s_and_b32 s5, s7, 63
  v_mfma_f32_16x16x32_bf16 v[136:139], a[20:23], v[112:115], v[136:139]
  s_add_u32 m0, s70, 8192
  s_lshl_b32 s5, s5, 3
  v_mfma_f32_16x16x32_bf16 v[124:127], a[24:27], v[116:119], v[124:127]
  ds_read_b128 v[108:111], v10 offset:8192
  ds_read_b128 v[112:115], v10 offset:9216
  v_mfma_f32_16x16x32_bf16 v[132:135], a[28:31], v[116:119], v[132:135]
  buffer_load_dwordx4 v2, s[28:31], s68 offen offset:0 lds
  v_mfma_f32_16x16x32_bf16 v[128:131], a[24:27], v[120:123], v[128:131]
  buffer_load_dwordx4 v3, s[28:31], s68 offen offset:1024 lds
  v_mfma_f32_16x16x32_bf16 v[136:139], a[28:31], v[120:123], v[136:139]
  buffer_load_dwordx4 v4, s[28:31], s68 offen offset:2048 lds
  v_mfma_f32_16x16x32_bf16 v[76:79], v[244:247], a[16:19], v[76:79]
  buffer_load_dwordx4 v5, s[28:31], s68 offen offset:3072 lds
  v_mfma_f32_16x16x32_bf16 v[84:87], a[16:19], a[16:19], v[84:87]
  ds_read_b128 v[116:119], v10 offset:10240
  ds_read_b128 v[120:123], v10 offset:11264
  v_mfma_f32_16x16x32_bf16 v[80:83], v[244:247], a[20:23], v[80:83]
  s_add_u32 s68, s68, 128
  s_add_u32 s5, s5, s81
  v_mfma_f32_16x16x32_bf16 v[88:91], a[20:23], a[20:23], v[88:91]
  s_cmpk_eq_u32 s68, 1280
  s_cselect_b32 s68, 0, s68
  v_mfma_f32_16x16x32_bf16 v[76:79], v[244:247], a[24:27], v[76:79]
  s_waitcnt vmcnt(8)
  ds_read_b128 a[48:51], v6 offset:0
  v_mfma_f32_16x16x32_bf16 v[84:87], a[24:27], a[24:27], v[84:87]
  ds_read_b128 a[52:55], v6 offset:2048
  ds_read_b128 a[56:59], v7 offset:0
  v_mfma_f32_16x16x32_bf16 v[80:83], v[244:247], a[28:31], v[80:83]
  ds_read_b128 a[60:63], v7 offset:2048
  s_mul_i32 s5, s5, 2568
  v_mfma_f32_16x16x32_bf16 v[88:91], a[28:31], a[28:31], v[88:91]
  s_and_b32 s5, s5, 0xffffff80
  v_cmp_gt_u32 vcc, 22, v0
  s_waitcnt lgkmcnt(7)
  v_mfma_f32_16x16x32_bf16 v[124:127], a[32:35], v[108:111], v[124:127]
  v_lshl_add_u32 v30, v0, 7, s5
  v_mfma_f32_16x16x32_bf16 v[132:135], a[36:39], v[108:111], v[132:135]
  s_cmp_lt_u32 s7, 64
  s_cselect_b32 s61, 0, 2147483392
  s_waitcnt lgkmcnt(6)
  v_mfma_f32_16x16x32_bf16 v[128:131], a[32:35], v[112:115], v[128:131]
  s_waitcnt lgkmcnt(0)
  v_cndmask_b32 v95, v254, v30, vcc
  v_mfma_f32_16x16x32_bf16 v[136:139], a[36:39], v[112:115], v[136:139]
  s_add_u32 m0, s70, 0
  s_xor_b32 s62, s61, 2147483392
  v_mfma_f32_16x16x32_bf16 v[124:127], a[40:43], v[116:119], v[124:127]
  ds_read_b128 v[108:111], v10 offset:12288
  ds_read_b128 v[112:115], v10 offset:13312
  v_mfma_f32_16x16x32_bf16 v[132:135], a[44:47], v[116:119], v[132:135]
  buffer_load_dwordx4 v2, s[28:31], s68 offen offset:0 lds
  v_mfma_f32_16x16x32_bf16 v[128:131], a[40:43], v[120:123], v[128:131]
  buffer_load_dwordx4 v3, s[28:31], s68 offen offset:1024 lds
  v_mfma_f32_16x16x32_bf16 v[136:139], a[44:47], v[120:123], v[136:139]
  buffer_load_dwordx4 v4, s[28:31], s68 offen offset:2048 lds
  v_mfma_f32_16x16x32_bf16 v[76:79], v[244:247], a[32:35], v[76:79]
  buffer_load_dwordx4 v5, s[28:31], s68 offen offset:3072 lds
  v_mfma_f32_16x16x32_bf16 v[84:87], a[32:35], a[32:35], v[84:87]
  ds_read_b128 v[116:119], v10 offset:14336
  ds_read_b128 v[120:123], v10 offset:15360
  v_mfma_f32_16x16x32_bf16 v[80:83], v[244:247], a[36:39], v[80:83]
  s_add_u32 s68, s68, 128
  s_lshl_b32 s5, s83, 1
  v_mfma_f32_16x16x32_bf16 v[88:91], a[36:39], a[36:39], v[88:91]
  s_cmpk_eq_u32 s68, 1280
  s_cselect_b32 s68, 0, s68
  v_mfma_f32_16x16x32_bf16 v[76:79], v[244:247], a[40:43], v[76:79]
  s_waitcnt vmcnt(8)
  ds_read_b128 a[64:67], v6 offset:4096
  v_mfma_f32_16x16x32_bf16 v[84:87], a[40:43], a[40:43], v[84:87]
  ds_read_b128 a[68:71], v6 offset:6144
  ds_read_b128 a[72:75], v7 offset:4096
  v_mfma_f32_16x16x32_bf16 v[80:83], v[244:247], a[44:47], v[80:83]
  ds_read_b128 a[76:79], v7 offset:6144
  s_and_b32 s6, s5, 15
  v_mfma_f32_16x16x32_bf16 v[88:91], a[44:47], a[44:47], v[88:91]
  s_mul_i32 s5, s83, 642
  s_lshl_b32 s7, s82, 5
  s_waitcnt lgkmcnt(7)
  v_mfma_f32_16x16x32_bf16 v[124:127], a[48:51], v[108:111], v[124:127]
  s_add_u32 s5, s5, s7
  s_sub_u32 s5, s5, s6
  v_mfma_f32_16x16x32_bf16 v[132:135], a[52:55], v[108:111], v[132:135]
  s_cmp_ge_u32 s77, 21
  s_cselect_b32 s5, 2147483392, s5
  s_waitcnt lgkmcnt(6)
  v_mfma_f32_16x16x32_bf16 v[128:131], a[48:51], v[112:115], v[128:131]
  s_waitcnt lgkmcnt(0)
  v_add_u32 v30, 0, v0
  v_mfma_f32_16x16x32_bf16 v[136:139], a[52:55], v[112:115], v[136:139]
  s_add_u32 m0, s70, 4096
  v_mul_u32_u24 v31, 21846, v30
  v_mfma_f32_16x16x32_bf16 v[124:127], a[56:59], v[116:119], v[124:127]
  ds_read_b128 v[108:111], v10 offset:16384
  ds_read_b128 v[112:115], v10 offset:17408
  v_mfma_f32_16x16x32_bf16 v[132:135], a[60:63], v[116:119], v[132:135]
  buffer_load_dwordx4 v2, s[28:31], s68 offen offset:0 lds
  v_mfma_f32_16x16x32_bf16 v[128:131], a[56:59], v[120:123], v[128:131]
  buffer_load_dwordx4 v3, s[28:31], s68 offen offset:1024 lds
  v_mfma_f32_16x16x32_bf16 v[136:139], a[60:63], v[120:123], v[136:139]
  buffer_load_dwordx4 v4, s[28:31], s68 offen offset:2048 lds
  v_mfma_f32_16x16x32_bf16 v[76:79], v[244:247], a[48:51], v[76:79]
  buffer_load_dwordx4 v5, s[28:31], s68 offen offset:3072 lds
  v_mfma_f32_16x16x32_bf16 v[84:87], a[48:51], a[48:51], v[84:87]
  ds_read_b128 v[116:119], v10 offset:18432
  ds_read_b128 v[120:123], v10 offset:19456
  v_mfma_f32_16x16x32_bf16 v[80:83], v[244:247], a[52:55], v[80:83]
  s_add_u32 s68, s68, 128
  v_lshrrev_b32 v31, 16, v31
  v_mfma_f32_16x16x32_bf16 v[88:91], a[52:55], a[52:55], v[88:91]
  s_cmpk_eq_u32 s68, 1280
  s_cselect_b32 s68, 0, s68
  v_mfma_f32_16x16x32_bf16 v[76:79], v[244:247], a[56:59], v[76:79]
  s_waitcnt vmcnt(8)
  ds_read_b128 a[80:83], v6 offset:8192
  v_mfma_f32_16x16x32_bf16 v[84:87], a[56:59], a[56:59], v[84:87]
  ds_read_b128 a[84:87], v6 offset:10240
  ds_read_b128 a[88:91], v7 offset:8192
  v_mfma_f32_16x16x32_bf16 v[80:83], v[244:247], a[60:63], v[80:83]
  ds_read_b128 a[92:95], v7 offset:10240
  v_mul_u32_u24 v92, 20496, v31
  v_mfma_f32_16x16x32_bf16 v[88:91], a[60:63], a[60:63], v[88:91]
  v_lshl_add_u32 v92, v30, 4, v92
  v_add_u32 v92, s5, v92
  s_waitcnt lgkmcnt(7)
  v_mfma_f32_16x16x32_bf16 v[124:127], a[64:67], v[108:111], v[124:127]
  v_add_u32 v30, 64, v0
  v_mul_u32_u24 v31, 21846, v30
  v_mfma_f32_16x16x32_bf16 v[132:135], a[68:71], v[108:111], v[132:135]
  v_lshrrev_b32 v31, 16, v31
  v_mul_u32_u24 v93, 20496, v31
  s_waitcnt lgkmcnt(6)
  v_mfma_f32_16x16x32_bf16 v[128:131], a[64:67], v[112:115], v[128:131]
  s_waitcnt lgkmcnt(0)
  v_lshl_add_u32 v93, v30, 4, v93
  v_mfma_f32_16x16x32_bf16 v[136:139], a[68:71], v[112:115], v[136:139]
  s_add_u32 m0, s70, 8192
  v_add_u32 v93, s5, v93
  v_mfma_f32_16x16x32_bf16 v[124:127], a[72:75], v[116:119], v[124:127]
  ds_read_b128 v[108:111], v10 offset:0
  ds_read_b128 v[112:115], v10 offset:1024
  v_mfma_f32_16x16x32_bf16 v[132:135], a[76:79], v[116:119], v[132:135]
  buffer_load_dwordx4 v2, s[28:31], s68 offen offset:0 lds
  v_mfma_f32_16x16x32_bf16 v[128:131], a[72:75], v[120:123], v[128:131]
  buffer_load_dwordx4 v3, s[28:31], s68 offen offset:1024 lds
  v_mfma_f32_16x16x32_bf16 v[136:139], a[76:79], v[120:123], v[136:139]
  buffer_load_dwordx4 v4, s[28:31], s68 offen offset:2048 lds
  v_mfma_f32_16x16x32_bf16 v[76:79], v[244:247], a[64:67], v[76:79]
  buffer_load_dwordx4 v5, s[28:31], s68 offen offset:3072 lds
  v_mfma_f32_16x16x32_bf16 v[84:87], a[64:67], a[64:67], v[84:87]
  ds_read_b128 v[116:119], v10 offset:2048
  ds_read_b128 v[120:123], v10 offset:3072
  v_mfma_f32_16x16x32_bf16 v[80:83], v[244:247], a[68:71], v[80:83]
  s_add_u32 s68, s68, 128
  v_add_u32 v30, 128, v0
  v_mfma_f32_16x16x32_bf16 v[88:91], a[68:71], a[68:71], v[88:91]
  s_cmpk_eq_u32 s68, 1280
  s_cselect_b32 s68, 0, s68
  v_mfma_f32_16x16x32_bf16 v[76:79], v[244:247], a[72:75], v[76:79]
  s_waitcnt vmcnt(8)
  ds_read_b128 a[96:99], v6 offset:0
  v_mfma_f32_16x16x32_bf16 v[84:87], a[72:75], a[72:75], v[84:87]
  ds_read_b128 a[100:103], v6 offset:2048
  ds_read_b128 a[104:107], v7 offset:0
  v_mfma_f32_16x16x32_bf16 v[80:83], v[244:247], a[76:79], v[80:83]
  ds_read_b128 a[108:111], v7 offset:2048
  v_mul_u32_u24 v31, 21846, v30
  v_mfma_f32_16x16x32_bf16 v[88:91], a[76:79], a[76:79], v[88:91]
  v_lshrrev_b32 v31, 16, v31
  v_mul_u32_u24 v94, 20496, v31
  s_waitcnt lgkmcnt(7)
  v_mfma_f32_16x16x32_bf16 v[140:143], a[80:83], v[108:111], 0
  v_lshl_add_u32 v94, v30, 4, v94
  v_add_u32 v94, s5, v94
  v_mfma_f32_16x16x32_bf16 v[148:151], a[84:87], v[108:111], 0
  s_mul_i32 s7, s60, 6144
  s_add_u32 s26, s7, 40960
  s_waitcnt lgkmcnt(6)
  v_mfma_f32_16x16x32_bf16 v[144:147], a[80:83], v[112:115], 0
  s_waitcnt lgkmcnt(0)
  v_mfma_f32_16x16x32_bf16 v[152:155], a[84:87], v[112:115], 0
  s_add_u32 m0, s70, 0
  v_mfma_f32_16x16x32_bf16 v[140:143], a[88:91], v[116:119], v[140:143]
  ds_read_b128 v[108:111], v10 offset:4096
  ds_read_b128 v[112:115], v10 offset:5120
  v_mfma_f32_16x16x32_bf16 v[148:151], a[92:95], v[116:119], v[148:151]
  buffer_load_dwordx4 v2, s[28:31], s68 offen offset:0 lds
  v_mfma_f32_16x16x32_bf16 v[144:147], a[88:91], v[120:123], v[144:147]
  buffer_load_dwordx4 v3, s[28:31], s68 offen offset:1024 lds
  v_mfma_f32_16x16x32_bf16 v[152:155], a[92:95], v[120:123], v[152:155]
  buffer_load_dwordx4 v4, s[28:31], s68 offen offset:2048 lds
  v_mfma_f32_16x16x32_bf16 v[76:79], v[244:247], a[80:83], v[76:79]
  buffer_load_dwordx4 v5, s[28:31], s68 offen offset:3072 lds
  v_mfma_f32_16x16x32_bf16 v[84:87], a[80:83], a[80:83], v[84:87]
  ds_read_b128 v[116:119], v10 offset:6144
  ds_read_b128 v[120:123], v10 offset:7168
  v_mfma_f32_16x16x32_bf16 v[80:83], v[244:247], a[84:87], v[80:83]
  v_mfma_f32_16x16x32_bf16 v[88:91], a[84:87], a[84:87], v[88:91]
  v_mfma_f32_16x16x32_bf16 v[76:79], v[244:247], a[88:91], v[76:79]
  s_waitcnt vmcnt(8)
  ds_read_b128 a[112:115], v6 offset:4096
  v_mfma_f32_16x16x32_bf16 v[84:87], a[88:91], a[88:91], v[84:87]
  ds_read_b128 a[116:119], v6 offset:6144
  ds_read_b128 a[120:123], v7 offset:4096
  v_mfma_f32_16x16x32_bf16 v[80:83], v[244:247], a[92:95], v[80:83]
  ds_read_b128 a[124:127], v7 offset:6144
  v_mfma_f32_16x16x32_bf16 v[88:91], a[92:95], a[92:95], v[88:91]
  s_waitcnt lgkmcnt(7)
  v_mfma_f32_16x16x32_bf16 v[140:143], a[96:99], v[108:111], v[140:143]
  v_mfma_f32_16x16x32_bf16 v[148:151], a[100:103], v[108:111], v[148:151]
  s_waitcnt lgkmcnt(6)
  v_mfma_f32_16x16x32_bf16 v[144:147], a[96:99], v[112:115], v[144:147]
  s_waitcnt lgkmcnt(0)
  v_mfma_f32_16x16x32_bf16 v[152:155], a[100:103], v[112:115], v[152:155]
  s_lshl_b32 s22, s60, 11
  s_add_u32 m0, s22, 155648
  v_mfma_f32_16x16x32_bf16 v[140:143], a[104:107], v[116:119], v[140:143]
  ds_read_b128 v[108:111], v10 offset:8192
  ds_read_b128 v[112:115], v10 offset:9216
  v_mfma_f32_16x16x32_bf16 v[148:151], a[108:111], v[116:119], v[148:151]
  s_movk_i32 s23, 20480
  v_mfma_f32_16x16x32_bf16 v[144:147], a[104:107], v[120:123], v[144:147]
  buffer_load_dwordx4 v1, s[40:43], 0 offen lds
  v_mfma_f32_16x16x32_bf16 v[152:155], a[108:111], v[120:123], v[152:155]
  s_add_u32 m0, s22, 156672
  v_mov_b32 v58, 0
  v_mfma_f32_16x16x32_bf16 v[76:79], v[244:247], a[96:99], v[76:79]
  buffer_load_dwordx4 v1, s[40:43], s23 offen lds
  v_mfma_f32_16x16x32_bf16 v[84:87], a[96:99], a[96:99], v[84:87]
  ds_read_b128 v[116:119], v10 offset:10240
  ds_read_b128 v[120:123], v10 offset:11264
  v_mfma_f32_16x16x32_bf16 v[80:83], v[244:247], a[100:103], v[80:83]
  s_add_u32 m0, s71, 0
  v_mfma_f32_16x16x32_bf16 v[88:91], a[100:103], a[100:103], v[88:91]
  buffer_load_dwordx4 v11, s[32:35], s69 offen lds
  v_mfma_f32_16x16x32_bf16 v[76:79], v[244:247], a[104:107], v[76:79]
  s_waitcnt vmcnt(7)
  ds_read_b128 a[128:131], v6 offset:8192
  v_mfma_f32_16x16x32_bf16 v[84:87], a[104:107], a[104:107], v[84:87]
  ds_read_b128 a[132:135], v6 offset:10240
  ds_read_b128 a[136:139], v7 offset:8192
  v_mfma_f32_16x16x32_bf16 v[80:83], v[244:247], a[108:111], v[80:83]
  ds_read_b128 a[140:143], v7 offset:10240
  v_mfma_f32_16x16x32_bf16 v[88:91], a[108:111], a[108:111], v[88:91]
  buffer_load_dwordx4 v11, s[36:39], s69 offen offset:1024 lds
  s_add_u32 s69, s69, 98304
  s_cmp_eq_u32 s69, 1966080
  s_cselect_b32 s69, 0, s69
  s_waitcnt lgkmcnt(7)
  v_mfma_f32_16x16x32_bf16 v[140:143], a[112:115], v[108:111], v[140:143]
  v_mfma_f32_16x16x32_bf16 v[148:151], a[116:119], v[108:111], v[148:151]
  s_waitcnt lgkmcnt(6)
  v_mfma_f32_16x16x32_bf16 v[144:147], a[112:115], v[112:115], v[144:147]
  s_waitcnt lgkmcnt(0)
  v_mfma_f32_16x16x32_bf16 v[152:155], a[116:119], v[112:115], v[152:155]
  s_lshl_b32 s17, s3, 10
  s_add_u32 s17, s17, 14680064
  v_mfma_f32_16x16x32_bf16 v[140:143], a[120:123], v[116:119], v[140:143]
  ds_read_b128 v[108:111], v10 offset:12288
  ds_read_b128 v[112:115], v10 offset:13312
  v_mfma_f32_16x16x32_bf16 v[148:151], a[124:127], v[116:119], v[148:151]
  s_cmp_lt_u32 s3, 800
  s_cselect_b32 s17, s17, 2147483392
  v_mfma_f32_16x16x32_bf16 v[144:147], a[120:123], v[120:123], v[144:147]
  buffer_store_dwordx4 v[172:175], v10, s[44:47], s17 offen sc1
  v_mfma_f32_16x16x32_bf16 v[152:155], a[124:127], v[120:123], v[152:155]
  buffer_load_dword v59, v58, s[8:11], 0 offen  sc1
  v_mfma_f32_16x16x32_bf16 v[76:79], v[244:247], a[112:115], v[76:79]
  s_add_u32 m0, s71, 8192
  v_mfma_f32_16x16x32_bf16 v[84:87], a[112:115], a[112:115], v[84:87]
  ds_read_b128 v[116:119], v10 offset:14336
  ds_read_b128 v[120:123], v10 offset:15360
  v_mfma_f32_16x16x32_bf16 v[80:83], v[244:247], a[116:119], v[80:83]
  buffer_load_dwordx4 v11, s[32:35], s69 offen lds
  v_mfma_f32_16x16x32_bf16 v[88:91], a[116:119], a[116:119], v[88:91]
  buffer_load_dwordx4 v11, s[36:39], s69 offen offset:1024 lds
  v_mfma_f32_16x16x32_bf16 v[76:79], v[244:247], a[120:123], v[76:79]
  s_waitcnt vmcnt(8)
  ds_read_b128 a[144:147], v6 offset:0
  v_mfma_f32_16x16x32_bf16 v[84:87], a[120:123], a[120:123], v[84:87]
  ds_read_b128 a[148:151], v6 offset:2048
  ds_read_b128 a[152:155], v7 offset:0
  v_mfma_f32_16x16x32_bf16 v[80:83], v[244:247], a[124:127], v[80:83]
  ds_read_b128 a[156:159], v7 offset:2048
  s_add_u32 s69, s69, 98304
  v_mfma_f32_16x16x32_bf16 v[88:91], a[124:127], a[124:127], v[88:91]
  s_cmp_eq_u32 s69, 1966080
  s_cselect_b32 s69, 0, s69
  s_waitcnt lgkmcnt(7)
  v_mfma_f32_16x16x32_bf16 v[140:143], a[128:131], v[108:111], v[140:143]
  v_mfma_f32_16x16x32_bf16 v[148:151], a[132:135], v[108:111], v[148:151]
  s_waitcnt lgkmcnt(6)
  v_mfma_f32_16x16x32_bf16 v[144:147], a[128:131], v[112:115], v[144:147]
  s_waitcnt lgkmcnt(0)
  v_mfma_f32_16x16x32_bf16 v[152:155], a[132:135], v[112:115], v[152:155]
  s_add_u32 m0, s71, 16384
  v_mfma_f32_16x16x32_bf16 v[140:143], a[136:139], v[116:119], v[140:143]
  ds_read_b128 v[108:111], v10 offset:16384
  ds_read_b128 v[112:115], v10 offset:17408
  v_mfma_f32_16x16x32_bf16 v[148:151], a[140:143], v[116:119], v[148:151]
  buffer_load_dwordx4 v11, s[32:35], s69 offen lds
  v_mfma_f32_16x16x32_bf16 v[144:147], a[136:139], v[120:123], v[144:147]
  buffer_load_dwordx4 v11, s[36:39], s69 offen offset:1024 lds
  v_mfma_f32_16x16x32_bf16 v[152:155], a[140:143], v[120:123], v[152:155]
  s_add_u32 s69, s69, 98304
  v_mfma_f32_16x16x32_bf16 v[76:79], v[244:247], a[128:131], v[76:79]
  s_cmp_eq_u32 s69, 1966080
  s_cselect_b32 s69, 0, s69
  v_mfma_f32_16x16x32_bf16 v[84:87], a[128:131], a[128:131], v[84:87]
  ds_read_b128 v[116:119], v10 offset:18432
  ds_read_b128 v[120:123], v10 offset:19456
  v_mfma_f32_16x16x32_bf16 v[80:83], v[244:247], a[132:135], v[80:83]
  s_add_u32 m0, s71, 24576
  v_mfma_f32_16x16x32_bf16 v[88:91], a[132:135], a[132:135], v[88:91]
  buffer_load_dwordx4 v11, s[32:35], s69 offen lds
  v_mfma_f32_16x16x32_bf16 v[76:79], v[244:247], a[136:139], v[76:79]
  buffer_load_dwordx4 v11, s[36:39], s69 offen offset:1024 lds
  v_mfma_f32_16x16x32_bf16 v[84:87], a[136:139], a[136:139], v[84:87]
  s_add_u32 s69, s69, 98304
  v_mfma_f32_16x16x32_bf16 v[80:83], v[244:247], a[140:143], v[80:83]
  s_cmp_eq_u32 s69, 1966080
  s_cselect_b32 s69, 0, s69
  v_mfma_f32_16x16x32_bf16 v[88:91], a[140:143], a[140:143], v[88:91]
  v_mfma_f32_16x16x32_bf16 v[76:79], v[244:247], a[144:147], v[76:79]
  s_add_u32 m0, s71, 32768
  v_mfma_f32_16x16x32_bf16 v[84:87], a[144:147], a[144:147], v[84:87]
  buffer_load_dwordx4 v11, s[32:35], s69 offen lds
  v_mfma_f32_16x16x32_bf16 v[80:83], v[244:247], a[148:151], v[80:83]
  buffer_load_dwordx4 v11, s[36:39], s69 offen offset:1024 lds
  v_mfma_f32_16x16x32_bf16 v[88:91], a[148:151], a[148:151], v[88:91]
  s_add_u32 s69, s69, 98304
  v_mfma_f32_16x16x32_bf16 v[76:79], v[244:247], a[152:155], v[76:79]
  s_cmp_eq_u32 s69, 1966080
  s_cselect_b32 s69, 0, s69
  v_mfma_f32_16x16x32_bf16 v[84:87], a[152:155], a[152:155], v[84:87]
  buffer_load_dword v255, v95, s[52:55], s61 offen  sc1
  v_mfma_f32_16x16x32_bf16 v[80:83], v[244:247], a[156:159], v[80:83]
  buffer_load_dword v255, v95, s[56:59], s62 offen  sc1
  v_mfma_f32_16x16x32_bf16 v[88:91], a[156:159], a[156:159], v[88:91]
  s_waitcnt lgkmcnt(3)
  v_mfma_f32_16x16x32_bf16 v[140:143], a[144:147], v[108:111], v[140:143]
  v_mfma_f32_16x16x32_bf16 v[148:151], a[148:151], v[108:111], v[148:151]
  s_mov_b32 s4, 1048577
  s_mov_b32 s5, 268435712
  s_waitcnt lgkmcnt(2)
  v_mfma_f32_16x16x32_bf16 v[144:147], a[144:147], v[112:115], v[144:147]
  v_cndmask_b32 v18, 0, v84, s[4:5]
  v_cndmask_b32 v19, 0, v88, s[4:5]
  v_mfma_f32_16x16x32_bf16 v[152:155], a[148:151], v[112:115], v[152:155]
  s_lshl_b64 s[4:5], s[4:5], 1
  v_cndmask_b32 v18, v18, v85, s[4:5]
  s_waitcnt lgkmcnt(1)
  v_mfma_f32_16x16x32_bf16 v[140:143], a[152:155], v[116:119], v[140:143]
  v_cndmask_b32 v19, v19, v89, s[4:5]
  s_lshl_b64 s[4:5], s[4:5], 1
  v_mfma_f32_16x16x32_bf16 v[148:151], a[156:159], v[116:119], v[148:151]
  v_cndmask_b32 v18, v18, v86, s[4:5]
  v_cndmask_b32 v19, v19, v90, s[4:5]
  s_waitcnt lgkmcnt(0)
  v_mfma_f32_16x16x32_bf16 v[144:147], a[152:155], v[120:123], v[144:147]
  s_lshl_b64 s[4:5], s[4:5], 1
  v_cndmask_b32 v18, v18, v87, s[4:5]
  v_mfma_f32_16x16x32_bf16 v[152:155], a[156:159], v[120:123], v[152:155]
  v_cndmask_b32 v19, v19, v91, s[4:5]
  v_permlane32_swap_b32 v76, v80
  s_nop 0
  v_permlane32_swap_b32 v18, v19
  v_and_b32 v32, 15, v0
  v_add_f32 v29, v18, v19
  v_mul_f32 v28, 0x3acccccd, v76
  v_mov_b32 v31, v29
  s_nop 0
  s_nop 0
  v_permlane16_swap_b32 v29, v31
  v_add_f32 v29, v29, v31
  v_mul_f32 v29, 0x3acccccd, v29
  v_fma_f32 v29, -v28, v28, v29
  v_max_f32 v29, 0, v29
  v_cvt_pk_bf16_f32 v30, v28, v29
  v_and_b32 v29, 0xffff0000, v30
  v_add_f32 v29, 0x3727c5ac, v29
  v_cvt_pk_bf16_f32 v29, v29, v29
  v_and_b32 v29, 0xffff0000, v29
  v_sqrt_f32 v29, v29
  v_lshlrev_b32 v28, 16, v30
  v_cvt_pk_bf16_f32 v29, v29, v29
  v_and_b32 v29, 0xffff0000, v29
  v_rcp_f32 v29, v29
  v_lshrrev_b32 v31, 5, v0
  v_lshl_add_u32 v32, v31, 4, v32
  s_add_u32 s5, s70, 12032
  v_lshl_add_u32 v32, v32, 2, s5
  ds_write2_b32 v32, v29, v28 offset0:0 offset1:32
  v_sub_f32 v20, 0, v28
  v_mul_f32 v24, v29, v29
  v_mov_b32 v22, v20
  v_mov_b32 v26, v24
  s_waitcnt lgkmcnt(0)
  ds_read_b128 v[236:239], v21
  ds_read_b128 v[240:243], v21 offset:64
  v_permlane32_swap_b32 v20, v22
  v_permlane32_swap_b32 v24, v26
  s_cmp_lg_u32 s65, 0
  s_cbranch_scc1 L_two
  v_pk_fma_f32 v[124:125], v[140:141], v[14:15], v[124:125] op_sel_hi:[1,0,1]
  v_pk_fma_f32 v[126:127], v[142:143], v[14:15], v[126:127] op_sel_hi:[1,0,1]
  v_pk_fma_f32 v[128:129], v[144:145], v[14:15], v[128:129] op_sel_hi:[1,0,1]
  v_pk_fma_f32 v[130:131], v[146:147], v[14:15], v[130:131] op_sel_hi:[1,0,1]
  v_pk_fma_f32 v[132:133], v[148:149], v[14:15], v[132:133] op_sel_hi:[1,0,1]
  v_pk_fma_f32 v[134:135], v[150:151], v[14:15], v[134:135] op_sel_hi:[1,0,1]
  v_pk_fma_f32 v[136:137], v[152:153], v[14:15], v[136:137] op_sel_hi:[1,0,1]
  v_pk_fma_f32 v[138:139], v[154:155], v[14:15], v[138:139] op_sel_hi:[1,0,1]
  s_waitcnt lgkmcnt(1)
  v_pk_mul_f32 v[124:125], v[124:125], v[236:237]
  v_pk_mul_f32 v[126:127], v[126:127], v[238:239]
  v_pk_mul_f32 v[128:129], v[128:129], v[236:237]
  v_pk_mul_f32 v[130:131], v[130:131], v[238:239]
  s_waitcnt lgkmcnt(0)
  v_pk_mul_f32 v[132:133], v[132:133], v[240:241]
  v_pk_mul_f32 v[134:135], v[134:135], v[242:243]
  v_pk_mul_f32 v[136:137], v[136:137], v[240:241]
  v_pk_mul_f32 v[138:139], v[138:139], v[242:243]
  v_cvt_pk_bf16_f32 v28, v124, v125
  v_cvt_pk_bf16_f32 v29, v126, v127
  v_cvt_pk_bf16_f32 v30, v132, v133
  v_cvt_pk_bf16_f32 v31, v134, v135
  v_cvt_pk_bf16_f32 v32, v128, v129
  v_cvt_pk_bf16_f32 v33, v130, v131
  v_cvt_pk_bf16_f32 v34, v136, v137
  v_cvt_pk_bf16_f32 v35, v138, v139
  v_cvt_pk_bf16_f32 v36, -v124, -v125
  v_cvt_pk_bf16_f32 v37, -v126, -v127
  v_cvt_pk_bf16_f32 v38, -v132, -v133
  v_cvt_pk_bf16_f32 v39, -v134, -v135
  v_mfma_f32_16x16x32_bf16 v[156:159], v[60:63], v[28:31], 0
  v_lshrrev_b32 v44, 4, v0
  v_bfe_u32 v45, v0, 2, 2
  v_mfma_f32_16x16x32_bf16 v[160:163], v[60:63], v[32:35], 0
  v_lshl_add_u32 v44, v44, 2, v45
  v_lshlrev_b32 v44, 6, v44
  v_mfma_f32_16x16x32_bf16 v[164:167], v[64:67], v[28:31], 0
  v_and_b32 v45, 3, v0
  v_lshl_add_u32 v44, v45, 3, v44
  v_mfma_f32_16x16x32_bf16 v[168:171], v[64:67], v[32:35], 0
  s_lshl_b32 s5, s60, 11
  s_add_u32 s5, s5, 155648
  v_mfma_f32_16x16x32_bf16 v[156:159], v[68:71], v[32:35], v[156:159]
  v_add_u32 v44, s5, v44
  s_waitcnt vmcnt(14)
  v_mfma_f32_16x16x32_bf16 v[160:163], v[68:71], v[36:39], v[160:163]
  ds_read_b64_tr_b16 v[84:85], v44 offset:0
  ds_read_b64_tr_b16 v[86:87], v44 offset:1024
  v_mfma_f32_16x16x32_bf16 v[164:167], v[72:75], v[32:35], v[164:167]
  ds_read_b64_tr_b16 v[88:89], v44 offset:32
  ds_read_b64_tr_b16 v[90:91], v44 offset:1056
  v_mfma_f32_16x16x32_bf16 v[168:171], v[72:75], v[36:39], v[168:171]
  s_mul_i32 s5, s75, 40
  s_lshl_b32 s6, s76, 3
  s_add_u32 s5, s5, s6
  s_lshl_b32 s6, s60, 1
  s_add_u32 s5, s5, s6
  s_lshl_b32 s5, s5, 10
  s_add_u32 s5, s5, 12582912
  s_cmp_lt_u32 s2, 240
  s_cselect_b32 s5, s5, 2147483392
  s_waitcnt lgkmcnt(2)
  buffer_store_dwordx4 v[84:87], v10, s[44:47], s5 offen offset:0 sc1
  s_waitcnt lgkmcnt(0)
  buffer_store_dwordx4 v[88:91], v10, s[44:47], s5 offen offset:1024 sc1
  s_branch L_nou1
L_two:
  ds_read_b128 v[108:111], v10 offset:20480
  ds_read_b128 v[112:115], v10 offset:21504
  ds_read_b128 v[116:119], v10 offset:22528
  ds_read_b128 v[120:123], v10 offset:23552
  ds_read_b128 v[172:175], v10 offset:24576
  ds_read_b128 v[176:179], v10 offset:25600
  s_waitcnt lgkmcnt(5)
  v_mfma_f32_16x16x32_bf16 v[188:191], a[0:3], v[108:111], 0
  ds_read_b128 v[180:183], v10 offset:26624
  ds_read_b128 v[184:187], v10 offset:27648
  v_mfma_f32_16x16x32_bf16 v[196:199], a[4:7], v[108:111], 0
  ds_read_b128 v[28:31], v21 offset:128
  ds_read_b128 v[32:35], v21 offset:192
  s_waitcnt lgkmcnt(8)
  v_mfma_f32_16x16x32_bf16 v[192:195], a[0:3], v[112:115], 0
  v_pk_fma_f32 v[124:125], v[140:141], v[14:15], v[124:125] op_sel_hi:[1,0,1]
  v_mfma_f32_16x16x32_bf16 v[200:203], a[4:7], v[112:115], 0
  v_pk_fma_f32 v[126:127], v[142:143], v[14:15], v[126:127] op_sel_hi:[1,0,1]
  s_waitcnt lgkmcnt(7)
  v_mfma_f32_16x16x32_bf16 v[188:191], a[8:11], v[116:119], v[188:191]
  ds_read_b128 v[108:111], v10 offset:28672
  ds_read_b128 v[112:115], v10 offset:29696
  v_mfma_f32_16x16x32_bf16 v[196:199], a[12:15], v[116:119], v[196:199]
  v_pk_fma_f32 v[128:129], v[144:145], v[14:15], v[128:129] op_sel_hi:[1,0,1]
  s_waitcnt lgkmcnt(8)
  v_mfma_f32_16x16x32_bf16 v[192:195], a[8:11], v[120:123], v[192:195]
  v_pk_fma_f32 v[130:131], v[146:147], v[14:15], v[130:131] op_sel_hi:[1,0,1]
  v_mfma_f32_16x16x32_bf16 v[200:203], a[12:15], v[120:123], v[200:203]
  v_pk_fma_f32 v[132:133], v[148:149], v[14:15], v[132:133] op_sel_hi:[1,0,1]
  s_waitcnt lgkmcnt(7)
  v_mfma_f32_16x16x32_bf16 v[188:191], a[16:19], v[172:175], v[188:191]
  ds_read_b128 v[116:119], v10 offset:30720
  ds_read_b128 v[120:123], v10 offset:31744
  v_mfma_f32_16x16x32_bf16 v[196:199], a[20:23], v[172:175], v[196:199]
  v_pk_fma_f32 v[134:135], v[150:151], v[14:15], v[134:135] op_sel_hi:[1,0,1]
  s_waitcnt lgkmcnt(8)
  v_mfma_f32_16x16x32_bf16 v[192:195], a[16:19], v[176:179], v[192:195]
  v_pk_fma_f32 v[136:137], v[152:153], v[14:15], v[136:137] op_sel_hi:[1,0,1]
  v_mfma_f32_16x16x32_bf16 v[200:203], a[20:23], v[176:179], v[200:203]
  v_pk_fma_f32 v[138:139], v[154:155], v[14:15], v[138:139] op_sel_hi:[1,0,1]
  s_waitcnt lgkmcnt(7)
  v_mfma_f32_16x16x32_bf16 v[188:191], a[24:27], v[180:183], v[188:191]
  ds_read_b128 v[172:175], v10 offset:32768
  ds_read_b128 v[176:179], v10 offset:33792
  v_mfma_f32_16x16x32_bf16 v[196:199], a[28:31], v[180:183], v[196:199]
  s_waitcnt lgkmcnt(7)
  v_fmac_f32 v124, v15, v28
  v_fmac_f32 v125, v15, v29
  v_mfma_f32_16x16x32_bf16 v[192:195], a[24:27], v[184:187], v[192:195]
  v_fmac_f32 v126, v15, v30
  v_fmac_f32 v127, v15, v31
  v_mfma_f32_16x16x32_bf16 v[200:203], a[28:31], v[184:187], v[200:203]
  s_waitcnt lgkmcnt(6)
  v_fmac_f32 v132, v15, v32
  v_fmac_f32 v133, v15, v33
  s_waitcnt lgkmcnt(5)
  v_mfma_f32_16x16x32_bf16 v[188:191], a[32:35], v[108:111], v[188:191]
  ds_read_b128 v[180:183], v10 offset:34816
  ds_read_b128 v[184:187], v10 offset:35840
  v_mfma_f32_16x16x32_bf16 v[196:199], a[36:39], v[108:111], v[196:199]
  v_fmac_f32 v134, v15, v34
  v_fmac_f32 v135, v15, v35
  s_waitcnt lgkmcnt(6)
  v_mfma_f32_16x16x32_bf16 v[192:195], a[32:35], v[112:115], v[192:195]
  v_pk_mul_f32 v[124:125], v[124:125], v[236:237]
  v_mfma_f32_16x16x32_bf16 v[200:203], a[36:39], v[112:115], v[200:203]
  v_pk_mul_f32 v[126:127], v[126:127], v[238:239]
  s_waitcnt lgkmcnt(5)
  v_mfma_f32_16x16x32_bf16 v[188:191], a[40:43], v[116:119], v[188:191]
  ds_read_b128 v[108:111], v10 offset:36864
  ds_read_b128 v[112:115], v10 offset:37888
  v_mfma_f32_16x16x32_bf16 v[196:199], a[44:47], v[116:119], v[196:199]
  v_pk_mul_f32 v[128:129], v[128:129], v[236:237]
  s_waitcnt lgkmcnt(6)
  v_mfma_f32_16x16x32_bf16 v[192:195], a[40:43], v[120:123], v[192:195]
  v_pk_mul_f32 v[130:131], v[130:131], v[238:239]
  v_mfma_f32_16x16x32_bf16 v[200:203], a[44:47], v[120:123], v[200:203]
  v_pk_mul_f32 v[132:133], v[132:133], v[240:241]
  s_waitcnt lgkmcnt(5)
  v_mfma_f32_16x16x32_bf16 v[188:191], a[48:51], v[172:175], v[188:191]
  ds_read_b128 v[116:119], v10 offset:38912
  ds_read_b128 v[120:123], v10 offset:39936
  v_mfma_f32_16x16x32_bf16 v[196:199], a[52:55], v[172:175], v[196:199]
  v_pk_mul_f32 v[134:135], v[134:135], v[242:243]
  s_waitcnt lgkmcnt(6)
  v_mfma_f32_16x16x32_bf16 v[192:195], a[48:51], v[176:179], v[192:195]
  v_pk_mul_f32 v[136:137], v[136:137], v[240:241]
  v_mfma_f32_16x16x32_bf16 v[200:203], a[52:55], v[176:179], v[200:203]
  v_pk_mul_f32 v[138:139], v[138:139], v[242:243]
  s_waitcnt lgkmcnt(5)
  v_mfma_f32_16x16x32_bf16 v[188:191], a[56:59], v[180:183], v[188:191]
  ds_read_b128 v[172:175], v10 offset:20480
  ds_read_b128 v[176:179], v10 offset:21504
  v_mfma_f32_16x16x32_bf16 v[196:199], a[60:63], v[180:183], v[196:199]
  v_cvt_pk_bf16_f32 v28, v124, v125
  v_cvt_pk_bf16_f32 v29, v126, v127
  s_waitcnt lgkmcnt(6)
  v_mfma_f32_16x16x32_bf16 v[192:195], a[56:59], v[184:187], v[192:195]
  v_cvt_pk_bf16_f32 v30, v132, v133
  v_cvt_pk_bf16_f32 v31, v134, v135
  v_mfma_f32_16x16x32_bf16 v[200:203], a[60:63], v[184:187], v[200:203]
  v_cvt_pk_bf16_f32 v32, v128, v129
  v_cvt_pk_bf16_f32 v33, v130, v131
  s_waitcnt lgkmcnt(5)
  v_mfma_f32_16x16x32_bf16 v[188:191], a[64:67], v[108:111], v[188:191]
  ds_read_b128 v[180:183], v10 offset:22528
  ds_read_b128 v[184:187], v10 offset:23552
  v_mfma_f32_16x16x32_bf16 v[196:199], a[68:71], v[108:111], v[196:199]
  v_cvt_pk_bf16_f32 v34, v136, v137
  v_cvt_pk_bf16_f32 v35, v138, v139
  s_waitcnt lgkmcnt(6)
  v_mfma_f32_16x16x32_bf16 v[192:195], a[64:67], v[112:115], v[192:195]
  v_cvt_pk_bf16_f32 v36, -v124, -v125
  v_cvt_pk_bf16_f32 v37, -v126, -v127
  v_mfma_f32_16x16x32_bf16 v[200:203], a[68:71], v[112:115], v[200:203]
  v_cvt_pk_bf16_f32 v38, -v132, -v133
  v_cvt_pk_bf16_f32 v39, -v134, -v135
  v_mfma_f32_16x16x32_bf16 v[156:159], v[60:63], v[28:31], 0
  v_lshrrev_b32 v44, 4, v0
  v_bfe_u32 v45, v0, 2, 2
  v_mfma_f32_16x16x32_bf16 v[160:163], v[60:63], v[32:35], 0
  v_lshl_add_u32 v44, v44, 2, v45
  v_lshlrev_b32 v44, 6, v44
  v_mfma_f32_16x16x32_bf16 v[164:167], v[64:67], v[28:31], 0
  v_and_b32 v45, 3, v0
  v_lshl_add_u32 v44, v45, 3, v44
  v_mfma_f32_16x16x32_bf16 v[168:171], v[64:67], v[32:35], 0
  s_lshl_b32 s5, s60, 11
  s_add_u32 s5, s5, 155648
  v_mfma_f32_16x16x32_bf16 v[156:159], v[68:71], v[32:35], v[156:159]
  v_add_u32 v44, s5, v44
  s_waitcnt vmcnt(14)
  v_mfma_f32_16x16x32_bf16 v[160:163], v[68:71], v[36:39], v[160:163]
  ds_read_b64_tr_b16 v[84:85], v44 offset:0
  ds_read_b64_tr_b16 v[86:87], v44 offset:1024
  v_mfma_f32_16x16x32_bf16 v[164:167], v[72:75], v[32:35], v[164:167]
  ds_read_b64_tr_b16 v[88:89], v44 offset:32
  ds_read_b64_tr_b16 v[90:91], v44 offset:1056
  v_mfma_f32_16x16x32_bf16 v[168:171], v[72:75], v[36:39], v[168:171]
  s_mul_i32 s5, s75, 40
  s_lshl_b32 s6, s76, 3
  s_waitcnt lgkmcnt(9)
  v_mfma_f32_16x16x32_bf16 v[188:191], a[72:75], v[116:119], v[188:191]
  ds_read_b128 v[108:111], v10 offset:24576
  ds_read_b128 v[112:115], v10 offset:25600
  v_mfma_f32_16x16x32_bf16 v[196:199], a[76:79], v[116:119], v[196:199]
  s_add_u32 s5, s5, s6
  s_lshl_b32 s6, s60, 1
  s_waitcnt lgkmcnt(10)
  v_mfma_f32_16x16x32_bf16 v[192:195], a[72:75], v[120:123], v[192:195]
  s_add_u32 s5, s5, s6
  s_lshl_b32 s5, s5, 10
  v_mfma_f32_16x16x32_bf16 v[200:203], a[76:79], v[120:123], v[200:203]
  s_add_u32 s5, s5, 12582912
  s_waitcnt lgkmcnt(9)
  v_mfma_f32_16x16x32_bf16 v[204:207], a[80:83], v[172:175], 0
  ds_read_b128 v[116:119], v10 offset:26624
  ds_read_b128 v[120:123], v10 offset:27648
  v_mfma_f32_16x16x32_bf16 v[212:215], a[84:87], v[172:175], 0
  s_cmp_lt_u32 s2, 240
  s_cselect_b32 s5, s5, 2147483392
  s_waitcnt lgkmcnt(10)
  v_mfma_f32_16x16x32_bf16 v[208:211], a[80:83], v[176:179], 0
  s_waitcnt lgkmcnt(6)
  buffer_store_dwordx4 v[84:87], v10, s[44:47], s5 offen offset:0 sc1
  v_mfma_f32_16x16x32_bf16 v[216:219], a[84:87], v[176:179], 0
  s_waitcnt lgkmcnt(4)
  buffer_store_dwordx4 v[88:91], v10, s[44:47], s5 offen offset:1024 sc1
  v_mfma_f32_16x16x32_bf16 v[204:207], a[88:91], v[180:183], v[204:207]
  ds_read_b128 v[172:175], v10 offset:28672
  ds_read_b128 v[176:179], v10 offset:29696
  v_mfma_f32_16x16x32_bf16 v[212:215], a[92:95], v[180:183], v[212:215]
  v_cvt_pk_bf16_f32 v40, v156, v160
  v_cvt_pk_bf16_f32 v41, v157, v161
  v_mfma_f32_16x16x32_bf16 v[208:211], a[88:91], v[184:187], v[208:211]
  v_cvt_pk_bf16_f32 v42, v158, v162
  v_cvt_pk_bf16_f32 v43, v159, v163
  v_mfma_f32_16x16x32_bf16 v[216:219], a[92:95], v[184:187], v[216:219]
  ds_write_b128 v8, v[40:43] offset:0
  s_waitcnt lgkmcnt(6)
  v_mfma_f32_16x16x32_bf16 v[204:207], a[96:99], v[108:111], v[204:207]
  ds_read_b128 v[180:183], v10 offset:30720
  ds_read_b128 v[184:187], v10 offset:31744
  v_mfma_f32_16x16x32_bf16 v[212:215], a[100:103], v[108:111], v[212:215]
  v_cvt_pk_bf16_f32 v48, v164, v168
  v_cvt_pk_bf16_f32 v49, v165, v169
  s_waitcnt lgkmcnt(7)
  v_mfma_f32_16x16x32_bf16 v[208:211], a[96:99], v[112:115], v[208:211]
  v_cvt_pk_bf16_f32 v50, v166, v170
  v_cvt_pk_bf16_f32 v51, v167, v171
  v_mfma_f32_16x16x32_bf16 v[216:219], a[100:103], v[112:115], v[216:219]
  ds_write_b128 v8, v[48:51] offset:1024
  s_waitcnt lgkmcnt(7)
  v_mfma_f32_16x16x32_bf16 v[204:207], a[104:107], v[116:119], v[204:207]
  ds_read_b128 v[108:111], v10 offset:32768
  ds_read_b128 v[112:115], v10 offset:33792
  v_mfma_f32_16x16x32_bf16 v[212:215], a[108:111], v[116:119], v[212:215]
  v_add_u32 v8, 2048, v8
  s_waitcnt lgkmcnt(8)
  v_mfma_f32_16x16x32_bf16 v[208:211], a[104:107], v[120:123], v[208:211]
  v_mfma_f32_16x16x32_bf16 v[216:219], a[108:111], v[120:123], v[216:219]
  s_waitcnt lgkmcnt(7)
  v_mfma_f32_16x16x32_bf16 v[204:207], a[112:115], v[172:175], v[204:207]
  s_waitcnt lgkmcnt(0)
  v_mfma_f32_16x16x32_bf16 v[212:215], a[116:119], v[172:175], v[212:215]
  s_barrier
  v_mfma_f32_16x16x32_bf16 v[208:211], a[112:115], v[176:179], v[208:211]
  ds_read_b128 v[116:119], v10 offset:34816
  ds_read_b128 v[120:123], v10 offset:35840
  v_mfma_f32_16x16x32_bf16 v[216:219], a[116:119], v[176:179], v[216:219]
  v_mfma_f32_16x16x32_bf16 v[204:207], a[120:123], v[180:183], v[204:207]
  ds_read_b128 v[172:175], v10 offset:36864
  ds_read_b128 v[176:179], v10 offset:37888
  v_mfma_f32_16x16x32_bf16 v[212:215], a[124:127], v[180:183], v[212:215]
  ds_read2st64_b32 v[76:77], v23 offset0:0 offset1:48
  ds_read2st64_b32 v[78:79], v23 offset0:96 offset1:144
  v_mfma_f32_16x16x32_bf16 v[208:211], a[120:123], v[184:187], v[208:211]
  ds_read2st64_b32 v[80:81], v23 offset0:1 offset1:49
  ds_read2st64_b32 v[82:83], v23 offset0:97 offset1:145
  v_mfma_f32_16x16x32_bf16 v[216:219], a[124:127], v[184:187], v[216:219]
  s_add_u32 s17, s14, 344064
  v_mfma_f32_16x16x32_bf16 v[204:207], a[128:131], v[108:111], v[204:207]
  ds_read_b128 v[180:183], v10 offset:38912
  ds_read_b128 v[184:187], v10 offset:39936
  v_mfma_f32_16x16x32_bf16 v[212:215], a[132:135], v[108:111], v[212:215]
  v_mfma_f32_16x16x32_bf16 v[208:211], a[128:131], v[112:115], v[208:211]
  v_mfma_f32_16x16x32_bf16 v[216:219], a[132:135], v[112:115], v[216:219]
  s_waitcnt lgkmcnt(9)
  v_mfma_f32_16x16x32_bf16 v[204:207], a[136:139], v[116:119], v[204:207]
  s_waitcnt lgkmcnt(4)
  buffer_store_dwordx4 v[76:79], v9, s[44:47], s14 offen sc1
  v_mfma_f32_16x16x32_bf16 v[212:215], a[140:143], v[116:119], v[212:215]
  s_waitcnt lgkmcnt(2)
  buffer_store_dwordx4 v[80:83], v9, s[44:47], s17 offen sc1
  v_mfma_f32_16x16x32_bf16 v[208:211], a[136:139], v[120:123], v[208:211]
  v_add_u32 v23, 2048, v23
  s_mov_b32 s14, s15
  v_mfma_f32_16x16x32_bf16 v[216:219], a[140:143], v[120:123], v[216:219]
  v_mfma_f32_16x16x32_bf16 v[204:207], a[144:147], v[172:175], v[204:207]
  v_mfma_f32_16x16x32_bf16 v[212:215], a[148:151], v[172:175], v[212:215]
  v_mfma_f32_16x16x32_bf16 v[208:211], a[144:147], v[176:179], v[208:211]
  v_mfma_f32_16x16x32_bf16 v[216:219], a[148:151], v[176:179], v[216:219]
  s_waitcnt lgkmcnt(1)
  v_mfma_f32_16x16x32_bf16 v[204:207], a[152:155], v[180:183], v[204:207]
  v_mfma_f32_16x16x32_bf16 v[212:215], a[156:159], v[180:183], v[212:215]
  s_waitcnt lgkmcnt(0)
  v_mfma_f32_16x16x32_bf16 v[208:211], a[152:155], v[184:187], v[208:211]
  v_mfma_f32_16x16x32_bf16 v[216:219], a[156:159], v[184:187], v[216:219]
  s_nop 3
  v_pk_fma_f32 v[188:189], v[204:205], v[14:15], v[188:189] op_sel_hi:[1,0,1]
  v_pk_fma_f32 v[190:191], v[206:207], v[14:15], v[190:191] op_sel_hi:[1,0,1]
  s_nop 0
  v_pk_fma_f32 v[192:193], v[208:209], v[14:15], v[192:193] op_sel_hi:[1,0,1]
  v_pk_fma_f32 v[194:195], v[210:211], v[14:15], v[194:195] op_sel_hi:[1,0,1]
  v_pk_fma_f32 v[196:197], v[212:213], v[14:15], v[196:197] op_sel_hi:[1,0,1]
  v_pk_fma_f32 v[198:199], v[214:215], v[14:15], v[198:199] op_sel_hi:[1,0,1]
  v_pk_fma_f32 v[200:201], v[216:217], v[14:15], v[200:201] op_sel_hi:[1,0,1]
  v_pk_fma_f32 v[202:203], v[218:219], v[14:15], v[202:203] op_sel_hi:[1,0,1]
  v_pk_mul_f32 v[188:189], v[188:189], v[236:237]
  v_pk_mul_f32 v[190:191], v[190:191], v[238:239]
  v_pk_mul_f32 v[192:193], v[192:193], v[236:237]
  v_pk_mul_f32 v[194:195], v[194:195], v[238:239]
  v_pk_mul_f32 v[196:197], v[196:197], v[240:241]
  v_pk_mul_f32 v[198:199], v[198:199], v[242:243]
  v_pk_mul_f32 v[200:201], v[200:201], v[240:241]
  v_pk_mul_f32 v[202:203], v[202:203], v[242:243]
  v_cvt_pk_bf16_f32 v28, v188, v189
  v_cvt_pk_bf16_f32 v29, v190, v191
  v_cvt_pk_bf16_f32 v30, v196, v197
  v_cvt_pk_bf16_f32 v31, v198, v199
  v_cvt_pk_bf16_f32 v32, v192, v193
  v_cvt_pk_bf16_f32 v33, v194, v195
  v_cvt_pk_bf16_f32 v34, v200, v201
  v_cvt_pk_bf16_f32 v35, v202, v203
  v_cvt_pk_bf16_f32 v36, -v188, -v189
  v_cvt_pk_bf16_f32 v37, -v190, -v191
  v_cvt_pk_bf16_f32 v38, -v196, -v197
  v_cvt_pk_bf16_f32 v39, -v198, -v199
  v_mfma_f32_16x16x32_bf16 v[156:159], v[60:63], v[28:31], 0
  v_mfma_f32_16x16x32_bf16 v[160:163], v[60:63], v[32:35], 0
  v_mfma_f32_16x16x32_bf16 v[164:167], v[64:67], v[28:31], 0
  v_mfma_f32_16x16x32_bf16 v[168:171], v[64:67], v[32:35], 0
  v_mfma_f32_16x16x32_bf16 v[156:159], v[68:71], v[32:35], v[156:159]
  v_mfma_f32_16x16x32_bf16 v[160:163], v[68:71], v[36:39], v[160:163]
  v_mfma_f32_16x16x32_bf16 v[164:167], v[72:75], v[32:35], v[164:167]
  v_mfma_f32_16x16x32_bf16 v[168:171], v[72:75], v[36:39], v[168:171]
L_nou1:
  s_add_u32 m0, s71, 40960
  s_nop 0
  buffer_load_dwordx4 v11, s[32:35], s69 offen lds
  buffer_load_dwordx4 v11, s[36:39], s69 offen offset:1024 lds
  s_add_u32 s69, s69, 98304
  s_cmp_eq_u32 s69, 1966080
  s_cselect_b32 s69, 0, s69
  s_waitcnt vmcnt(12)
  v_cmp_le_u32 s[0:1], 1, v59
  s_nop 0
  s_cmp_eq_u64 s[0:1], exec
  s_cbranch_scc1 L_ok0
  s_mov_b32 s78, 65536
L_spin0:
  s_sleep 4
  buffer_load_dword v59, v58, s[8:11], 0 offen  sc1
  s_waitcnt vmcnt(0)
  v_cmp_le_u32 s[0:1], 1, v59
  s_nop 0
  s_cmp_eq_u64 s[0:1], exec
  s_cbranch_scc1 L_ok0
  s_sub_u32 s78, s78, 1
  s_cmp_lg_u32 s78, 0
  s_cbranch_scc1 L_spin0
L_ok0:
  s_waitcnt vmcnt(10)
  s_barrier
  ds_read_b64_tr_b16 v[188:189], v220 offset:0
  ds_read_b64_tr_b16 v[190:191], v220 offset:2048
  ds_read_b64_tr_b16 v[192:193], v221 offset:0
  ds_read_b64_tr_b16 v[194:195], v221 offset:2048
  ds_read_b64_tr_b16 v[196:197], v222 offset:0
  ds_read_b64_tr_b16 v[198:199], v222 offset:2048
  ds_read_b64_tr_b16 v[200:201], v223 offset:0
  ds_read_b64_tr_b16 v[202:203], v223 offset:2048
  ds_read_b64_tr_b16 v[204:205], v224 offset:0
  ds_read_b64_tr_b16 v[206:207], v224 offset:2048
  ds_read_b64_tr_b16 v[208:209], v225 offset:0
  ds_read_b64_tr_b16 v[210:211], v225 offset:2048
  ds_read_b64_tr_b16 v[212:213], v226 offset:0
  ds_read_b64_tr_b16 v[214:215], v226 offset:2048
  ds_read_b64_tr_b16 v[216:217], v227 offset:0
  ds_read_b64_tr_b16 v[218:219], v227 offset:2048
  v_cvt_pk_bf16_f32 v40, v156, v160
  v_cvt_pk_bf16_f32 v41, v157, v161
  v_cvt_pk_bf16_f32 v42, v158, v162
  v_cvt_pk_bf16_f32 v43, v159, v163
  ds_write_b128 v8, v[40:43] offset:0
  v_cvt_pk_bf16_f32 v48, v164, v168
  v_cvt_pk_bf16_f32 v49, v165, v169
  v_cvt_pk_bf16_f32 v50, v166, v170
  v_cvt_pk_bf16_f32 v51, v167, v171
  ds_write_b128 v8, v[48:51] offset:1024
  s_waitcnt lgkmcnt(15)
  v_mfma_f32_16x16x32_bf16 v[124:127], v[188:191], a[0:3], 0
  v_and_b32 v28, 15, v0
  v_lshrrev_b32 v29, 4, v0
  v_mfma_f32_16x16x32_bf16 v[128:131], v[188:191], a[4:7], 0
  s_lshl_b32 s5, s24, 10
  s_lshl_b32 s6, s79, 1
  v_mfma_f32_16x16x32_bf16 v[228:231], v[188:191], v[244:247], 0
  ds_read_b64_tr_b16 v[188:189], v220 offset:8192
  ds_read_b64_tr_b16 v[190:191], v220 offset:10240
  s_waitcnt lgkmcnt(15)
  v_mfma_f32_16x16x32_bf16 v[132:135], v[192:195], a[0:3], 0
  s_add_u32 s5, s5, s6
  s_add_u32 s5, s5, s25
  v_mfma_f32_16x16x32_bf16 v[136:139], v[192:195], a[4:7], 0
  s_mul_i32 s5, s5, 1280
  s_mul_i32 s6, s80, 160
  v_mfma_f32_16x16x32_bf16 v[232:235], v[192:195], v[244:247], 0
  ds_read_b64_tr_b16 v[192:193], v221 offset:8192
  ds_read_b64_tr_b16 v[194:195], v221 offset:10240
  s_waitcnt lgkmcnt(15)
  v_mfma_f32_16x16x32_bf16 v[140:143], v[196:199], a[0:3], 0
  s_add_u32 s64, s5, s6
  s_mul_i32 s6, s60, 3072
  v_mfma_f32_16x16x32_bf16 v[144:147], v[196:199], a[4:7], 0
  ds_read_b64_tr_b16 v[196:197], v222 offset:8192
  ds_read_b64_tr_b16 v[198:199], v222 offset:10240
  s_waitcnt lgkmcnt(15)
  v_mfma_f32_16x16x32_bf16 v[148:151], v[200:203], a[0:3], 0
  s_waitcnt lgkmcnt(8)
  s_add_u32 s72, s6, 0
  v_mfma_f32_16x16x32_bf16 v[152:155], v[200:203], a[4:7], 0
  ds_read_b64_tr_b16 v[200:201], v223 offset:8192
  ds_read_b64_tr_b16 v[202:203], v223 offset:10240
  v_mfma_f32_16x16x32_bf16 v[156:159], v[204:207], a[0:3], 0
  v_add_u32 v30, 0, v0
  v_mul_u32_u24 v31, 6554, v30
  v_mfma_f32_16x16x32_bf16 v[160:163], v[204:207], a[4:7], 0
  ds_read_b64_tr_b16 v[204:205], v224 offset:8192
  ds_read_b64_tr_b16 v[206:207], v224 offset:10240
  v_mfma_f32_16x16x32_bf16 v[164:167], v[208:211], a[0:3], 0
  v_lshrrev_b32 v31, 16, v31
  v_mul_u32_u24 v31, 81760, v31
  v_mfma_f32_16x16x32_bf16 v[168:171], v[208:211], a[4:7], 0
  ds_read_b64_tr_b16 v[208:209], v225 offset:8192
  ds_read_b64_tr_b16 v[210:211], v225 offset:10240
  v_mfma_f32_16x16x32_bf16 v[172:175], v[212:215], a[0:3], 0
  v_lshl_add_u32 v31, v30, 4, v31
  v_add_u32 v33, s64, v31
  v_mfma_f32_16x16x32_bf16 v[176:179], v[212:215], a[4:7], 0
  ds_read_b64_tr_b16 v[212:213], v226 offset:8192
  ds_read_b64_tr_b16 v[214:215], v226 offset:10240
  v_mfma_f32_16x16x32_bf16 v[180:183], v[216:219], a[0:3], 0
  s_waitcnt lgkmcnt(6)
  v_add_u32 v30, 64, v0
  v_mfma_f32_16x16x32_bf16 v[184:187], v[216:219], a[4:7], 0
  ds_read_b64_tr_b16 v[216:217], v227 offset:8192
  ds_read_b64_tr_b16 v[218:219], v227 offset:10240
  v_mfma_f32_16x16x32_bf16 v[124:127], v[188:191], a[8:11], v[124:127]
  s_waitcnt vmcnt(6)
  v_mul_u32_u24 v31, 6554, v30
  v_mfma_f32_16x16x32_bf16 v[128:131], v[188:191], a[12:15], v[128:131]
  s_barrier
  v_mfma_f32_16x16x32_bf16 v[228:231], v[188:191], v[244:247], v[228:231]
  ds_read_b64_tr_b16 v[188:189], v220 offset:16384
  ds_read_b64_tr_b16 v[190:191], v220 offset:18432
  v_mfma_f32_16x16x32_bf16 v[132:135], v[192:195], a[8:11], v[132:135]
  s_add_u32 m0, s71, 49152
  v_lshrrev_b32 v31, 16, v31
  v_mfma_f32_16x16x32_bf16 v[136:139], v[192:195], a[12:15], v[136:139]
  buffer_load_dwordx4 v11, s[32:35], s69 offen lds
  v_mfma_f32_16x16x32_bf16 v[232:235], v[192:195], v[244:247], v[232:235]
  ds_read_b64_tr_b16 v[192:193], v221 offset:16384
  ds_read_b64_tr_b16 v[194:195], v221 offset:18432
  v_mfma_f32_16x16x32_bf16 v[140:143], v[196:199], a[8:11], v[140:143]
  buffer_load_dwordx4 v11, s[36:39], s69 offen offset:1024 lds
  v_mfma_f32_16x16x32_bf16 v[144:147], v[196:199], a[12:15], v[144:147]
  ds_read_b64_tr_b16 v[196:197], v222 offset:16384
  ds_read_b64_tr_b16 v[198:199], v222 offset:18432
  v_mfma_f32_16x16x32_bf16 v[148:151], v[200:203], a[8:11], v[148:151]
  s_waitcnt lgkmcnt(6)
  v_mul_u32_u24 v31, 81760, v31
  v_mfma_f32_16x16x32_bf16 v[152:155], v[200:203], a[12:15], v[152:155]
  ds_read_b64_tr_b16 v[200:201], v223 offset:16384
  ds_read_b64_tr_b16 v[202:203], v223 offset:18432
  v_mfma_f32_16x16x32_bf16 v[156:159], v[204:207], a[8:11], v[156:159]
  ds_read2st64_b32 v[76:77], v23 offset0:0 offset1:48
  ds_read2st64_b32 v[78:79], v23 offset0:96 offset1:144
  v_mfma_f32_16x16x32_bf16 v[160:163], v[204:207], a[12:15], v[160:163]
  ds_read_b64_tr_b16 v[204:205], v224 offset:16384
  ds_read_b64_tr_b16 v[206:207], v224 offset:18432
  v_mfma_f32_16x16x32_bf16 v[164:167], v[208:211], a[8:11], v[164:167]
  ds_read2st64_b32 v[80:81], v23 offset0:1 offset1:49
  ds_read2st64_b32 v[82:83], v23 offset0:97 offset1:145
  v_mfma_f32_16x16x32_bf16 v[168:171], v[208:211], a[12:15], v[168:171]
  ds_read_b64_tr_b16 v[208:209], v225 offset:16384
  ds_read_b64_tr_b16 v[210:211], v225 offset:18432
  v_mfma_f32_16x16x32_bf16 v[172:175], v[212:215], a[8:11], v[172:175]
  s_add_u32 s17, s14, 344064
  v_lshl_add_u32 v31, v30, 4, v31
  v_mfma_f32_16x16x32_bf16 v[176:179], v[212:215], a[12:15], v[176:179]
  ds_read_b64_tr_b16 v[212:213], v226 offset:16384
  ds_read_b64_tr_b16 v[214:215], v226 offset:18432
  v_mfma_f32_16x16x32_bf16 v[180:183], v[216:219], a[8:11], v[180:183]
  s_waitcnt lgkmcnt(10)
  s_add_u32 s69, s69, 98304
  v_mfma_f32_16x16x32_bf16 v[184:187], v[216:219], a[12:15], v[184:187]
  ds_read_b64_tr_b16 v[216:217], v227 offset:16384
  ds_read_b64_tr_b16 v[218:219], v227 offset:18432
  v_mfma_f32_16x16x32_bf16 v[124:127], v[188:191], a[16:19], v[124:127]
  s_cmp_eq_u32 s69, 1966080
  s_cselect_b32 s69, 0, s69
  v_mfma_f32_16x16x32_bf16 v[128:131], v[188:191], a[20:23], v[128:131]
  s_waitcnt lgkmcnt(10)
  buffer_store_dwordx4 v[76:79], v9, s[44:47], s14 offen sc1
  v_mfma_f32_16x16x32_bf16 v[228:231], v[188:191], v[244:247], v[228:231]
  ds_read_b64_tr_b16 v[188:189], v220 offset:24576
  ds_read_b64_tr_b16 v[190:191], v220 offset:26624
  v_mfma_f32_16x16x32_bf16 v[132:135], v[192:195], a[16:19], v[132:135]
  s_add_u32 m0, s71, 57344
  v_add_u32 v34, s64, v31
  v_mfma_f32_16x16x32_bf16 v[136:139], v[192:195], a[20:23], v[136:139]
  buffer_load_dwordx4 v11, s[32:35], s69 offen lds
  v_mfma_f32_16x16x32_bf16 v[232:235], v[192:195], v[244:247], v[232:235]
  ds_read_b64_tr_b16 v[192:193], v221 offset:24576
  ds_read_b64_tr_b16 v[194:195], v221 offset:26624
  v_mfma_f32_16x16x32_bf16 v[140:143], v[196:199], a[16:19], v[140:143]
  buffer_load_dwordx4 v11, s[36:39], s69 offen offset:1024 lds
  v_mfma_f32_16x16x32_bf16 v[144:147], v[196:199], a[20:23], v[144:147]
  ds_read_b64_tr_b16 v[196:197], v222 offset:24576
  ds_read_b64_tr_b16 v[198:199], v222 offset:26624
  v_mfma_f32_16x16x32_bf16 v[148:151], v[200:203], a[16:19], v[148:151]
  s_waitcnt lgkmcnt(6)
  v_add_u32 v30, 128, v0
  v_mfma_f32_16x16x32_bf16 v[152:155], v[200:203], a[20:23], v[152:155]
  ds_read_b64_tr_b16 v[200:201], v223 offset:24576
  ds_read_b64_tr_b16 v[202:203], v223 offset:26624
  v_mfma_f32_16x16x32_bf16 v[156:159], v[204:207], a[16:19], v[156:159]
  v_mul_u32_u24 v31, 6554, v30
  v_lshrrev_b32 v31, 16, v31
  v_mfma_f32_16x16x32_bf16 v[160:163], v[204:207], a[20:23], v[160:163]
  ds_read_b64_tr_b16 v[204:205], v224 offset:24576
  ds_read_b64_tr_b16 v[206:207], v224 offset:26624
  v_mfma_f32_16x16x32_bf16 v[164:167], v[208:211], a[16:19], v[164:167]
  buffer_store_dwordx4 v[80:83], v9, s[44:47], s17 offen sc1
  v_mfma_f32_16x16x32_bf16 v[168:171], v[208:211], a[20:23], v[168:171]
  ds_read_b64_tr_b16 v[208:209], v225 offset:24576
  ds_read_b64_tr_b16 v[210:211], v225 offset:26624
  v_mfma_f32_16x16x32_bf16 v[172:175], v[212:215], a[16:19], v[172:175]
  v_mul_u32_u24 v31, 81760, v31
  v_lshl_add_u32 v31, v30, 4, v31
  v_mfma_f32_16x16x32_bf16 v[176:179], v[212:215], a[20:23], v[176:179]
  ds_read_b64_tr_b16 v[212:213], v226 offset:24576
  ds_read_b64_tr_b16 v[214:215], v226 offset:26624
  v_mfma_f32_16x16x32_bf16 v[180:183], v[216:219], a[16:19], v[180:183]
  s_waitcnt lgkmcnt(6)
  s_add_u32 s69, s69, 98304
  v_mfma_f32_16x16x32_bf16 v[184:187], v[216:219], a[20:23], v[184:187]
  ds_read_b64_tr_b16 v[216:217], v227 offset:24576
  ds_read_b64_tr_b16 v[218:219], v227 offset:26624
  v_mfma_f32_16x16x32_bf16 v[124:127], v[188:191], a[24:27], v[124:127]
  s_waitcnt vmcnt(6)
  v_add_u32 v35, s64, v31
  v_mfma_f32_16x16x32_bf16 v[128:131], v[188:191], a[28:31], v[128:131]
  s_barrier
  v_mfma_f32_16x16x32_bf16 v[228:231], v[188:191], v[244:247], v[228:231]
  ds_read_b64_tr_b16 v[188:189], v220 offset:32768
  ds_read_b64_tr_b16 v[190:191], v220 offset:34816
  v_mfma_f32_16x16x32_bf16 v[132:135], v[192:195], a[24:27], v[132:135]
  s_add_u32 m0, s71, 0
  s_cmp_eq_u32 s69, 1966080
  s_cselect_b32 s69, 0, s69
  v_mfma_f32_16x16x32_bf16 v[136:139], v[192:195], a[28:31], v[136:139]
  buffer_load_dwordx4 v11, s[32:35], s69 offen lds
  v_mfma_f32_16x16x32_bf16 v[232:235], v[192:195], v[244:247], v[232:235]
  ds_read_b64_tr_b16 v[192:193], v221 offset:32768
  ds_read_b64_tr_b16 v[194:195], v221 offset:34816
  v_mfma_f32_16x16x32_bf16 v[140:143], v[196:199], a[24:27], v[140:143]
  buffer_load_dwordx4 v11, s[36:39], s69 offen offset:1024 lds
  v_mfma_f32_16x16x32_bf16 v[144:147], v[196:199], a[28:31], v[144:147]
  ds_read_b64_tr_b16 v[196:197], v222 offset:32768
  ds_read_b64_tr_b16 v[198:199], v222 offset:34816
  v_mfma_f32_16x16x32_bf16 v[148:151], v[200:203], a[24:27], v[148:151]
  s_waitcnt lgkmcnt(6)
  v_cmp_gt_u32 vcc, 32, v0
  v_mfma_f32_16x16x32_bf16 v[152:155], v[200:203], a[28:31], v[152:155]
  ds_read_b64_tr_b16 v[200:201], v223 offset:32768
  ds_read_b64_tr_b16 v[202:203], v223 offset:34816
  v_mfma_f32_16x16x32_bf16 v[156:159], v[204:207], a[24:27], v[156:159]
  s_nop 0
  s_nop 0
  v_mfma_f32_16x16x32_bf16 v[160:163], v[204:207], a[28:31], v[160:163]
  ds_read_b64_tr_b16 v[204:205], v224 offset:32768
  ds_read_b64_tr_b16 v[206:207], v224 offset:34816
  v_mfma_f32_16x16x32_bf16 v[164:167], v[208:211], a[24:27], v[164:167]
  v_cndmask_b32 v35, v254, v35, vcc
  s_lshl_b32 s5, s83, 1
  v_mfma_f32_16x16x32_bf16 v[168:171], v[208:211], a[28:31], v[168:171]
  ds_read_b64_tr_b16 v[208:209], v225 offset:32768
  ds_read_b64_tr_b16 v[210:211], v225 offset:34816
  v_mfma_f32_16x16x32_bf16 v[172:175], v[212:215], a[24:27], v[172:175]
  s_and_b32 s6, s5, 15
  s_add_u32 s6, s6, s26
  v_mfma_f32_16x16x32_bf16 v[176:179], v[212:215], a[28:31], v[176:179]
  ds_read_b64_tr_b16 v[212:213], v226 offset:32768
  ds_read_b64_tr_b16 v[214:215], v226 offset:34816
  v_mfma_f32_16x16x32_bf16 v[180:183], v[216:219], a[24:27], v[180:183]
  s_waitcnt lgkmcnt(6)
  s_add_u32 s69, s69, 98304
  v_mfma_f32_16x16x32_bf16 v[184:187], v[216:219], a[28:31], v[184:187]
  ds_read_b64_tr_b16 v[216:217], v227 offset:32768
  ds_read_b64_tr_b16 v[218:219], v227 offset:34816
  v_mfma_f32_16x16x32_bf16 v[124:127], v[188:191], a[32:35], v[124:127]
  s_cmp_eq_u32 s69, 1966080
  s_cselect_b32 s69, 0, s69
  v_mfma_f32_16x16x32_bf16 v[128:131], v[188:191], a[36:39], v[128:131]
  v_mul_u32_u24 v30, 192, v29
  v_lshl_add_u32 v30, v28, 1, v30
  v_mfma_f32_16x16x32_bf16 v[228:231], v[188:191], v[244:247], v[228:231]
  ds_read_b64_tr_b16 v[188:189], v220 offset:40960
  ds_read_b64_tr_b16 v[190:191], v220 offset:43008
  v_mfma_f32_16x16x32_bf16 v[132:135], v[192:195], a[32:35], v[132:135]
  s_add_u32 m0, s71, 8192
  v_add_u32 v5, s6, v30
  v_mfma_f32_16x16x32_bf16 v[136:139], v[192:195], a[36:39], v[136:139]
  buffer_load_dwordx4 v11, s[32:35], s69 offen lds
  v_mfma_f32_16x16x32_bf16 v[232:235], v[192:195], v[244:247], v[232:235]
  ds_read_b64_tr_b16 v[192:193], v221 offset:40960
  ds_read_b64_tr_b16 v[194:195], v221 offset:43008
  v_mfma_f32_16x16x32_bf16 v[140:143], v[196:199], a[32:35], v[140:143]
  buffer_load_dwordx4 v11, s[36:39], s69 offen offset:1024 lds
  v_mfma_f32_16x16x32_bf16 v[144:147], v[196:199], a[36:39], v[144:147]
  ds_read_b64_tr_b16 v[196:197], v222 offset:40960
  ds_read_b64_tr_b16 v[198:199], v222 offset:43008
  v_mfma_f32_16x16x32_bf16 v[148:151], v[200:203], a[32:35], v[148:151]
  s_waitcnt lgkmcnt(6)
  s_add_u32 m0, s26, 0
  v_mfma_f32_16x16x32_bf16 v[152:155], v[200:203], a[36:39], v[152:155]
  ds_read_b64_tr_b16 v[200:201], v223 offset:40960
  ds_read_b64_tr_b16 v[202:203], v223 offset:43008
  v_mfma_f32_16x16x32_bf16 v[156:159], v[204:207], a[32:35], v[156:159]
  buffer_load_dwordx4 v92, s[52:55], 0 offen lds
  v_mfma_f32_16x16x32_bf16 v[160:163], v[204:207], a[36:39], v[160:163]
  ds_read_b64_tr_b16 v[204:205], v224 offset:40960
  ds_read_b64_tr_b16 v[206:207], v224 offset:43008
  v_mfma_f32_16x16x32_bf16 v[164:167], v[208:211], a[32:35], v[164:167]
  v_add_u32 v3, 16252928, v10
  v_mov_b64 v[108:109], 0
  v_mfma_f32_16x16x32_bf16 v[168:171], v[208:211], a[36:39], v[168:171]
  ds_read_b64_tr_b16 v[208:209], v225 offset:40960
  ds_read_b64_tr_b16 v[210:211], v225 offset:43008
  v_mfma_f32_16x16x32_bf16 v[172:175], v[212:215], a[32:35], v[172:175]
  v_mov_b64 v[60:61], 0
  v_mov_b64 v[110:111], 0
  v_mfma_f32_16x16x32_bf16 v[176:179], v[212:215], a[36:39], v[176:179]
  ds_read_b64_tr_b16 v[212:213], v226 offset:40960
  ds_read_b64_tr_b16 v[214:215], v226 offset:43008
  v_mfma_f32_16x16x32_bf16 v[180:183], v[216:219], a[32:35], v[180:183]
  s_waitcnt lgkmcnt(6)
  s_add_u32 s69, s69, 98304
  v_mfma_f32_16x16x32_bf16 v[184:187], v[216:219], a[36:39], v[184:187]
  ds_read_b64_tr_b16 v[216:217], v227 offset:40960
  ds_read_b64_tr_b16 v[218:219], v227 offset:43008
  v_mfma_f32_16x16x32_bf16 v[124:127], v[188:191], a[40:43], v[124:127]
  s_waitcnt vmcnt(5)
  v_mov_b64 v[62:63], 0
  v_mfma_f32_16x16x32_bf16 v[128:131], v[188:191], a[44:47], v[128:131]
  s_barrier
  v_mfma_f32_16x16x32_bf16 v[228:231], v[188:191], v[244:247], v[228:231]
  ds_read_b64_tr_b16 v[188:189], v220 offset:49152
  ds_read_b64_tr_b16 v[190:191], v220 offset:51200
  v_mfma_f32_16x16x32_bf16 v[132:135], v[192:195], a[40:43], v[132:135]
  s_add_u32 m0, s71, 16384
  s_cmp_eq_u32 s69, 1966080
  s_cselect_b32 s69, 0, s69
  v_mfma_f32_16x16x32_bf16 v[136:139], v[192:195], a[44:47], v[136:139]
  buffer_load_dwordx4 v11, s[32:35], s69 offen lds
  v_mfma_f32_16x16x32_bf16 v[232:235], v[192:195], v[244:247], v[232:235]
  ds_read_b64_tr_b16 v[192:193], v221 offset:49152
  ds_read_b64_tr_b16 v[194:195], v221 offset:51200
  v_mfma_f32_16x16x32_bf16 v[140:143], v[196:199], a[40:43], v[140:143]
  buffer_load_dwordx4 v11, s[36:39], s69 offen offset:1024 lds
  v_mfma_f32_16x16x32_bf16 v[144:147], v[196:199], a[44:47], v[144:147]
  ds_read_b64_tr_b16 v[196:197], v222 offset:49152
  ds_read_b64_tr_b16 v[198:199], v222 offset:51200
  v_mfma_f32_16x16x32_bf16 v[148:151], v[200:203], a[40:43], v[148:151]
  s_waitcnt lgkmcnt(6)
  v_mov_b64 v[112:113], 0
  v_mfma_f32_16x16x32_bf16 v[152:155], v[200:203], a[44:47], v[152:155]
  ds_read_b64_tr_b16 v[200:201], v223 offset:49152
  ds_read_b64_tr_b16 v[202:203], v223 offset:51200
  v_mfma_f32_16x16x32_bf16 v[156:159], v[204:207], a[40:43], v[156:159]
  buffer_store_dword v253, v13, s[44:47], 0 offen sc1
  v_mfma_f32_16x16x32_bf16 v[160:163], v[204:207], a[44:47], v[160:163]
  ds_read_b64_tr_b16 v[204:205], v224 offset:49152
  ds_read_b64_tr_b16 v[206:207], v224 offset:51200
  v_mfma_f32_16x16x32_bf16 v[164:167], v[208:211], a[40:43], v[164:167]
  v_mov_b64 v[64:65], 0
  v_mov_b64 v[114:115], 0
  v_mfma_f32_16x16x32_bf16 v[168:171], v[208:211], a[44:47], v[168:171]
  ds_read_b64_tr_b16 v[208:209], v225 offset:49152
  ds_read_b64_tr_b16 v[210:211], v225 offset:51200
  v_mfma_f32_16x16x32_bf16 v[172:175], v[212:215], a[40:43], v[172:175]
  v_mov_b64 v[66:67], 0
  v_mov_b64 v[116:117], 0
  v_mfma_f32_16x16x32_bf16 v[176:179], v[212:215], a[44:47], v[176:179]
  ds_read_b64_tr_b16 v[212:213], v226 offset:49152
  ds_read_b64_tr_b16 v[214:215], v226 offset:51200
  v_mfma_f32_16x16x32_bf16 v[180:183], v[216:219], a[40:43], v[180:183]
  s_waitcnt lgkmcnt(6)
  s_add_u32 s69, s69, 98304
  v_mfma_f32_16x16x32_bf16 v[184:187], v[216:219], a[44:47], v[184:187]
  ds_read_b64_tr_b16 v[216:217], v227 offset:49152
  ds_read_b64_tr_b16 v[218:219], v227 offset:51200
  v_mfma_f32_16x16x32_bf16 v[124:127], v[188:191], a[48:51], v[124:127]
  s_cmp_eq_u32 s69, 1966080
  s_cselect_b32 s69, 0, s69
  v_mfma_f32_16x16x32_bf16 v[128:131], v[188:191], a[52:55], v[128:131]
  v_mov_b64 v[68:69], 0
  v_mov_b64 v[118:119], 0
  v_mfma_f32_16x16x32_bf16 v[228:231], v[188:191], v[244:247], v[228:231]
  ds_read_b64_tr_b16 v[188:189], v220 offset:57344
  ds_read_b64_tr_b16 v[190:191], v220 offset:59392
  v_mfma_f32_16x16x32_bf16 v[132:135], v[192:195], a[48:51], v[132:135]
  s_add_u32 m0, s71, 24576
  v_mov_b64 v[70:71], 0
  v_mfma_f32_16x16x32_bf16 v[136:139], v[192:195], a[52:55], v[136:139]
  buffer_load_dwordx4 v11, s[32:35], s69 offen lds
  v_mfma_f32_16x16x32_bf16 v[232:235], v[192:195], v[244:247], v[232:235]
  ds_read_b64_tr_b16 v[192:193], v221 offset:57344
  ds_read_b64_tr_b16 v[194:195], v221 offset:59392
  v_mfma_f32_16x16x32_bf16 v[140:143], v[196:199], a[48:51], v[140:143]
  buffer_load_dwordx4 v11, s[36:39], s69 offen offset:1024 lds
  v_mfma_f32_16x16x32_bf16 v[144:147], v[196:199], a[52:55], v[144:147]
  ds_read_b64_tr_b16 v[196:197], v222 offset:57344
  ds_read_b64_tr_b16 v[198:199], v222 offset:59392
  v_mfma_f32_16x16x32_bf16 v[148:151], v[200:203], a[48:51], v[148:151]
  s_waitcnt lgkmcnt(6)
  s_add_u32 m0, s26, 1024
  v_mfma_f32_16x16x32_bf16 v[152:155], v[200:203], a[52:55], v[152:155]
  ds_read_b64_tr_b16 v[200:201], v223 offset:57344
  ds_read_b64_tr_b16 v[202:203], v223 offset:59392
  v_mfma_f32_16x16x32_bf16 v[156:159], v[204:207], a[48:51], v[156:159]
  buffer_load_dwordx4 v93, s[52:55], 0 offen lds
  v_mfma_f32_16x16x32_bf16 v[160:163], v[204:207], a[52:55], v[160:163]
  ds_read_b64_tr_b16 v[204:205], v224 offset:57344
  ds_read_b64_tr_b16 v[206:207], v224 offset:59392
  v_mfma_f32_16x16x32_bf16 v[164:167], v[208:211], a[48:51], v[164:167]
  v_mov_b64 v[120:121], 0
  v_mov_b64 v[72:73], 0
  v_mfma_f32_16x16x32_bf16 v[168:171], v[208:211], a[52:55], v[168:171]
  ds_read_b64_tr_b16 v[208:209], v225 offset:57344
  ds_read_b64_tr_b16 v[210:211], v225 offset:59392
  v_mfma_f32_16x16x32_bf16 v[172:175], v[212:215], a[48:51], v[172:175]
  v_mov_b64 v[122:123], 0
  v_mov_b64 v[74:75], 0
  v_mfma_f32_16x16x32_bf16 v[176:179], v[212:215], a[52:55], v[176:179]
  ds_read_b64_tr_b16 v[212:213], v226 offset:57344
  ds_read_b64_tr_b16 v[214:215], v226 offset:59392
  v_mfma_f32_16x16x32_bf16 v[180:183], v[216:219], a[48:51], v[180:183]
  s_waitcnt lgkmcnt(6)
  s_add_u32 s69, s69, 98304
  v_mfma_f32_16x16x32_bf16 v[184:187], v[216:219], a[52:55], v[184:187]
  ds_read_b64_tr_b16 v[216:217], v227 offset:57344
  ds_read_b64_tr_b16 v[218:219], v227 offset:59392
  v_mfma_f32_16x16x32_bf16 v[124:127], v[188:191], a[56:59], v[124:127]
  s_waitcnt vmcnt(7)
  s_lshl_b32 s5, s60, 7
  v_mfma_f32_16x16x32_bf16 v[128:131], v[188:191], a[60:63], v[128:131]
  s_barrier
  v_mfma_f32_16x16x32_bf16 v[228:231], v[188:191], v[244:247], v[228:231]
  ds_read_b64_tr_b16 v[188:189], v220 offset:0
  ds_read_b64_tr_b16 v[190:191], v220 offset:2048
  v_mfma_f32_16x16x32_bf16 v[132:135], v[192:195], a[56:59], v[132:135]
  s_add_u32 m0, s71, 32768
  s_cmp_eq_u32 s69, 1966080
  s_cselect_b32 s69, 0, s69
  v_mfma_f32_16x16x32_bf16 v[136:139], v[192:195], a[60:63], v[136:139]
  buffer_load_dwordx4 v11, s[32:35], s69 offen lds
  v_mfma_f32_16x16x32_bf16 v[232:235], v[192:195], v[244:247], v[232:235]
  ds_read_b64_tr_b16 v[192:193], v221 offset:0
  ds_read_b64_tr_b16 v[194:195], v221 offset:2048
  v_mfma_f32_16x16x32_bf16 v[140:143], v[196:199], a[56:59], v[140:143]
  buffer_load_dwordx4 v11, s[36:39], s69 offen offset:1024 lds
  v_mfma_f32_16x16x32_bf16 v[144:147], v[196:199], a[60:63], v[144:147]
  ds_read_b64_tr_b16 v[196:197], v222 offset:0
  ds_read_b64_tr_b16 v[198:199], v222 offset:2048
  v_mfma_f32_16x16x32_bf16 v[148:151], v[200:203], a[56:59], v[148:151]
  s_waitcnt lgkmcnt(6)
  s_add_u32 s5, s5, 155648
  v_mfma_f32_16x16x32_bf16 v[152:155], v[200:203], a[60:63], v[152:155]
  ds_read_b64_tr_b16 v[200:201], v223 offset:0
  ds_read_b64_tr_b16 v[202:203], v223 offset:2048
  v_mfma_f32_16x16x32_bf16 v[156:159], v[204:207], a[56:59], v[156:159]
  v_lshl_add_u32 v30, v29, 4, s5
  v_cmp_eq_u32 vcc, 0, v28
  v_mfma_f32_16x16x32_bf16 v[160:163], v[204:207], a[60:63], v[160:163]
  ds_read_b64_tr_b16 v[204:205], v224 offset:0
  ds_read_b64_tr_b16 v[206:207], v224 offset:2048
  v_mfma_f32_16x16x32_bf16 v[164:167], v[208:211], a[56:59], v[164:167]
  v_add_u32 v31, 157696, v10
  s_nop 0
  v_mfma_f32_16x16x32_bf16 v[168:171], v[208:211], a[60:63], v[168:171]
  ds_read_b64_tr_b16 v[208:209], v225 offset:0
  ds_read_b64_tr_b16 v[210:211], v225 offset:2048
  v_mfma_f32_16x16x32_bf16 v[172:175], v[212:215], a[56:59], v[172:175]
  v_cndmask_b32 v2, v31, v30, vcc
  s_xor_b32 s5, s60, 0
  v_mfma_f32_16x16x32_bf16 v[176:179], v[212:215], a[60:63], v[176:179]
  ds_read_b64_tr_b16 v[212:213], v226 offset:0
  ds_read_b64_tr_b16 v[214:215], v226 offset:2048
  v_mfma_f32_16x16x32_bf16 v[180:183], v[216:219], a[56:59], v[180:183]
  s_waitcnt lgkmcnt(6)
  s_add_u32 s69, s69, 98304
  v_mfma_f32_16x16x32_bf16 v[184:187], v[216:219], a[60:63], v[184:187]
  ds_read_b64_tr_b16 v[216:217], v227 offset:0
  ds_read_b64_tr_b16 v[218:219], v227 offset:2048
  v_mfma_f32_16x16x32_bf16 v[124:127], v[188:191], a[64:67], v[124:127]
  s_cmp_eq_u32 s69, 1966080
  s_cselect_b32 s69, 0, s69
  v_mfma_f32_16x16x32_bf16 v[128:131], v[188:191], a[68:71], v[128:131]
  s_lshl_b32 s5, s5, 7
  s_add_u32 s5, s5, 155648
  v_mfma_f32_16x16x32_bf16 v[228:231], v[188:191], v[244:247], v[228:231]
  ds_read_b64_tr_b16 v[188:189], v220 offset:8192
  ds_read_b64_tr_b16 v[190:191], v220 offset:10240
  v_mfma_f32_16x16x32_bf16 v[132:135], v[192:195], a[64:67], v[132:135]
  s_add_u32 m0, s71, 40960
  v_lshl_add_u32 v236, v29, 4, s5
  v_mfma_f32_16x16x32_bf16 v[136:139], v[192:195], a[68:71], v[136:139]
  buffer_load_dwordx4 v11, s[32:35], s69 offen lds
  v_mfma_f32_16x16x32_bf16 v[232:235], v[192:195], v[244:247], v[232:235]
  ds_read_b64_tr_b16 v[192:193], v221 offset:8192
  ds_read_b64_tr_b16 v[194:195], v221 offset:10240
  v_mfma_f32_16x16x32_bf16 v[140:143], v[196:199], a[64:67], v[140:143]
  buffer_load_dwordx4 v11, s[36:39], s69 offen offset:1024 lds
  v_mfma_f32_16x16x32_bf16 v[144:147], v[196:199], a[68:71], v[144:147]
  ds_read_b64_tr_b16 v[196:197], v222 offset:8192
  ds_read_b64_tr_b16 v[198:199], v222 offset:10240
  v_mfma_f32_16x16x32_bf16 v[148:151], v[200:203], a[64:67], v[148:151]
  s_waitcnt lgkmcnt(6)
  s_add_u32 m0, s26, 2048
  v_mfma_f32_16x16x32_bf16 v[152:155], v[200:203], a[68:71], v[152:155]
  ds_read_b64_tr_b16 v[200:201], v223 offset:8192
  ds_read_b64_tr_b16 v[202:203], v223 offset:10240
  v_mfma_f32_16x16x32_bf16 v[156:159], v[204:207], a[64:67], v[156:159]
  buffer_load_dwordx4 v94, s[52:55], 0 offen lds
  v_mfma_f32_16x16x32_bf16 v[160:163], v[204:207], a[68:71], v[160:163]
  ds_read_b64_tr_b16 v[204:205], v224 offset:8192
  ds_read_b64_tr_b16 v[206:207], v224 offset:10240
  v_mfma_f32_16x16x32_bf16 v[164:167], v[208:211], a[64:67], v[164:167]
  s_xor_b32 s5, s60, 1
  s_lshl_b32 s5, s5, 7
  v_mfma_f32_16x16x32_bf16 v[168:171], v[208:211], a[68:71], v[168:171]
  ds_read_b64_tr_b16 v[208:209], v225 offset:8192
  ds_read_b64_tr_b16 v[210:211], v225 offset:10240
  v_mfma_f32_16x16x32_bf16 v[172:175], v[212:215], a[64:67], v[172:175]
  s_add_u32 s5, s5, 155648
  v_lshl_add_u32 v237, v29, 4, s5
  v_mfma_f32_16x16x32_bf16 v[176:179], v[212:215], a[68:71], v[176:179]
  ds_read_b64_tr_b16 v[212:213], v226 offset:8192
  ds_read_b64_tr_b16 v[214:215], v226 offset:10240
  v_mfma_f32_16x16x32_bf16 v[180:183], v[216:219], a[64:67], v[180:183]
  s_waitcnt lgkmcnt(6)
  s_add_u32 s69, s69, 98304
  v_mfma_f32_16x16x32_bf16 v[184:187], v[216:219], a[68:71], v[184:187]
  ds_read_b64_tr_b16 v[216:217], v227 offset:8192
  ds_read_b64_tr_b16 v[218:219], v227 offset:10240
  v_mfma_f32_16x16x32_bf16 v[124:127], v[188:191], a[72:75], v[124:127]
  s_waitcnt vmcnt(6)
  s_xor_b32 s5, s60, 2
  v_mfma_f32_16x16x32_bf16 v[128:131], v[188:191], a[76:79], v[128:131]
  s_barrier
  v_mfma_f32_16x16x32_bf16 v[228:231], v[188:191], v[244:247], v[228:231]
  ds_read_b64_tr_b16 v[188:189], v220 offset:16384
  ds_read_b64_tr_b16 v[190:191], v220 offset:18432
  v_mfma_f32_16x16x32_bf16 v[132:135], v[192:195], a[72:75], v[132:135]
  s_add_u32 m0, s71, 49152
  s_cmp_eq_u32 s69, 1966080
  s_cselect_b32 s69, 0, s69
  v_mfma_f32_16x16x32_bf16 v[136:139], v[192:195], a[76:79], v[136:139]
  buffer_load_dwordx4 v11, s[32:35], s69 offen lds
  v_mfma_f32_16x16x32_bf16 v[232:235], v[192:195], v[244:247], v[232:235]
  ds_read_b64_tr_b16 v[192:193], v221 offset:16384
  ds_read_b64_tr_b16 v[194:195], v221 offset:18432
  v_mfma_f32_16x16x32_bf16 v[140:143], v[196:199], a[72:75], v[140:143]
  buffer_load_dwordx4 v11, s[36:39], s69 offen offset:1024 lds
  v_mfma_f32_16x16x32_bf16 v[144:147], v[196:199], a[76:79], v[144:147]
  ds_read_b64_tr_b16 v[196:197], v222 offset:16384
  ds_read_b64_tr_b16 v[198:199], v222 offset:18432
  v_mfma_f32_16x16x32_bf16 v[148:151], v[200:203], a[72:75], v[148:151]
  s_waitcnt lgkmcnt(6)
  s_add_u32 m0, s72, 0
  v_mfma_f32_16x16x32_bf16 v[152:155], v[200:203], a[76:79], v[152:155]
  ds_read_b64_tr_b16 v[200:201], v223 offset:16384
  ds_read_b64_tr_b16 v[202:203], v223 offset:18432
  v_mfma_f32_16x16x32_bf16 v[156:159], v[204:207], a[72:75], v[156:159]
  buffer_load_dwordx4 v33, s[28:31], 0 offen lds
  v_mfma_f32_16x16x32_bf16 v[160:163], v[204:207], a[76:79], v[160:163]
  ds_read_b64_tr_b16 v[204:205], v224 offset:16384
  ds_read_b64_tr_b16 v[206:207], v224 offset:18432
  v_mfma_f32_16x16x32_bf16 v[164:167], v[208:211], a[72:75], v[164:167]
  s_lshl_b32 s5, s5, 7
  s_add_u32 s5, s5, 155648
  v_mfma_f32_16x16x32_bf16 v[168:171], v[208:211], a[76:79], v[168:171]
  ds_read_b64_tr_b16 v[208:209], v225 offset:16384
  ds_read_b64_tr_b16 v[210:211], v225 offset:18432
  v_mfma_f32_16x16x32_bf16 v[172:175], v[212:215], a[72:75], v[172:175]
  v_lshl_add_u32 v238, v29, 4, s5
  s_xor_b32 s5, s60, 3
  v_mfma_f32_16x16x32_bf16 v[176:179], v[212:215], a[76:79], v[176:179]
  ds_read_b64_tr_b16 v[212:213], v226 offset:16384
  ds_read_b64_tr_b16 v[214:215], v226 offset:18432
  v_mfma_f32_16x16x32_bf16 v[180:183], v[216:219], a[72:75], v[180:183]
  s_waitcnt lgkmcnt(6)
  s_add_u32 s69, s69, 98304
  v_mfma_f32_16x16x32_bf16 v[184:187], v[216:219], a[76:79], v[184:187]
  ds_read_b64_tr_b16 v[216:217], v227 offset:16384
  ds_read_b64_tr_b16 v[218:219], v227 offset:18432
  v_mfma_f32_16x16x32_bf16 v[124:127], v[188:191], a[80:83], v[124:127]
  s_cmp_eq_u32 s69, 1966080
  s_cselect_b32 s69, 0, s69
  v_mfma_f32_16x16x32_bf16 v[128:131], v[188:191], a[84:87], v[128:131]
  s_lshl_b32 s5, s5, 7
  s_add_u32 s5, s5, 155648
  v_mfma_f32_16x16x32_bf16 v[228:231], v[188:191], v[244:247], v[228:231]
  ds_read_b64_tr_b16 v[188:189], v220 offset:24576
  ds_read_b64_tr_b16 v[190:191], v220 offset:26624
  v_mfma_f32_16x16x32_bf16 v[132:135], v[192:195], a[80:83], v[132:135]
  s_add_u32 m0, s71, 57344
  v_lshl_add_u32 v239, v29, 4, s5
  v_mfma_f32_16x16x32_bf16 v[136:139], v[192:195], a[84:87], v[136:139]
  buffer_load_dwordx4 v11, s[32:35], s69 offen lds
  v_mfma_f32_16x16x32_bf16 v[232:235], v[192:195], v[244:247], v[232:235]
  ds_read_b64_tr_b16 v[192:193], v221 offset:24576
  ds_read_b64_tr_b16 v[194:195], v221 offset:26624
  v_mfma_f32_16x16x32_bf16 v[140:143], v[196:199], a[80:83], v[140:143]
  buffer_load_dwordx4 v11, s[36:39], s69 offen offset:1024 lds
  v_mfma_f32_16x16x32_bf16 v[144:147], v[196:199], a[84:87], v[144:147]
  ds_read_b64_tr_b16 v[196:197], v222 offset:24576
  ds_read_b64_tr_b16 v[198:199], v222 offset:26624
  v_mfma_f32_16x16x32_bf16 v[148:151], v[200:203], a[80:83], v[148:151]
  s_waitcnt lgkmcnt(6)
  s_add_u32 m0, s26, 3072
  v_mfma_f32_16x16x32_bf16 v[152:155], v[200:203], a[84:87], v[152:155]
  ds_read_b64_tr_b16 v[200:201], v223 offset:24576
  ds_read_b64_tr_b16 v[202:203], v223 offset:26624
  v_mfma_f32_16x16x32_bf16 v[156:159], v[204:207], a[80:83], v[156:159]
  buffer_load_dwordx4 v92, s[56:59], 0 offen lds
  v_mfma_f32_16x16x32_bf16 v[160:163], v[204:207], a[84:87], v[160:163]
  ds_read_b64_tr_b16 v[204:205], v224 offset:24576
  ds_read_b64_tr_b16 v[206:207], v224 offset:26624
  v_mfma_f32_16x16x32_bf16 v[164:167], v[208:211], a[80:83], v[164:167]
  s_mul_i32 s5, s83, 21
  s_add_u32 s5, s5, s82
  v_mfma_f32_16x16x32_bf16 v[168:171], v[208:211], a[84:87], v[168:171]
  ds_read_b64_tr_b16 v[208:209], v225 offset:24576
  ds_read_b64_tr_b16 v[210:211], v225 offset:26624
  v_mfma_f32_16x16x32_bf16 v[172:175], v[212:215], a[80:83], v[172:175]
  s_lshl_b32 s5, s5, 12
  s_add_u32 s5, s5, 0
  v_mfma_f32_16x16x32_bf16 v[176:179], v[212:215], a[84:87], v[176:179]
  ds_read_b64_tr_b16 v[212:213], v226 offset:24576
  ds_read_b64_tr_b16 v[214:215], v226 offset:26624
  v_mfma_f32_16x16x32_bf16 v[180:183], v[216:219], a[80:83], v[180:183]
  s_waitcnt lgkmcnt(6)
  s_add_u32 s69, s69, 98304
  v_mfma_f32_16x16x32_bf16 v[184:187], v[216:219], a[84:87], v[184:187]
  ds_read_b64_tr_b16 v[216:217], v227 offset:24576
  ds_read_b64_tr_b16 v[218:219], v227 offset:26624
  v_mfma_f32_16x16x32_bf16 v[124:127], v[188:191], a[88:91], v[124:127]
  s_waitcnt vmcnt(7)
  v_mfma_f32_16x16x32_bf16 v[128:131], v[188:191], a[92:95], v[128:131]
  s_barrier
  v_mfma_f32_16x16x32_bf16 v[228:231], v[188:191], v[244:247], v[228:231]
  ds_read_b64_tr_b16 v[188:189], v220 offset:32768
  ds_read_b64_tr_b16 v[190:191], v220 offset:34816
  v_mfma_f32_16x16x32_bf16 v[132:135], v[192:195], a[88:91], v[132:135]
  s_add_u32 m0, s71, 0
  s_cmp_eq_u32 s69, 1966080
  s_cselect_b32 s69, 0, s69
  v_mfma_f32_16x16x32_bf16 v[136:139], v[192:195], a[92:95], v[136:139]
  buffer_load_dwordx4 v11, s[32:35], s69 offen lds
  v_mfma_f32_16x16x32_bf16 v[232:235], v[192:195], v[244:247], v[232:235]
  ds_read_b64_tr_b16 v[192:193], v221 offset:32768
  ds_read_b64_tr_b16 v[194:195], v221 offset:34816
  v_mfma_f32_16x16x32_bf16 v[140:143], v[196:199], a[88:91], v[140:143]
  buffer_load_dwordx4 v11, s[36:39], s69 offen offset:1024 lds
  v_mfma_f32_16x16x32_bf16 v[144:147], v[196:199], a[92:95], v[144:147]
  ds_read_b64_tr_b16 v[196:197], v222 offset:32768
  ds_read_b64_tr_b16 v[198:199], v222 offset:34816
  v_mfma_f32_16x16x32_bf16 v[148:151], v[200:203], a[88:91], v[148:151]
  s_waitcnt lgkmcnt(6)
  s_add_u32 m0, s72, 1024
  v_mfma_f32_16x16x32_bf16 v[152:155], v[200:203], a[92:95], v[152:155]
  ds_read_b64_tr_b16 v[200:201], v223 offset:32768
  ds_read_b64_tr_b16 v[202:203], v223 offset:34816
  v_mfma_f32_16x16x32_bf16 v[156:159], v[204:207], a[88:91], v[156:159]
  buffer_load_dwordx4 v34, s[28:31], 0 offen lds
  v_mfma_f32_16x16x32_bf16 v[160:163], v[204:207], a[92:95], v[160:163]
  ds_read_b64_tr_b16 v[204:205], v224 offset:32768
  ds_read_b64_tr_b16 v[206:207], v224 offset:34816
  v_mfma_f32_16x16x32_bf16 v[164:167], v[208:211], a[88:91], v[164:167]
  s_cmp_ge_u32 s77, 21
  s_cselect_b32 s68, 2147483392, s5
  v_mfma_f32_16x16x32_bf16 v[168:171], v[208:211], a[92:95], v[168:171]
  ds_read_b64_tr_b16 v[208:209], v225 offset:32768
  ds_read_b64_tr_b16 v[210:211], v225 offset:34816
  v_mfma_f32_16x16x32_bf16 v[172:175], v[212:215], a[88:91], v[172:175]
  v_and_b32 v30, 3, v0
  v_bfe_u32 v31, v0, 2, 1
  v_mfma_f32_16x16x32_bf16 v[176:179], v[212:215], a[92:95], v[176:179]
  ds_read_b64_tr_b16 v[212:213], v226 offset:32768
  ds_read_b64_tr_b16 v[214:215], v226 offset:34816
  v_mfma_f32_16x16x32_bf16 v[180:183], v[216:219], a[88:91], v[180:183]
  s_waitcnt lgkmcnt(6)
  s_add_u32 s69, s69, 98304
  v_mfma_f32_16x16x32_bf16 v[184:187], v[216:219], a[92:95], v[184:187]
  ds_read_b64_tr_b16 v[216:217], v227 offset:32768
  ds_read_b64_tr_b16 v[218:219], v227 offset:34816
  v_mfma_f32_16x16x32_bf16 v[124:127], v[188:191], a[96:99], v[124:127]
  s_cmp_eq_u32 s69, 1966080
  s_cselect_b32 s69, 0, s69
  v_mfma_f32_16x16x32_bf16 v[128:131], v[188:191], a[100:103], v[128:131]
  v_lshl_add_u32 v30, v31, 4, v30
  s_lshl_b32 s5, s79, 5
  v_mfma_f32_16x16x32_bf16 v[228:231], v[188:191], v[244:247], v[228:231]
  ds_read_b64_tr_b16 v[188:189], v220 offset:40960
  ds_read_b64_tr_b16 v[190:191], v220 offset:43008
  v_mfma_f32_16x16x32_bf16 v[132:135], v[192:195], a[96:99], v[132:135]
  s_add_u32 m0, s71, 8192
  s_lshl_b32 s6, s60, 2
  v_mfma_f32_16x16x32_bf16 v[136:139], v[192:195], a[100:103], v[136:139]
  buffer_load_dwordx4 v11, s[32:35], s69 offen lds
  v_mfma_f32_16x16x32_bf16 v[232:235], v[192:195], v[244:247], v[232:235]
  ds_read_b64_tr_b16 v[192:193], v221 offset:40960
  ds_read_b64_tr_b16 v[194:195], v221 offset:43008
  v_mfma_f32_16x16x32_bf16 v[140:143], v[196:199], a[96:99], v[140:143]
  buffer_load_dwordx4 v11, s[36:39], s69 offen offset:1024 lds
  v_mfma_f32_16x16x32_bf16 v[144:147], v[196:199], a[100:103], v[144:147]
  ds_read_b64_tr_b16 v[196:197], v222 offset:40960
  ds_read_b64_tr_b16 v[198:199], v222 offset:43008
  v_mfma_f32_16x16x32_bf16 v[148:151], v[200:203], a[96:99], v[148:151]
  s_waitcnt lgkmcnt(6)
  s_add_u32 m0, s26, 4096
  v_mfma_f32_16x16x32_bf16 v[152:155], v[200:203], a[100:103], v[152:155]
  ds_read_b64_tr_b16 v[200:201], v223 offset:40960
  ds_read_b64_tr_b16 v[202:203], v223 offset:43008
  v_mfma_f32_16x16x32_bf16 v[156:159], v[204:207], a[96:99], v[156:159]
  buffer_load_dwordx4 v93, s[56:59], 0 offen lds
  v_mfma_f32_16x16x32_bf16 v[160:163], v[204:207], a[100:103], v[160:163]
  ds_read_b64_tr_b16 v[204:205], v224 offset:40960
  ds_read_b64_tr_b16 v[206:207], v224 offset:43008
  v_mfma_f32_16x16x32_bf16 v[164:167], v[208:211], a[96:99], v[164:167]
  s_add_u32 s5, s5, s6
  v_add_u32 v30, s5, v30
  v_mfma_f32_16x16x32_bf16 v[168:171], v[208:211], a[100:103], v[168:171]
  ds_read_b64_tr_b16 v[208:209], v225 offset:40960
  ds_read_b64_tr_b16 v[210:211], v225 offset:43008
  v_mfma_f32_16x16x32_bf16 v[172:175], v[212:215], a[96:99], v[172:175]
  v_lshlrev_b32 v30, 2, v30
  v_add_u32 v4, 16254976, v30
  v_mfma_f32_16x16x32_bf16 v[176:179], v[212:215], a[100:103], v[176:179]
  ds_read_b64_tr_b16 v[212:213], v226 offset:40960
  ds_read_b64_tr_b16 v[214:215], v226 offset:43008
  v_mfma_f32_16x16x32_bf16 v[180:183], v[216:219], a[96:99], v[180:183]
  s_waitcnt lgkmcnt(6)
  s_add_u32 s69, s69, 98304
  v_mfma_f32_16x16x32_bf16 v[184:187], v[216:219], a[100:103], v[184:187]
  ds_read_b64_tr_b16 v[216:217], v227 offset:40960
  ds_read_b64_tr_b16 v[218:219], v227 offset:43008
  v_mfma_f32_16x16x32_bf16 v[124:127], v[188:191], a[104:107], v[124:127]
  s_waitcnt vmcnt(7)
  s_mul_i32 s75, s60, 5120
  v_mfma_f32_16x16x32_bf16 v[128:131], v[188:191], a[108:111], v[128:131]
  s_barrier
  v_mfma_f32_16x16x32_bf16 v[228:231], v[188:191], v[244:247], v[228:231]
  ds_read_b64_tr_b16 v[188:189], v220 offset:49152
  ds_read_b64_tr_b16 v[190:191], v220 offset:51200
  v_mfma_f32_16x16x32_bf16 v[132:135], v[192:195], a[104:107], v[132:135]
  s_add_u32 m0, s71, 16384
  s_cmp_eq_u32 s69, 1966080
  s_cselect_b32 s69, 0, s69
  v_mfma_f32_16x16x32_bf16 v[136:139], v[192:195], a[108:111], v[136:139]
  buffer_load_dwordx4 v11, s[32:35], s69 offen lds
  v_mfma_f32_16x16x32_bf16 v[232:235], v[192:195], v[244:247], v[232:235]
  ds_read_b64_tr_b16 v[192:193], v221 offset:49152
  ds_read_b64_tr_b16 v[194:195], v221 offset:51200
  v_mfma_f32_16x16x32_bf16 v[140:143], v[196:199], a[104:107], v[140:143]
  buffer_load_dwordx4 v11, s[36:39], s69 offen offset:1024 lds
  v_mfma_f32_16x16x32_bf16 v[144:147], v[196:199], a[108:111], v[144:147]
  ds_read_b64_tr_b16 v[196:197], v222 offset:49152
  ds_read_b64_tr_b16 v[198:199], v222 offset:51200
  v_mfma_f32_16x16x32_bf16 v[148:151], v[200:203], a[104:107], v[148:151]
  s_waitcnt lgkmcnt(6)
  s_add_u32 m0, s72, 2048
  v_mfma_f32_16x16x32_bf16 v[152:155], v[200:203], a[108:111], v[152:155]
  ds_read_b64_tr_b16 v[200:201], v223 offset:49152
  ds_read_b64_tr_b16 v[202:203], v223 offset:51200
  v_mfma_f32_16x16x32_bf16 v[156:159], v[204:207], a[104:107], v[156:159]
  buffer_load_dwordx4 v35, s[28:31], 0 offen lds
  v_mfma_f32_16x16x32_bf16 v[160:163], v[204:207], a[108:111], v[160:163]
  ds_read_b64_tr_b16 v[204:205], v224 offset:49152
  ds_read_b64_tr_b16 v[206:207], v224 offset:51200
  v_mfma_f32_16x16x32_bf16 v[164:167], v[208:211], a[104:107], v[164:167]
  v_add_u32 v1, s75, v10
  v_add_u32 v18, 0x10000, v1
  v_mfma_f32_16x16x32_bf16 v[168:171], v[208:211], a[108:111], v[168:171]
  ds_read_b64_tr_b16 v[208:209], v225 offset:49152
  ds_read_b64_tr_b16 v[210:211], v225 offset:51200
  v_mfma_f32_16x16x32_bf16 v[172:175], v[212:215], a[104:107], v[172:175]
  v_mfma_f32_16x16x32_bf16 v[176:179], v[212:215], a[108:111], v[176:179]
  ds_read_b64_tr_b16 v[212:213], v226 offset:49152
  ds_read_b64_tr_b16 v[214:215], v226 offset:51200
  v_mfma_f32_16x16x32_bf16 v[180:183], v[216:219], a[104:107], v[180:183]
  s_waitcnt lgkmcnt(6)
  s_add_u32 s69, s69, 98304
  v_mfma_f32_16x16x32_bf16 v[184:187], v[216:219], a[108:111], v[184:187]
  ds_read_b64_tr_b16 v[216:217], v227 offset:49152
  ds_read_b64_tr_b16 v[218:219], v227 offset:51200
  v_mfma_f32_16x16x32_bf16 v[124:127], v[188:191], a[112:115], v[124:127]
  s_cmp_eq_u32 s69, 1966080
  s_cselect_b32 s69, 0, s69
  v_mfma_f32_16x16x32_bf16 v[128:131], v[188:191], a[116:119], v[128:131]
  v_mfma_f32_16x16x32_bf16 v[228:231], v[188:191], v[244:247], v[228:231]
  ds_read_b64_tr_b16 v[188:189], v220 offset:57344
  ds_read_b64_tr_b16 v[190:191], v220 offset:59392
  v_mfma_f32_16x16x32_bf16 v[132:135], v[192:195], a[112:115], v[132:135]
  s_add_u32 m0, s71, 24576
  v_mfma_f32_16x16x32_bf16 v[136:139], v[192:195], a[116:119], v[136:139]
  buffer_load_dwordx4 v11, s[32:35], s69 offen lds
  v_mfma_f32_16x16x32_bf16 v[232:235], v[192:195], v[244:247], v[232:235]
  ds_read_b64_tr_b16 v[192:193], v221 offset:57344
  ds_read_b64_tr_b16 v[194:195], v221 offset:59392
  v_mfma_f32_16x16x32_bf16 v[140:143], v[196:199], a[112:115], v[140:143]
  buffer_load_dwordx4 v11, s[36:39], s69 offen offset:1024 lds
  v_mfma_f32_16x16x32_bf16 v[144:147], v[196:199], a[116:119], v[144:147]
  ds_read_b64_tr_b16 v[196:197], v222 offset:57344
  ds_read_b64_tr_b16 v[198:199], v222 offset:59392
  v_mfma_f32_16x16x32_bf16 v[148:151], v[200:203], a[112:115], v[148:151]
  s_waitcnt lgkmcnt(6)
  s_add_u32 m0, s26, 5120
  v_mfma_f32_16x16x32_bf16 v[152:155], v[200:203], a[116:119], v[152:155]
  ds_read_b64_tr_b16 v[200:201], v223 offset:57344
  ds_read_b64_tr_b16 v[202:203], v223 offset:59392
  v_mfma_f32_16x16x32_bf16 v[156:159], v[204:207], a[112:115], v[156:159]
  buffer_load_dwordx4 v94, s[56:59], 0 offen lds
  v_mfma_f32_16x16x32_bf16 v[160:163], v[204:207], a[116:119], v[160:163]
  ds_read_b64_tr_b16 v[204:205], v224 offset:57344
  ds_read_b64_tr_b16 v[206:207], v224 offset:59392
  v_mfma_f32_16x16x32_bf16 v[164:167], v[208:211], a[112:115], v[164:167]
  v_mfma_f32_16x16x32_bf16 v[168:171], v[208:211], a[116:119], v[168:171]
  ds_read_b64_tr_b16 v[208:209], v225 offset:57344
  ds_read_b64_tr_b16 v[210:211], v225 offset:59392
  v_mfma_f32_16x16x32_bf16 v[172:175], v[212:215], a[112:115], v[172:175]
  v_mfma_f32_16x16x32_bf16 v[176:179], v[212:215], a[116:119], v[176:179]
  ds_read_b64_tr_b16 v[212:213], v226 offset:57344
  ds_read_b64_tr_b16 v[214:215], v226 offset:59392
  v_mfma_f32_16x16x32_bf16 v[180:183], v[216:219], a[112:115], v[180:183]
  s_waitcnt lgkmcnt(6)
  s_add_u32 s69, s69, 98304
  v_mfma_f32_16x16x32_bf16 v[184:187], v[216:219], a[116:119], v[184:187]
  ds_read_b64_tr_b16 v[216:217], v227 offset:57344
  ds_read_b64_tr_b16 v[218:219], v227 offset:59392
  v_mfma_f32_16x16x32_bf16 v[124:127], v[188:191], a[120:123], v[124:127]
  s_waitcnt vmcnt(7)
  v_mfma_f32_16x16x32_bf16 v[128:131], v[188:191], a[124:127], v[128:131]
  s_barrier
  v_mfma_f32_16x16x32_bf16 v[228:231], v[188:191], v[244:247], v[228:231]
  ds_read_b64_tr_b16 v[188:189], v220 offset:0
  ds_read_b64_tr_b16 v[190:191], v220 offset:2048
  v_mfma_f32_16x16x32_bf16 v[132:135], v[192:195], a[120:123], v[132:135]
  s_add_u32 m0, s71, 32768
  s_cmp_eq_u32 s69, 1966080
  s_cselect_b32 s69, 0, s69
  v_mfma_f32_16x16x32_bf16 v[136:139], v[192:195], a[124:127], v[136:139]
  buffer_load_dwordx4 v12, s[32:35], s69 offen lds
  v_mfma_f32_16x16x32_bf16 v[232:235], v[192:195], v[244:247], v[232:235]
  ds_read_b64_tr_b16 v[192:193], v221 offset:0
  ds_read_b64_tr_b16 v[194:195], v221 offset:2048
  v_mfma_f32_16x16x32_bf16 v[140:143], v[196:199], a[120:123], v[140:143]
  buffer_load_dwordx4 v12, s[36:39], s69 offen offset:1024 lds
  v_mfma_f32_16x16x32_bf16 v[144:147], v[196:199], a[124:127], v[144:147]
  ds_read_b64_tr_b16 v[196:197], v222 offset:0
  ds_read_b64_tr_b16 v[198:199], v222 offset:2048
  v_mfma_f32_16x16x32_bf16 v[148:151], v[200:203], a[120:123], v[148:151]
  s_waitcnt lgkmcnt(6)
  v_mfma_f32_16x16x32_bf16 v[152:155], v[200:203], a[124:127], v[152:155]
  ds_read_b64_tr_b16 v[200:201], v223 offset:0
  ds_read_b64_tr_b16 v[202:203], v223 offset:2048
  v_mfma_f32_16x16x32_bf16 v[156:159], v[204:207], a[120:123], v[156:159]
  v_mfma_f32_16x16x32_bf16 v[160:163], v[204:207], a[124:127], v[160:163]
  ds_read_b64_tr_b16 v[204:205], v224 offset:0
  ds_read_b64_tr_b16 v[206:207], v224 offset:2048
  v_mfma_f32_16x16x32_bf16 v[164:167], v[208:211], a[120:123], v[164:167]
  v_mfma_f32_16x16x32_bf16 v[168:171], v[208:211], a[124:127], v[168:171]
  ds_read_b64_tr_b16 v[208:209], v225 offset:0
  ds_read_b64_tr_b16 v[210:211], v225 offset:2048
  v_mfma_f32_16x16x32_bf16 v[172:175], v[212:215], a[120:123], v[172:175]
  v_mfma_f32_16x16x32_bf16 v[176:179], v[212:215], a[124:127], v[176:179]
  ds_read_b64_tr_b16 v[212:213], v226 offset:0
  ds_read_b64_tr_b16 v[214:215], v226 offset:2048
  v_mfma_f32_16x16x32_bf16 v[180:183], v[216:219], a[120:123], v[180:183]
  s_waitcnt lgkmcnt(6)
  s_add_u32 s69, s69, 196608
  v_mfma_f32_16x16x32_bf16 v[184:187], v[216:219], a[124:127], v[184:187]
  ds_read_b64_tr_b16 v[216:217], v227 offset:0
  ds_read_b64_tr_b16 v[218:219], v227 offset:2048
  v_mfma_f32_16x16x32_bf16 v[124:127], v[188:191], a[128:131], v[124:127]
  s_cmp_eq_u32 s69, 1966080
  s_cselect_b32 s69, 0, s69
  v_mfma_f32_16x16x32_bf16 v[128:131], v[188:191], a[132:135], v[128:131]
  v_mfma_f32_16x16x32_bf16 v[228:231], v[188:191], v[244:247], v[228:231]
  ds_read_b64_tr_b16 v[188:189], v220 offset:8192
  ds_read_b64_tr_b16 v[190:191], v220 offset:10240
  v_mfma_f32_16x16x32_bf16 v[132:135], v[192:195], a[128:131], v[132:135]
  s_add_u32 m0, s71, 40960
  v_mfma_f32_16x16x32_bf16 v[136:139], v[192:195], a[132:135], v[136:139]
  buffer_load_dwordx4 v12, s[32:35], s69 offen lds
  v_mfma_f32_16x16x32_bf16 v[232:235], v[192:195], v[244:247], v[232:235]
  ds_read_b64_tr_b16 v[192:193], v221 offset:8192
  ds_read_b64_tr_b16 v[194:195], v221 offset:10240
  v_mfma_f32_16x16x32_bf16 v[140:143], v[196:199], a[128:131], v[140:143]
  buffer_load_dwordx4 v12, s[36:39], s69 offen offset:1024 lds
  v_mfma_f32_16x16x32_bf16 v[144:147], v[196:199], a[132:135], v[144:147]
  ds_read_b64_tr_b16 v[196:197], v222 offset:8192
  ds_read_b64_tr_b16 v[198:199], v222 offset:10240
  v_mfma_f32_16x16x32_bf16 v[148:151], v[200:203], a[128:131], v[148:151]
  s_waitcnt lgkmcnt(6)
  v_mfma_f32_16x16x32_bf16 v[152:155], v[200:203], a[132:135], v[152:155]
  ds_read_b64_tr_b16 v[200:201], v223 offset:8192
  ds_read_b64_tr_b16 v[202:203], v223 offset:10240
  v_mfma_f32_16x16x32_bf16 v[156:159], v[204:207], a[128:131], v[156:159]
  v_mfma_f32_16x16x32_bf16 v[160:163], v[204:207], a[132:135], v[160:163]
  ds_read_b64_tr_b16 v[204:205], v224 offset:8192
  ds_read_b64_tr_b16 v[206:207], v224 offset:10240
  v_mfma_f32_16x16x32_bf16 v[164:167], v[208:211], a[128:131], v[164:167]
  v_mfma_f32_16x16x32_bf16 v[168:171], v[208:211], a[132:135], v[168:171]
  ds_read_b64_tr_b16 v[208:209], v225 offset:8192
  ds_read_b64_tr_b16 v[210:211], v225 offset:10240
  v_mfma_f32_16x16x32_bf16 v[172:175], v[212:215], a[128:131], v[172:175]
  v_mfma_f32_16x16x32_bf16 v[176:179], v[212:215], a[132:135], v[176:179]
  ds_read_b64_tr_b16 v[212:213], v226 offset:8192
  ds_read_b64_tr_b16 v[214:215], v226 offset:10240
  v_mfma_f32_16x16x32_bf16 v[180:183], v[216:219], a[128:131], v[180:183]
  s_waitcnt lgkmcnt(6)
  s_add_u32 s69, s69, 196608
  v_mfma_f32_16x16x32_bf16 v[184:187], v[216:219], a[132:135], v[184:187]
  ds_read_b64_tr_b16 v[216:217], v227 offset:8192
  ds_read_b64_tr_b16 v[218:219], v227 offset:10240
  v_mfma_f32_16x16x32_bf16 v[124:127], v[188:191], a[136:139], v[124:127]
  s_waitcnt vmcnt(5)
  v_mfma_f32_16x16x32_bf16 v[128:131], v[188:191], a[140:143], v[128:131]
  s_barrier
  v_mfma_f32_16x16x32_bf16 v[228:231], v[188:191], v[244:247], v[228:231]
  ds_read_b64_tr_b16 v[188:189], v220 offset:16384
  ds_read_b64_tr_b16 v[190:191], v220 offset:18432
  v_mfma_f32_16x16x32_bf16 v[132:135], v[192:195], a[136:139], v[132:135]
  s_add_u32 m0, s71, 49152
  s_cmp_eq_u32 s69, 1966080
  s_cselect_b32 s69, 0, s69
  v_mfma_f32_16x16x32_bf16 v[136:139], v[192:195], a[140:143], v[136:139]
  buffer_load_dwordx4 v12, s[32:35], s69 offen lds
  v_mfma_f32_16x16x32_bf16 v[232:235], v[192:195], v[244:247], v[232:235]
  ds_read_b64_tr_b16 v[192:193], v221 offset:16384
  ds_read_b64_tr_b16 v[194:195], v221 offset:18432
  v_mfma_f32_16x16x32_bf16 v[140:143], v[196:199], a[136:139], v[140:143]
  buffer_load_dwordx4 v12, s[36:39], s69 offen offset:1024 lds
  v_mfma_f32_16x16x32_bf16 v[144:147], v[196:199], a[140:143], v[144:147]
  ds_read_b64_tr_b16 v[196:197], v222 offset:16384
  ds_read_b64_tr_b16 v[198:199], v222 offset:18432
  v_mfma_f32_16x16x32_bf16 v[148:151], v[200:203], a[136:139], v[148:151]
  s_waitcnt lgkmcnt(6)
  v_mfma_f32_16x16x32_bf16 v[152:155], v[200:203], a[140:143], v[152:155]
  ds_read_b64_tr_b16 v[200:201], v223 offset:16384
  ds_read_b64_tr_b16 v[202:203], v223 offset:18432
  v_mfma_f32_16x16x32_bf16 v[156:159], v[204:207], a[136:139], v[156:159]
  v_mfma_f32_16x16x32_bf16 v[160:163], v[204:207], a[140:143], v[160:163]
  ds_read_b64_tr_b16 v[204:205], v224 offset:16384
  ds_read_b64_tr_b16 v[206:207], v224 offset:18432
  v_mfma_f32_16x16x32_bf16 v[164:167], v[208:211], a[136:139], v[164:167]
  v_mfma_f32_16x16x32_bf16 v[168:171], v[208:211], a[140:143], v[168:171]
  ds_read_b64_tr_b16 v[208:209], v225 offset:16384
  ds_read_b64_tr_b16 v[210:211], v225 offset:18432
  v_mfma_f32_16x16x32_bf16 v[172:175], v[212:215], a[136:139], v[172:175]
  v_mfma_f32_16x16x32_bf16 v[176:179], v[212:215], a[140:143], v[176:179]
  ds_read_b64_tr_b16 v[212:213], v226 offset:16384
  ds_read_b64_tr_b16 v[214:215], v226 offset:18432
  v_mfma_f32_16x16x32_bf16 v[180:183], v[216:219], a[136:139], v[180:183]
  s_waitcnt lgkmcnt(6)
  s_add_u32 s69, s69, 196608
  v_mfma_f32_16x16x32_bf16 v[184:187], v[216:219], a[140:143], v[184:187]
  ds_read_b64_tr_b16 v[216:217], v227 offset:16384
  ds_read_b64_tr_b16 v[218:219], v227 offset:18432
  v_mfma_f32_16x16x32_bf16 v[124:127], v[188:191], a[144:147], v[124:127]
  s_cmp_eq_u32 s69, 1966080
  s_cselect_b32 s69, 0, s69
  v_mfma_f32_16x16x32_bf16 v[128:131], v[188:191], a[148:151], v[128:131]
  v_mfma_f32_16x16x32_bf16 v[228:231], v[188:191], v[244:247], v[228:231]
  ds_read_b64_tr_b16 v[188:189], v220 offset:24576
  ds_read_b64_tr_b16 v[190:191], v220 offset:26624
  v_mfma_f32_16x16x32_bf16 v[132:135], v[192:195], a[144:147], v[132:135]
  s_add_u32 m0, s71, 57344
  v_mfma_f32_16x16x32_bf16 v[136:139], v[192:195], a[148:151], v[136:139]
  buffer_load_dwordx4 v12, s[32:35], s69 offen lds
  v_mfma_f32_16x16x32_bf16 v[232:235], v[192:195], v[244:247], v[232:235]
  ds_read_b64_tr_b16 v[192:193], v221 offset:24576
  ds_read_b64_tr_b16 v[194:195], v221 offset:26624
  v_mfma_f32_16x16x32_bf16 v[140:143], v[196:199], a[144:147], v[140:143]
  buffer_load_dwordx4 v12, s[36:39], s69 offen offset:1024 lds
  v_mfma_f32_16x16x32_bf16 v[144:147], v[196:199], a[148:151], v[144:147]
  ds_read_b64_tr_b16 v[196:197], v222 offset:24576
  ds_read_b64_tr_b16 v[198:199], v222 offset:26624
  v_mfma_f32_16x16x32_bf16 v[148:151], v[200:203], a[144:147], v[148:151]
  s_waitcnt lgkmcnt(6)
  v_mfma_f32_16x16x32_bf16 v[152:155], v[200:203], a[148:151], v[152:155]
  ds_read_b64_tr_b16 v[200:201], v223 offset:24576
  ds_read_b64_tr_b16 v[202:203], v223 offset:26624
  v_mfma_f32_16x16x32_bf16 v[156:159], v[204:207], a[144:147], v[156:159]
  buffer_load_dwordx4 v[52:55], v3, s[44:47], 0 offen  sc1
  v_mfma_f32_16x16x32_bf16 v[160:163], v[204:207], a[148:151], v[160:163]
  ds_read_b64_tr_b16 v[204:205], v224 offset:24576
  ds_read_b64_tr_b16 v[206:207], v224 offset:26624
  v_mfma_f32_16x16x32_bf16 v[164:167], v[208:211], a[144:147], v[164:167]
  v_mfma_f32_16x16x32_bf16 v[168:171], v[208:211], a[148:151], v[168:171]
  ds_read_b64_tr_b16 v[208:209], v225 offset:24576
  ds_read_b64_tr_b16 v[210:211], v225 offset:26624
  v_mfma_f32_16x16x32_bf16 v[172:175], v[212:215], a[144:147], v[172:175]
  v_mfma_f32_16x16x32_bf16 v[176:179], v[212:215], a[148:151], v[176:179]
  ds_read_b64_tr_b16 v[212:213], v226 offset:24576
  ds_read_b64_tr_b16 v[214:215], v226 offset:26624
  v_mfma_f32_16x16x32_bf16 v[180:183], v[216:219], a[144:147], v[180:183]
  s_waitcnt lgkmcnt(6)
  s_add_u32 s69, s69, 196608
  v_mfma_f32_16x16x32_bf16 v[184:187], v[216:219], a[148:151], v[184:187]
  ds_read_b64_tr_b16 v[216:217], v227 offset:24576
  ds_read_b64_tr_b16 v[218:219], v227 offset:26624
  s_cmp_eq_u32 s69, 1966080
  s_cselect_b32 s69, 0, s69
  v_mfma_f32_16x16x32_bf16 v[124:127], v[188:191], a[152:155], v[124:127]
  v_mfma_f32_16x16x32_bf16 v[128:131], v[188:191], a[156:159], v[128:131]
  v_mfma_f32_16x16x32_bf16 v[228:231], v[188:191], v[244:247], v[228:231]
  v_mfma_f32_16x16x32_bf16 v[132:135], v[192:195], a[152:155], v[132:135]
  v_mfma_f32_16x16x32_bf16 v[136:139], v[192:195], a[156:159], v[136:139]
  v_mfma_f32_16x16x32_bf16 v[232:235], v[192:195], v[244:247], v[232:235]
  v_mfma_f32_16x16x32_bf16 v[140:143], v[196:199], a[152:155], v[140:143]
  s_nop 3
  ds_write_b128 v2, v[228:231]
  v_mfma_f32_16x16x32_bf16 v[144:147], v[196:199], a[156:159], v[144:147]
  v_mfma_f32_16x16x32_bf16 v[148:151], v[200:203], a[152:155], v[148:151]
  s_waitcnt lgkmcnt(1)
  v_mfma_f32_16x16x32_bf16 v[152:155], v[200:203], a[156:159], v[152:155]
  ds_write_b128 v2, v[232:235] offset:64
  v_mfma_f32_16x16x32_bf16 v[156:159], v[204:207], a[152:155], v[156:159]
  s_waitcnt vmcnt(5)
  s_waitcnt lgkmcnt(0)
  v_mfma_f32_16x16x32_bf16 v[160:163], v[204:207], a[156:159], v[160:163]
  s_barrier
  v_mfma_f32_16x16x32_bf16 v[164:167], v[208:211], a[152:155], v[164:167]
  ds_read_b128 v[76:79], v236 offset:0
  ds_read_b128 v[92:95], v238 offset:0
  v_mfma_f32_16x16x32_bf16 v[168:171], v[208:211], a[156:159], v[168:171]
  ds_read_b128 v[80:83], v236 offset:64
  ds_read_b128 v[96:99], v238 offset:64
  v_mfma_f32_16x16x32_bf16 v[172:175], v[212:215], a[152:155], v[172:175]
  ds_read_b128 v[84:87], v237 offset:0
  ds_read_b128 v[100:103], v239 offset:0
  v_mfma_f32_16x16x32_bf16 v[176:179], v[212:215], a[156:159], v[176:179]
  ds_read_b128 v[88:91], v237 offset:64
  ds_read_b128 v[104:107], v239 offset:64
  v_mfma_f32_16x16x32_bf16 v[180:183], v[216:219], a[152:155], v[180:183]
  ds_read_b64_tr_b16 v[188:189], v248 offset:32768
  ds_read_b64_tr_b16 v[190:191], v248 offset:33024
  v_mfma_f32_16x16x32_bf16 v[184:187], v[216:219], a[156:159], v[184:187]
  ds_read_b64_tr_b16 v[192:193], v249 offset:32768
  ds_read_b64_tr_b16 v[194:195], v249 offset:33024
  ds_read_b64_tr_b16 v[196:197], v250 offset:32768
  ds_read_b64_tr_b16 v[198:199], v250 offset:33024
  ds_read_b64_tr_b16 v[200:201], v251 offset:32768
  ds_read_b64_tr_b16 v[202:203], v251 offset:33024
  s_waitcnt lgkmcnt(15)
  v_pk_fma_f32 v[124:125], v[76:77], v[20:21], v[124:125] op_sel_hi:[1,0,1]
  v_pk_fma_f32 v[126:127], v[78:79], v[20:21], v[126:127] op_sel_hi:[1,0,1]
  s_waitcnt lgkmcnt(14)
  v_pk_fma_f32 v[156:157], v[92:93], v[20:21], v[156:157] op_sel_hi:[1,0,1]
  v_pk_fma_f32 v[158:159], v[94:95], v[20:21], v[158:159] op_sel_hi:[1,0,1]
  s_waitcnt lgkmcnt(13)
  v_pk_fma_f32 v[132:133], v[80:81], v[20:21], v[132:133] op_sel_hi:[1,0,1]
  v_pk_fma_f32 v[134:135], v[82:83], v[20:21], v[134:135] op_sel_hi:[1,0,1]
  s_waitcnt lgkmcnt(12)
  v_pk_fma_f32 v[164:165], v[96:97], v[20:21], v[164:165] op_sel_hi:[1,0,1]
  v_pk_fma_f32 v[166:167], v[98:99], v[20:21], v[166:167] op_sel_hi:[1,0,1]
  s_add_u32 m0, s71, 0
  s_nop 0
  buffer_load_dwordx4 v12, s[32:35], s69 offen lds
  v_pk_fma_f32 v[128:129], v[76:77], v[22:23], v[128:129] op_sel_hi:[1,0,1]
  v_pk_fma_f32 v[130:131], v[78:79], v[22:23], v[130:131] op_sel_hi:[1,0,1]
  v_pk_fma_f32 v[160:161], v[92:93], v[22:23], v[160:161] op_sel_hi:[1,0,1]
  v_pk_fma_f32 v[162:163], v[94:95], v[22:23], v[162:163] op_sel_hi:[1,0,1]
  v_pk_fma_f32 v[136:137], v[80:81], v[22:23], v[136:137] op_sel_hi:[1,0,1]
  v_pk_fma_f32 v[138:139], v[82:83], v[22:23], v[138:139] op_sel_hi:[1,0,1]
  v_pk_fma_f32 v[168:169], v[96:97], v[22:23], v[168:169] op_sel_hi:[1,0,1]
  v_pk_fma_f32 v[170:171], v[98:99], v[22:23], v[170:171] op_sel_hi:[1,0,1]
  buffer_load_dwordx4 v12, s[36:39], s69 offen offset:1024 lds
  s_cmp_lg_u32 s25, 0
  s_cbranch_scc1 L_sw1
  v_max_f32 v124, 0, v124
  v_max_f32 v125, 0, v125
  v_max_f32 v126, 0, v126
  v_max_f32 v127, 0, v127
  v_pk_mul_f32 v[156:157], v[156:157], v[24:25] op_sel_hi:[1,0]
  v_pk_mul_f32 v[158:159], v[158:159], v[24:25] op_sel_hi:[1,0]
  v_max_f32 v132, 0, v132
  v_max_f32 v133, 0, v133
  v_max_f32 v134, 0, v134
  v_max_f32 v135, 0, v135
  v_pk_mul_f32 v[164:165], v[164:165], v[24:25] op_sel_hi:[1,0]
  v_pk_mul_f32 v[166:167], v[166:167], v[24:25] op_sel_hi:[1,0]
  v_max_f32 v128, 0, v128
  v_max_f32 v129, 0, v129
  v_max_f32 v130, 0, v130
  v_max_f32 v131, 0, v131
  v_pk_mul_f32 v[160:161], v[160:161], v[26:27] op_sel_hi:[1,0]
  v_pk_mul_f32 v[162:163], v[162:163], v[26:27] op_sel_hi:[1,0]
  v_max_f32 v136, 0, v136
  v_max_f32 v137, 0, v137
  v_max_f32 v138, 0, v138
  v_max_f32 v139, 0, v139
  v_pk_mul_f32 v[168:169], v[168:169], v[26:27] op_sel_hi:[1,0]
  v_pk_mul_f32 v[170:171], v[170:171], v[26:27] op_sel_hi:[1,0]
  s_branch L_sj1
L_sw1:
  v_max_f32 v156, 0, v156
  v_max_f32 v157, 0, v157
  v_max_f32 v158, 0, v158
  v_max_f32 v159, 0, v159
  v_pk_mul_f32 v[124:125], v[124:125], v[24:25] op_sel_hi:[1,0]
  v_pk_mul_f32 v[126:127], v[126:127], v[24:25] op_sel_hi:[1,0]
  v_max_f32 v164, 0, v164
  v_max_f32 v165, 0, v165
  v_max_f32 v166, 0, v166
  v_max_f32 v167, 0, v167
  v_pk_mul_f32 v[132:133], v[132:133], v[24:25] op_sel_hi:[1,0]
  v_pk_mul_f32 v[134:135], v[134:135], v[24:25] op_sel_hi:[1,0]
  v_max_f32 v160, 0, v160
  v_max_f32 v161, 0, v161
  v_max_f32 v162, 0, v162
  v_max_f32 v163, 0, v163
  v_pk_mul_f32 v[128:129], v[128:129], v[26:27] op_sel_hi:[1,0]
  v_pk_mul_f32 v[130:131], v[130:131], v[26:27] op_sel_hi:[1,0]
  v_max_f32 v168, 0, v168
  v_max_f32 v169, 0, v169
  v_max_f32 v170, 0, v170
  v_max_f32 v171, 0, v171
  v_pk_mul_f32 v[136:137], v[136:137], v[26:27] op_sel_hi:[1,0]
  v_pk_mul_f32 v[138:139], v[138:139], v[26:27] op_sel_hi:[1,0]
L_sj1:
  v_pk_mul_f32 v[124:125], v[124:125], v[156:157]
  v_pk_mul_f32 v[126:127], v[126:127], v[158:159]
  v_cvt_pk_bf16_f32 v36, v124, v125
  v_cvt_pk_bf16_f32 v37, v126, v127
  s_add_u32 s69, s69, 196608
  s_cmp_eq_u32 s69, 1966080
  s_cselect_b32 s69, 0, s69
  s_add_u32 m0, s71, 8192
  s_nop 0
  buffer_load_dwordx4 v12, s[32:35], s69 offen lds
  v_pk_mul_f32 v[132:133], v[132:133], v[164:165]
  v_pk_mul_f32 v[134:135], v[134:135], v[166:167]
  v_cvt_pk_bf16_f32 v38, v132, v133
  v_cvt_pk_bf16_f32 v39, v134, v135
  buffer_store_dwordx4 v[36:39], v10, s[44:47], s73 offen offset:0 sc1
  v_pk_mul_f32 v[128:129], v[128:129], v[160:161]
  v_pk_mul_f32 v[130:131], v[130:131], v[162:163]
  v_cvt_pk_bf16_f32 v40, v128, v129
  v_cvt_pk_bf16_f32 v41, v130, v131
  buffer_load_dwordx4 v12, s[36:39], s69 offen offset:1024 lds
  v_pk_mul_f32 v[136:137], v[136:137], v[168:169]
  v_pk_mul_f32 v[138:139], v[138:139], v[170:171]
  v_cvt_pk_bf16_f32 v42, v136, v137
  v_cvt_pk_bf16_f32 v43, v138, v139
  buffer_store_dwordx4 v[40:43], v10, s[44:47], s73 offen offset:1024 sc1
  s_lshl_b32 s5, s24, 12
  s_sub_u32 s73, s73, s5
  s_add_u32 s73, s73, 2048
  s_waitcnt lgkmcnt(11)
  v_pk_fma_f32 v[140:141], v[84:85], v[20:21], v[140:141] op_sel_hi:[1,0,1]
  v_pk_fma_f32 v[142:143], v[86:87], v[20:21], v[142:143] op_sel_hi:[1,0,1]
  s_waitcnt lgkmcnt(10)
  v_pk_fma_f32 v[172:173], v[100:101], v[20:21], v[172:173] op_sel_hi:[1,0,1]
  v_pk_fma_f32 v[174:175], v[102:103], v[20:21], v[174:175] op_sel_hi:[1,0,1]
  s_waitcnt lgkmcnt(9)
  v_pk_fma_f32 v[148:149], v[88:89], v[20:21], v[148:149] op_sel_hi:[1,0,1]
  v_pk_fma_f32 v[150:151], v[90:91], v[20:21], v[150:151] op_sel_hi:[1,0,1]
  s_waitcnt lgkmcnt(8)
  v_pk_fma_f32 v[180:181], v[104:105], v[20:21], v[180:181] op_sel_hi:[1,0,1]
  v_pk_fma_f32 v[182:183], v[106:107], v[20:21], v[182:183] op_sel_hi:[1,0,1]
  s_add_u32 s69, s69, 196608
  s_cmp_eq_u32 s69, 1966080
  s_cselect_b32 s69, 0, s69
  v_pk_fma_f32 v[144:145], v[84:85], v[22:23], v[144:145] op_sel_hi:[1,0,1]
  v_pk_fma_f32 v[146:147], v[86:87], v[22:23], v[146:147] op_sel_hi:[1,0,1]
  v_pk_fma_f32 v[176:177], v[100:101], v[22:23], v[176:177] op_sel_hi:[1,0,1]
  v_pk_fma_f32 v[178:179], v[102:103], v[22:23], v[178:179] op_sel_hi:[1,0,1]
  v_pk_fma_f32 v[152:153], v[88:89], v[22:23], v[152:153] op_sel_hi:[1,0,1]
  v_pk_fma_f32 v[154:155], v[90:91], v[22:23], v[154:155] op_sel_hi:[1,0,1]
  v_pk_fma_f32 v[184:185], v[104:105], v[22:23], v[184:185] op_sel_hi:[1,0,1]
  v_pk_fma_f32 v[186:187], v[106:107], v[22:23], v[186:187] op_sel_hi:[1,0,1]
  s_cmp_lg_u32 s25, 0
  s_cbranch_scc1 L_sw2
  v_max_f32 v140, 0, v140
  v_max_f32 v141, 0, v141
  v_max_f32 v142, 0, v142
  v_max_f32 v143, 0, v143
  v_pk_mul_f32 v[172:173], v[172:173], v[24:25] op_sel_hi:[1,0]
  v_pk_mul_f32 v[174:175], v[174:175], v[24:25] op_sel_hi:[1,0]
  v_max_f32 v148, 0, v148
  v_max_f32 v149, 0, v149
  v_max_f32 v150, 0, v150
  v_max_f32 v151, 0, v151
  v_pk_mul_f32 v[180:181], v[180:181], v[24:25] op_sel_hi:[1,0]
  v_pk_mul_f32 v[182:183], v[182:183], v[24:25] op_sel_hi:[1,0]
  v_max_f32 v144, 0, v144
  v_max_f32 v145, 0, v145
  v_max_f32 v146, 0, v146
  v_max_f32 v147, 0, v147
  v_pk_mul_f32 v[176:177], v[176:177], v[26:27] op_sel_hi:[1,0]
  v_pk_mul_f32 v[178:179], v[178:179], v[26:27] op_sel_hi:[1,0]
  v_max_f32 v152, 0, v152
  v_max_f32 v153, 0, v153
  v_max_f32 v154, 0, v154
  v_max_f32 v155, 0, v155
  v_pk_mul_f32 v[184:185], v[184:185], v[26:27] op_sel_hi:[1,0]
  v_pk_mul_f32 v[186:187], v[186:187], v[26:27] op_sel_hi:[1,0]
  s_branch L_sj2
L_sw2:
  v_max_f32 v172, 0, v172
  v_max_f32 v173, 0, v173
  v_max_f32 v174, 0, v174
  v_max_f32 v175, 0, v175
  v_pk_mul_f32 v[140:141], v[140:141], v[24:25] op_sel_hi:[1,0]
  v_pk_mul_f32 v[142:143], v[142:143], v[24:25] op_sel_hi:[1,0]
  v_max_f32 v180, 0, v180
  v_max_f32 v181, 0, v181
  v_max_f32 v182, 0, v182
  v_max_f32 v183, 0, v183
  v_pk_mul_f32 v[148:149], v[148:149], v[24:25] op_sel_hi:[1,0]
  v_pk_mul_f32 v[150:151], v[150:151], v[24:25] op_sel_hi:[1,0]
  v_max_f32 v176, 0, v176
  v_max_f32 v177, 0, v177
  v_max_f32 v178, 0, v178
  v_max_f32 v179, 0, v179
  v_pk_mul_f32 v[144:145], v[144:145], v[26:27] op_sel_hi:[1,0]
  v_pk_mul_f32 v[146:147], v[146:147], v[26:27] op_sel_hi:[1,0]
  v_max_f32 v184, 0, v184
  v_max_f32 v185, 0, v185
  v_max_f32 v186, 0, v186
  v_max_f32 v187, 0, v187
  v_pk_mul_f32 v[152:153], v[152:153], v[26:27] op_sel_hi:[1,0]
  v_pk_mul_f32 v[154:155], v[154:155], v[26:27] op_sel_hi:[1,0]
L_sj2:
  v_pk_mul_f32 v[140:141], v[140:141], v[172:173]
  v_pk_mul_f32 v[142:143], v[142:143], v[174:175]
  v_cvt_pk_bf16_f32 v44, v140, v141
  v_cvt_pk_bf16_f32 v45, v142, v143
  v_pk_mul_f32 v[148:149], v[148:149], v[180:181]
  v_pk_mul_f32 v[150:151], v[150:151], v[182:183]
  v_cvt_pk_bf16_f32 v46, v148, v149
  v_cvt_pk_bf16_f32 v47, v150, v151
  buffer_store_dwordx4 v[44:47], v10, s[44:47], s73 offen offset:0 sc1
  v_pk_mul_f32 v[144:145], v[144:145], v[176:177]
  v_pk_mul_f32 v[146:147], v[146:147], v[178:179]
  v_cvt_pk_bf16_f32 v48, v144, v145
  v_cvt_pk_bf16_f32 v49, v146, v147
  v_pk_mul_f32 v[152:153], v[152:153], v[184:185]
  v_pk_mul_f32 v[154:155], v[154:155], v[186:187]
  v_cvt_pk_bf16_f32 v50, v152, v153
  v_cvt_pk_bf16_f32 v51, v154, v155
  buffer_store_dwordx4 v[48:51], v10, s[44:47], s73 offen offset:1024 sc1
  s_waitcnt vmcnt(8)
  v_min3_u32 v52, v52, v53, v54
  v_min_u32 v52, v52, v55
  v_cmp_le_u32 s[0:1], 1, v52
  s_nop 0
  s_cmp_eq_u64 s[0:1], exec
  s_cbranch_scc1 L_ok3
  s_mov_b32 s78, 65536
L_spin3:
  s_sleep 4
  buffer_load_dwordx4 v[52:55], v3, s[44:47], 0 offen  sc1
  s_waitcnt vmcnt(0)
  v_min3_u32 v52, v52, v53, v54
  v_min_u32 v52, v52, v55
  v_cmp_le_u32 s[0:1], 1, v52
  s_nop 0
  s_cmp_eq_u64 s[0:1], exec
  s_cbranch_scc1 L_ok3
  s_sub_u32 s78, s78, 1
  s_cmp_lg_u32 s78, 0
  s_cbranch_scc1 L_spin3
L_ok3:
  s_waitcnt lgkmcnt(6)
  v_mfma_f32_16x16x32_bf16 v[124:127], v[188:191], a[0:3], 0
  buffer_load_dwordx4 v[76:79], v10, s[44:47], s68 offen offset:0 sc1
  v_mfma_f32_16x16x32_bf16 v[128:131], v[188:191], a[4:7], 0
  ds_read_b64_tr_b16 v[204:205], v248 offset:36864
  ds_read_b64_tr_b16 v[206:207], v248 offset:37120
  v_mfma_f32_16x16x32_bf16 v[228:231], v[188:191], v[244:247], 0
  ds_read_b64_tr_b16 v[208:209], v249 offset:36864
  ds_read_b64_tr_b16 v[210:211], v249 offset:37120
  s_waitcnt lgkmcnt(8)
  v_mfma_f32_16x16x32_bf16 v[132:135], v[192:195], a[0:3], 0
  buffer_load_dwordx4 v[80:83], v10, s[44:47], s68 offen offset:1024 sc1
  v_mfma_f32_16x16x32_bf16 v[136:139], v[192:195], a[4:7], 0
  s_waitcnt lgkmcnt(4)
  v_mfma_f32_16x16x32_bf16 v[140:143], v[196:199], a[0:3], 0
  ds_read_b64_tr_b16 v[212:213], v250 offset:36864
  ds_read_b64_tr_b16 v[214:215], v250 offset:37120
  v_mfma_f32_16x16x32_bf16 v[144:147], v[196:199], a[4:7], 0
  ds_read_b64_tr_b16 v[216:217], v251 offset:36864
  ds_read_b64_tr_b16 v[218:219], v251 offset:37120
  v_mfma_f32_16x16x32_bf16 v[148:151], v[200:203], a[0:3], 0
  buffer_load_dwordx4 v[84:87], v10, s[44:47], s68 offen offset:2048 sc1
  v_mfma_f32_16x16x32_bf16 v[152:155], v[200:203], a[4:7], 0
  s_waitcnt lgkmcnt(4)
  v_mfma_f32_16x16x32_bf16 v[124:127], v[204:207], a[8:11], v[124:127]
  buffer_load_dwordx4 v[88:91], v10, s[44:47], s68 offen offset:3072 sc1
  v_mfma_f32_16x16x32_bf16 v[128:131], v[204:207], a[12:15], v[128:131]
  ds_read_b64_tr_b16 v[188:189], v248 offset:40960
  ds_read_b64_tr_b16 v[190:191], v248 offset:41216
  v_mfma_f32_16x16x32_bf16 v[228:231], v[204:207], v[244:247], v[228:231]
  ds_read_b64_tr_b16 v[192:193], v249 offset:40960
  ds_read_b64_tr_b16 v[194:195], v249 offset:41216
  v_mfma_f32_16x16x32_bf16 v[132:135], v[208:211], a[8:11], v[132:135]
  ds_read_b128 a[0:3], v10 offset:20480
  ds_read_b128 a[4:7], v10 offset:21504
  v_mfma_f32_16x16x32_bf16 v[136:139], v[208:211], a[12:15], v[136:139]
  s_waitcnt lgkmcnt(6)
  v_mfma_f32_16x16x32_bf16 v[140:143], v[212:215], a[8:11], v[140:143]
  ds_read_b64_tr_b16 v[196:197], v250 offset:40960
  ds_read_b64_tr_b16 v[198:199], v250 offset:41216
  v_mfma_f32_16x16x32_bf16 v[144:147], v[212:215], a[12:15], v[144:147]
  ds_read_b64_tr_b16 v[200:201], v251 offset:40960
  ds_read_b64_tr_b16 v[202:203], v251 offset:41216
  v_mfma_f32_16x16x32_bf16 v[148:151], v[216:219], a[8:11], v[148:151]
  v_mfma_f32_16x16x32_bf16 v[152:155], v[216:219], a[12:15], v[152:155]
  s_waitcnt lgkmcnt(6)
  v_mfma_f32_16x16x32_bf16 v[124:127], v[188:191], a[16:19], v[124:127]
  ds_read_b128 a[8:11], v10 offset:22528
  ds_read_b128 a[12:15], v10 offset:23552
  v_mfma_f32_16x16x32_bf16 v[128:131], v[188:191], a[20:23], v[128:131]
  ds_read_b64_tr_b16 v[204:205], v248 offset:45056
  ds_read_b64_tr_b16 v[206:207], v248 offset:45312
  v_mfma_f32_16x16x32_bf16 v[228:231], v[188:191], v[244:247], v[228:231]
  ds_read_b64_tr_b16 v[208:209], v249 offset:45056
  ds_read_b64_tr_b16 v[210:211], v249 offset:45312
  v_mfma_f32_16x16x32_bf16 v[132:135], v[192:195], a[16:19], v[132:135]
  v_mfma_f32_16x16x32_bf16 v[136:139], v[192:195], a[20:23], v[136:139]
  s_waitcnt lgkmcnt(6)
  v_mfma_f32_16x16x32_bf16 v[140:143], v[196:199], a[16:19], v[140:143]
  ds_read_b64_tr_b16 v[212:213], v250 offset:45056
  ds_read_b64_tr_b16 v[214:215], v250 offset:45312
  v_mfma_f32_16x16x32_bf16 v[144:147], v[196:199], a[20:23], v[144:147]
  ds_read_b64_tr_b16 v[216:217], v251 offset:45056
  ds_read_b64_tr_b16 v[218:219], v251 offset:45312
  v_mfma_f32_16x16x32_bf16 v[148:151], v[200:203], a[16:19], v[148:151]
  v_mfma_f32_16x16x32_bf16 v[152:155], v[200:203], a[20:23], v[152:155]
  s_waitcnt lgkmcnt(4)
  v_mfma_f32_16x16x32_bf16 v[124:127], v[204:207], a[24:27], v[124:127]
  s_barrier
  v_mfma_f32_16x16x32_bf16 v[128:131], v[204:207], a[28:31], v[128:131]
  ds_read_b64_tr_b16 v[188:189], v248 offset:49152
  ds_read_b64_tr_b16 v[190:191], v248 offset:49408
  v_mfma_f32_16x16x32_bf16 v[228:231], v[204:207], v[244:247], v[228:231]
  ds_read_b64_tr_b16 v[192:193], v249 offset:49152
  ds_read_b64_tr_b16 v[194:195], v249 offset:49408
  v_mfma_f32_16x16x32_bf16 v[132:135], v[208:211], a[24:27], v[132:135]
  s_add_u32 m0, s71, 16384
  ds_read_b128 a[16:19], v10 offset:24576
  v_mfma_f32_16x16x32_bf16 v[136:139], v[208:211], a[28:31], v[136:139]
  s_waitcnt lgkmcnt(5)
  ds_read_b128 a[20:23], v10 offset:25600
  v_mfma_f32_16x16x32_bf16 v[140:143], v[212:215], a[24:27], v[140:143]
  ds_read_b64_tr_b16 v[196:197], v250 offset:49152
  ds_read_b64_tr_b16 v[198:199], v250 offset:49408
  v_mfma_f32_16x16x32_bf16 v[144:147], v[212:215], a[28:31], v[144:147]
  ds_read_b64_tr_b16 v[200:201], v251 offset:49152
  ds_read_b64_tr_b16 v[202:203], v251 offset:49408
  v_mfma_f32_16x16x32_bf16 v[148:151], v[216:219], a[24:27], v[148:151]
  buffer_load_dwordx4 v12, s[32:35], s69 offen lds
  v_mfma_f32_16x16x32_bf16 v[152:155], v[216:219], a[28:31], v[152:155]
  s_waitcnt lgkmcnt(6)
  v_mfma_f32_16x16x32_bf16 v[124:127], v[188:191], a[32:35], v[124:127]
  buffer_load_dwordx4 v12, s[36:39], s69 offen offset:1024 lds
  v_mfma_f32_16x16x32_bf16 v[128:131], v[188:191], a[36:39], v[128:131]
  ds_read_b64_tr_b16 v[204:205], v248 offset:53248
  ds_read_b64_tr_b16 v[206:207], v248 offset:53504
  v_mfma_f32_16x16x32_bf16 v[228:231], v[188:191], v[244:247], v[228:231]
  ds_read_b64_tr_b16 v[208:209], v249 offset:53248
  ds_read_b64_tr_b16 v[210:211], v249 offset:53504
  v_mfma_f32_16x16x32_bf16 v[132:135], v[192:195], a[32:35], v[132:135]
  s_add_u32 s69, s69, 196608
  ds_read_b128 a[24:27], v10 offset:26624
  v_mfma_f32_16x16x32_bf16 v[136:139], v[192:195], a[36:39], v[136:139]
  s_waitcnt lgkmcnt(5)
  ds_read_b128 a[28:31], v10 offset:27648
  v_mfma_f32_16x16x32_bf16 v[140:143], v[196:199], a[32:35], v[140:143]
  ds_read_b64_tr_b16 v[212:213], v250 offset:53248
  ds_read_b64_tr_b16 v[214:215], v250 offset:53504
  v_mfma_f32_16x16x32_bf16 v[144:147], v[196:199], a[36:39], v[144:147]
  ds_read_b64_tr_b16 v[216:217], v251 offset:53248
  ds_read_b64_tr_b16 v[218:219], v251 offset:53504
  v_mfma_f32_16x16x32_bf16 v[148:151], v[200:203], a[32:35], v[148:151]
  s_cmp_eq_u32 s69, 1966080
  s_cselect_b32 s69, 0, s69
  v_mfma_f32_16x16x32_bf16 v[152:155], v[200:203], a[36:39], v[152:155]
  s_waitcnt lgkmcnt(6)
  s_waitcnt vmcnt(5)
  v_alignbit_b32 v92, v76, v76, 16
  v_mfma_f32_16x16x32_bf16 v[124:127], v[204:207], a[40:43], v[124:127]
  ds_read_b128 a[32:35], v10 offset:28672
  v_mfma_f32_16x16x32_bf16 v[128:131], v[204:207], a[44:47], v[128:131]
  ds_read_b64_tr_b16 v[188:189], v248 offset:57344
  ds_read_b64_tr_b16 v[190:191], v248 offset:57600
  v_mfma_f32_16x16x32_bf16 v[228:231], v[204:207], v[244:247], v[228:231]
  ds_read_b64_tr_b16 v[192:193], v249 offset:57344
  ds_read_b64_tr_b16 v[194:195], v249 offset:57600
  v_mfma_f32_16x16x32_bf16 v[132:135], v[208:211], a[40:43], v[132:135]
  buffer_store_dword v253, v252, s[44:47], 0 offen sc1
  v_mfma_f32_16x16x32_bf16 v[136:139], v[208:211], a[44:47], v[136:139]
  s_waitcnt lgkmcnt(5)
  s_add_u32 m0, s71, 24576
  v_mfma_f32_16x16x32_bf16 v[140:143], v[212:215], a[40:43], v[140:143]
  ds_read_b64_tr_b16 v[196:197], v250 offset:57344
  ds_read_b64_tr_b16 v[198:199], v250 offset:57600
  v_mfma_f32_16x16x32_bf16 v[144:147], v[212:215], a[44:47], v[144:147]
  ds_read_b64_tr_b16 v[200:201], v251 offset:57344
  ds_read_b64_tr_b16 v[202:203], v251 offset:57600
  v_mfma_f32_16x16x32_bf16 v[148:151], v[216:219], a[40:43], v[148:151]
  buffer_load_dwordx4 v12, s[32:35], s69 offen lds
  v_mfma_f32_16x16x32_bf16 v[152:155], v[216:219], a[44:47], v[152:155]
  s_waitcnt lgkmcnt(4)
  ds_read_b128 a[36:39], v10 offset:29696
  v_mfma_f32_16x16x32_bf16 v[124:127], v[188:191], a[48:51], v[124:127]
  buffer_load_dwordx4 v12, s[36:39], s69 offen offset:1024 lds
  v_mfma_f32_16x16x32_bf16 v[128:131], v[188:191], a[52:55], v[128:131]
  ds_read_b64_tr_b16 v[204:205], v248 offset:61440
  ds_read_b64_tr_b16 v[206:207], v248 offset:61696
  v_mfma_f32_16x16x32_bf16 v[228:231], v[188:191], v[244:247], v[228:231]
  ds_read_b64_tr_b16 v[208:209], v249 offset:61440
  ds_read_b64_tr_b16 v[210:211], v249 offset:61696
  v_mfma_f32_16x16x32_bf16 v[132:135], v[192:195], a[48:51], v[132:135]
  s_add_u32 s69, s69, 196608
  ds_read_b128 a[40:43], v10 offset:30720
  v_mfma_f32_16x16x32_bf16 v[136:139], v[192:195], a[52:55], v[136:139]
  s_waitcnt lgkmcnt(6)
  ds_read_b128 a[44:47], v10 offset:31744
  v_mfma_f32_16x16x32_bf16 v[140:143], v[196:199], a[48:51], v[140:143]
  ds_read_b64_tr_b16 v[212:213], v250 offset:61440
  ds_read_b64_tr_b16 v[214:215], v250 offset:61696
  v_mfma_f32_16x16x32_bf16 v[144:147], v[196:199], a[52:55], v[144:147]
  ds_read_b64_tr_b16 v[216:217], v251 offset:61440
  ds_read_b64_tr_b16 v[218:219], v251 offset:61696
  v_mfma_f32_16x16x32_bf16 v[148:151], v[200:203], a[48:51], v[148:151]
  s_cmp_eq_u32 s69, 1966080
  s_cselect_b32 s69, 0, s69
  v_mfma_f32_16x16x32_bf16 v[152:155], v[200:203], a[52:55], v[152:155]
  s_waitcnt lgkmcnt(6)
  v_mfma_f32_16x16x32_bf16 v[124:127], v[204:207], a[56:59], v[124:127]
  s_barrier
  v_mfma_f32_16x16x32_bf16 v[128:131], v[204:207], a[60:63], v[128:131]
  ds_read_b64_tr_b16 v[188:189], v248 offset:0
  ds_read_b64_tr_b16 v[190:191], v248 offset:256
  v_mfma_f32_16x16x32_bf16 v[228:231], v[204:207], v[244:247], v[228:231]
  ds_read_b64_tr_b16 v[192:193], v249 offset:0
  ds_read_b64_tr_b16 v[194:195], v249 offset:256
  v_mfma_f32_16x16x32_bf16 v[132:135], v[208:211], a[56:59], v[132:135]
  s_add_u32 m0, s71, 32768
  ds_read_b128 a[48:51], v10 offset:32768
  v_mfma_f32_16x16x32_bf16 v[136:139], v[208:211], a[60:63], v[136:139]
  s_waitcnt lgkmcnt(5)
  ds_read_b128 a[52:55], v10 offset:33792
  v_mfma_f32_16x16x32_bf16 v[140:143], v[212:215], a[56:59], v[140:143]
  ds_read_b64_tr_b16 v[196:197], v250 offset:0
  ds_read_b64_tr_b16 v[198:199], v250 offset:256
  v_mfma_f32_16x16x32_bf16 v[144:147], v[212:215], a[60:63], v[144:147]
  ds_read_b64_tr_b16 v[200:201], v251 offset:0
  ds_read_b64_tr_b16 v[202:203], v251 offset:256
  v_mfma_f32_16x16x32_bf16 v[148:151], v[216:219], a[56:59], v[148:151]
  buffer_load_dwordx4 v12, s[32:35], s69 offen lds
  v_mfma_f32_16x16x32_bf16 v[152:155], v[216:219], a[60:63], v[152:155]
  s_waitcnt lgkmcnt(6)
  v_xor_b32 v92, 0x80000000, v92
  v_mfma_f32_16x16x32_bf16 v[124:127], v[188:191], a[64:67], v[124:127]
  buffer_load_dwordx4 v12, s[36:39], s69 offen offset:1024 lds
  v_mfma_f32_16x16x32_bf16 v[128:131], v[188:191], a[68:71], v[128:131]
  ds_read_b64_tr_b16 v[204:205], v248 offset:4096
  ds_read_b64_tr_b16 v[206:207], v248 offset:4352
  v_mfma_f32_16x16x32_bf16 v[228:231], v[188:191], v[244:247], v[228:231]
  ds_read_b64_tr_b16 v[208:209], v249 offset:4096
  ds_read_b64_tr_b16 v[210:211], v249 offset:4352
  v_mfma_f32_16x16x32_bf16 v[132:135], v[192:195], a[64:67], v[132:135]
  s_add_u32 s69, s69, 196608
  ds_read_b128 a[56:59], v10 offset:34816
  v_mfma_f32_16x16x32_bf16 v[136:139], v[192:195], a[68:71], v[136:139]
  s_waitcnt lgkmcnt(5)
  ds_read_b128 a[60:63], v10 offset:35840
  v_mfma_f32_16x16x32_bf16 v[140:143], v[196:199], a[64:67], v[140:143]
  ds_read_b64_tr_b16 v[212:213], v250 offset:4096
  ds_read_b64_tr_b16 v[214:215], v250 offset:4352
  v_mfma_f32_16x16x32_bf16 v[144:147], v[196:199], a[68:71], v[144:147]
  ds_read_b64_tr_b16 v[216:217], v251 offset:4096
  ds_read_b64_tr_b16 v[218:219], v251 offset:4352
  v_mfma_f32_16x16x32_bf16 v[148:151], v[200:203], a[64:67], v[148:151]
  s_cmp_eq_u32 s69, 1966080
  s_cselect_b32 s69, 0, s69
  v_mfma_f32_16x16x32_bf16 v[152:155], v[200:203], a[68:71], v[152:155]
  s_waitcnt lgkmcnt(6)
  v_alignbit_b32 v93, v77, v77, 16
  v_mfma_f32_16x16x32_bf16 v[124:127], v[204:207], a[72:75], v[124:127]
  s_add_u32 m0, s71, 40960
  v_xor_b32 v93, 0x80000000, v93
  v_mfma_f32_16x16x32_bf16 v[128:131], v[204:207], a[76:79], v[128:131]
  ds_read_b64_tr_b16 v[188:189], v248 offset:8192
  ds_read_b64_tr_b16 v[190:191], v248 offset:8448
  v_mfma_f32_16x16x32_bf16 v[228:231], v[204:207], v[244:247], v[228:231]
  ds_read_b64_tr_b16 v[192:193], v249 offset:8192
  ds_read_b64_tr_b16 v[194:195], v249 offset:8448
  v_mfma_f32_16x16x32_bf16 v[132:135], v[208:211], a[72:75], v[132:135]
  buffer_load_dwordx4 v12, s[32:35], s69 offen lds
  v_mfma_f32_16x16x32_bf16 v[136:139], v[208:211], a[76:79], v[136:139]
  s_waitcnt lgkmcnt(4)
  v_alignbit_b32 v94, v78, v78, 16
  v_mfma_f32_16x16x32_bf16 v[140:143], v[212:215], a[72:75], v[140:143]
  ds_read_b64_tr_b16 v[196:197], v250 offset:8192
  ds_read_b64_tr_b16 v[198:199], v250 offset:8448
  v_mfma_f32_16x16x32_bf16 v[144:147], v[212:215], a[76:79], v[144:147]
  ds_read_b64_tr_b16 v[200:201], v251 offset:8192
  ds_read_b64_tr_b16 v[202:203], v251 offset:8448
  v_mfma_f32_16x16x32_bf16 v[148:151], v[216:219], a[72:75], v[148:151]
  buffer_load_dwordx4 v12, s[36:39], s69 offen offset:1024 lds
  v_mfma_f32_16x16x32_bf16 v[152:155], v[216:219], a[76:79], v[152:155]
  s_waitcnt lgkmcnt(4)
  v_xor_b32 v94, 0x80000000, v94
  v_mfma_f32_16x16x32_bf16 v[124:127], v[188:191], a[80:83], v[124:127]
  s_add_u32 s17, s16, 0
  v_alignbit_b32 v95, v79, v79, 16
  v_mfma_f32_16x16x32_bf16 v[128:131], v[188:191], a[84:87], v[128:131]
  ds_read_b64_tr_b16 v[204:205], v248 offset:12288
  ds_read_b64_tr_b16 v[206:207], v248 offset:12544
  v_mfma_f32_16x16x32_bf16 v[228:231], v[188:191], v[244:247], v[228:231]
  ds_read_b64_tr_b16 v[208:209], v249 offset:12288
  ds_read_b64_tr_b16 v[210:211], v249 offset:12544
  v_mfma_f32_16x16x32_bf16 v[132:135], v[192:195], a[80:83], v[132:135]
  buffer_load_dwordx4 a[160:163], v10, s[44:47], s17 offen offset:0 sc1
  v_mfma_f32_16x16x32_bf16 v[136:139], v[192:195], a[84:87], v[136:139]
  s_waitcnt lgkmcnt(4)
  s_add_u32 s18, s17, 4096
  v_mfma_f32_16x16x32_bf16 v[140:143], v[196:199], a[80:83], v[140:143]
  ds_read_b64_tr_b16 v[212:213], v250 offset:12288
  ds_read_b64_tr_b16 v[214:215], v250 offset:12544
  v_mfma_f32_16x16x32_bf16 v[144:147], v[196:199], a[84:87], v[144:147]
  ds_read_b64_tr_b16 v[216:217], v251 offset:12288
  ds_read_b64_tr_b16 v[218:219], v251 offset:12544
  v_mfma_f32_16x16x32_bf16 v[148:151], v[200:203], a[80:83], v[148:151]
  buffer_load_dwordx4 a[164:167], v10, s[44:47], s17 offen offset:1024 sc1
  v_mfma_f32_16x16x32_bf16 v[152:155], v[200:203], a[84:87], v[152:155]
  s_waitcnt lgkmcnt(4)
  s_waitcnt vmcnt(6)
  v_mfma_f32_16x16x32_bf16 v[124:127], v[204:207], a[88:91], v[124:127]
  s_barrier
  v_mfma_f32_16x16x32_bf16 v[128:131], v[204:207], a[92:95], v[128:131]
  ds_read_b64_tr_b16 v[188:189], v248 offset:16384
  ds_read_b64_tr_b16 v[190:191], v248 offset:16640
  v_mfma_f32_16x16x32_bf16 v[228:231], v[204:207], v[244:247], v[228:231]
  ds_read_b64_tr_b16 v[192:193], v249 offset:16384
  ds_read_b64_tr_b16 v[194:195], v249 offset:16640
  v_mfma_f32_16x16x32_bf16 v[132:135], v[208:211], a[88:91], v[132:135]
  buffer_load_dwordx4 a[168:171], v10, s[44:47], s17 offen offset:2048 sc1
  v_mfma_f32_16x16x32_bf16 v[136:139], v[208:211], a[92:95], v[136:139]
  s_waitcnt lgkmcnt(4)
  v_xor_b32 v95, 0x80000000, v95
  v_mfma_f32_16x16x32_bf16 v[140:143], v[212:215], a[88:91], v[140:143]
  ds_read_b64_tr_b16 v[196:197], v250 offset:16384
  ds_read_b64_tr_b16 v[198:199], v250 offset:16640
  v_mfma_f32_16x16x32_bf16 v[144:147], v[212:215], a[92:95], v[144:147]
  ds_read_b64_tr_b16 v[200:201], v251 offset:16384
  ds_read_b64_tr_b16 v[202:203], v251 offset:16640
  v_mfma_f32_16x16x32_bf16 v[148:151], v[216:219], a[88:91], v[148:151]
  buffer_load_dwordx4 a[172:175], v10, s[44:47], s17 offen offset:3072 sc1
  v_mfma_f32_16x16x32_bf16 v[152:155], v[216:219], a[92:95], v[152:155]
  s_waitcnt lgkmcnt(4)
  v_alignbit_b32 v96, v80, v80, 16
  v_mfma_f32_16x16x32_bf16 v[124:127], v[188:191], a[96:99], v[124:127]
  buffer_load_dwordx4 a[176:179], v10, s[44:47], s18 offen sc1
  v_mfma_f32_16x16x32_bf16 v[128:131], v[188:191], a[100:103], v[128:131]
  ds_read_b64_tr_b16 v[204:205], v248 offset:20480
  ds_read_b64_tr_b16 v[206:207], v248 offset:20736
  v_mfma_f32_16x16x32_bf16 v[228:231], v[188:191], v[244:247], v[228:231]
  ds_read_b64_tr_b16 v[208:209], v249 offset:20480
  ds_read_b64_tr_b16 v[210:211], v249 offset:20736
  v_mfma_f32_16x16x32_bf16 v[132:135], v[192:195], a[96:99], v[132:135]
  s_add_u32 s17, s16, 40960
  v_xor_b32 v96, 0x80000000, v96
  v_mfma_f32_16x16x32_bf16 v[136:139], v[192:195], a[100:103], v[136:139]
  s_waitcnt lgkmcnt(4)
  v_alignbit_b32 v97, v81, v81, 16
  v_mfma_f32_16x16x32_bf16 v[140:143], v[196:199], a[96:99], v[140:143]
  ds_read_b64_tr_b16 v[212:213], v250 offset:20480
  ds_read_b64_tr_b16 v[214:215], v250 offset:20736
  v_mfma_f32_16x16x32_bf16 v[144:147], v[196:199], a[100:103], v[144:147]
  ds_read_b64_tr_b16 v[216:217], v251 offset:20480
  ds_read_b64_tr_b16 v[218:219], v251 offset:20736
  v_mfma_f32_16x16x32_bf16 v[148:151], v[200:203], a[96:99], v[148:151]
  buffer_load_dwordx4 a[180:183], v10, s[44:47], s17 offen offset:0 sc1
  v_mfma_f32_16x16x32_bf16 v[152:155], v[200:203], a[100:103], v[152:155]
  s_waitcnt lgkmcnt(4)
  v_xor_b32 v97, 0x80000000, v97
  v_mfma_f32_16x16x32_bf16 v[124:127], v[204:207], a[104:107], v[124:127]
  s_add_u32 s18, s17, 4096
  v_alignbit_b32 v98, v82, v82, 16
  v_mfma_f32_16x16x32_bf16 v[128:131], v[204:207], a[108:111], v[128:131]
  ds_read_b64_tr_b16 v[188:189], v248 offset:24576
  ds_read_b64_tr_b16 v[190:191], v248 offset:24832
  v_mfma_f32_16x16x32_bf16 v[228:231], v[204:207], v[244:247], v[228:231]
  ds_read_b64_tr_b16 v[192:193], v249 offset:24576
  ds_read_b64_tr_b16 v[194:195], v249 offset:24832
  v_mfma_f32_16x16x32_bf16 v[132:135], v[208:211], a[104:107], v[132:135]
  buffer_load_dwordx4 a[184:187], v10, s[44:47], s17 offen offset:1024 sc1
  v_mfma_f32_16x16x32_bf16 v[136:139], v[208:211], a[108:111], v[136:139]
  s_waitcnt lgkmcnt(4)
  v_xor_b32 v98, 0x80000000, v98
  v_mfma_f32_16x16x32_bf16 v[140:143], v[212:215], a[104:107], v[140:143]
  ds_read_b64_tr_b16 v[196:197], v250 offset:24576
  ds_read_b64_tr_b16 v[198:199], v250 offset:24832
  v_mfma_f32_16x16x32_bf16 v[144:147], v[212:215], a[108:111], v[144:147]
  ds_read_b64_tr_b16 v[200:201], v251 offset:24576
  ds_read_b64_tr_b16 v[202:203], v251 offset:24832
  v_mfma_f32_16x16x32_bf16 v[148:151], v[216:219], a[104:107], v[148:151]
  buffer_load_dwordx4 a[188:191], v10, s[44:47], s17 offen offset:2048 sc1
  v_mfma_f32_16x16x32_bf16 v[152:155], v[216:219], a[108:111], v[152:155]
  s_waitcnt lgkmcnt(4)
  v_alignbit_b32 v99, v83, v83, 16
  v_mfma_f32_16x16x32_bf16 v[124:127], v[188:191], a[112:115], v[124:127]
  buffer_load_dwordx4 a[192:195], v10, s[44:47], s17 offen offset:3072 sc1
  v_mfma_f32_16x16x32_bf16 v[128:131], v[188:191], a[116:119], v[128:131]
  ds_read_b64_tr_b16 v[204:205], v248 offset:28672
  ds_read_b64_tr_b16 v[206:207], v248 offset:28928
  v_mfma_f32_16x16x32_bf16 v[228:231], v[188:191], v[244:247], v[228:231]
  ds_read_b64_tr_b16 v[208:209], v249 offset:28672
  ds_read_b64_tr_b16 v[210:211], v249 offset:28928
  v_mfma_f32_16x16x32_bf16 v[132:135], v[192:195], a[112:115], v[132:135]
  buffer_load_dwordx4 a[196:199], v10, s[44:47], s18 offen sc1
  v_mfma_f32_16x16x32_bf16 v[136:139], v[192:195], a[116:119], v[136:139]
  s_waitcnt lgkmcnt(4)
  v_xor_b32 v99, 0x80000000, v99
  v_mfma_f32_16x16x32_bf16 v[140:143], v[196:199], a[112:115], v[140:143]
  ds_read_b64_tr_b16 v[212:213], v250 offset:28672
  ds_read_b64_tr_b16 v[214:215], v250 offset:28928
  v_mfma_f32_16x16x32_bf16 v[144:147], v[196:199], a[116:119], v[144:147]
  ds_read_b64_tr_b16 v[216:217], v251 offset:28672
  ds_read_b64_tr_b16 v[218:219], v251 offset:28928
  v_mfma_f32_16x16x32_bf16 v[148:151], v[200:203], a[112:115], v[148:151]
  v_alignbit_b32 v100, v84, v84, 16
  v_xor_b32 v100, 0x80000000, v100
  v_mfma_f32_16x16x32_bf16 v[152:155], v[200:203], a[116:119], v[152:155]
  s_waitcnt lgkmcnt(4)
  s_waitcnt vmcnt(10)
  v_mfma_f32_16x16x32_bf16 v[124:127], v[204:207], a[120:123], v[124:127]
  s_barrier
  v_mfma_f32_16x16x32_bf16 v[128:131], v[204:207], a[124:127], v[128:131]
  ds_read_b64_tr_b16 v[188:189], v248 offset:32768
  ds_read_b64_tr_b16 v[190:191], v248 offset:33024
  v_mfma_f32_16x16x32_bf16 v[228:231], v[204:207], v[244:247], v[228:231]
  ds_read_b64_tr_b16 v[192:193], v249 offset:32768
  ds_read_b64_tr_b16 v[194:195], v249 offset:33024
  v_mfma_f32_16x16x32_bf16 v[132:135], v[208:211], a[120:123], v[132:135]
  s_add_u32 s17, s16, 163840
  v_alignbit_b32 v101, v85, v85, 16
  v_mfma_f32_16x16x32_bf16 v[136:139], v[208:211], a[124:127], v[136:139]
  s_waitcnt lgkmcnt(4)
  v_xor_b32 v101, 0x80000000, v101
  v_mfma_f32_16x16x32_bf16 v[140:143], v[212:215], a[120:123], v[140:143]
  ds_read_b64_tr_b16 v[196:197], v250 offset:32768
  ds_read_b64_tr_b16 v[198:199], v250 offset:33024
  v_mfma_f32_16x16x32_bf16 v[144:147], v[212:215], a[124:127], v[144:147]
  ds_read_b64_tr_b16 v[200:201], v251 offset:32768
  ds_read_b64_tr_b16 v[202:203], v251 offset:33024
  v_mfma_f32_16x16x32_bf16 v[148:151], v[216:219], a[120:123], v[148:151]
  buffer_load_dwordx4 a[200:203], v10, s[44:47], s17 offen offset:0 sc1
  v_mfma_f32_16x16x32_bf16 v[152:155], v[216:219], a[124:127], v[152:155]
  s_waitcnt lgkmcnt(4)
  s_add_u32 s18, s17, 4096
  v_mfma_f32_16x16x32_bf16 v[124:127], v[188:191], a[128:131], v[124:127]
  buffer_load_dword v56, v4, s[44:47], 0 offen  sc1
  v_mfma_f32_16x16x32_bf16 v[128:131], v[188:191], a[132:135], v[128:131]
  ds_read_b64_tr_b16 v[204:205], v248 offset:36864
  ds_read_b64_tr_b16 v[206:207], v248 offset:37120
  v_mfma_f32_16x16x32_bf16 v[228:231], v[188:191], v[244:247], v[228:231]
  ds_read_b64_tr_b16 v[208:209], v249 offset:36864
  ds_read_b64_tr_b16 v[210:211], v249 offset:37120
  v_mfma_f32_16x16x32_bf16 v[132:135], v[192:195], a[128:131], v[132:135]
  buffer_load_dwordx4 a[204:207], v10, s[44:47], s17 offen offset:1024 sc1
  v_mfma_f32_16x16x32_bf16 v[136:139], v[192:195], a[132:135], v[136:139]
  s_waitcnt lgkmcnt(4)
  v_alignbit_b32 v102, v86, v86, 16
  v_mfma_f32_16x16x32_bf16 v[140:143], v[196:199], a[128:131], v[140:143]
  ds_read_b64_tr_b16 v[212:213], v250 offset:36864
  ds_read_b64_tr_b16 v[214:215], v250 offset:37120
  v_mfma_f32_16x16x32_bf16 v[144:147], v[196:199], a[132:135], v[144:147]
  ds_read_b64_tr_b16 v[216:217], v251 offset:36864
  ds_read_b64_tr_b16 v[218:219], v251 offset:37120
  v_mfma_f32_16x16x32_bf16 v[148:151], v[200:203], a[128:131], v[148:151]
  v_xor_b32 v102, 0x80000000, v102
  v_alignbit_b32 v103, v87, v87, 16
  v_mfma_f32_16x16x32_bf16 v[152:155], v[200:203], a[132:135], v[152:155]
  s_waitcnt lgkmcnt(4)
  v_xor_b32 v103, 0x80000000, v103
  v_mfma_f32_16x16x32_bf16 v[124:127], v[204:207], a[136:139], v[124:127]
  buffer_load_dwordx4 a[208:211], v10, s[44:47], s17 offen offset:2048 sc1
  v_mfma_f32_16x16x32_bf16 v[128:131], v[204:207], a[140:143], v[128:131]
  ds_read_b64_tr_b16 v[188:189], v248 offset:40960
  ds_read_b64_tr_b16 v[190:191], v248 offset:41216
  v_mfma_f32_16x16x32_bf16 v[228:231], v[204:207], v[244:247], v[228:231]
  ds_read_b64_tr_b16 v[192:193], v249 offset:40960
  ds_read_b64_tr_b16 v[194:195], v249 offset:41216
  v_mfma_f32_16x16x32_bf16 v[132:135], v[208:211], a[136:139], v[132:135]
  buffer_load_dwordx4 a[212:215], v10, s[44:47], s17 offen offset:3072 sc1
  v_mfma_f32_16x16x32_bf16 v[136:139], v[208:211], a[140:143], v[136:139]
  s_waitcnt lgkmcnt(4)
  v_alignbit_b32 v104, v88, v88, 16
  v_mfma_f32_16x16x32_bf16 v[140:143], v[212:215], a[136:139], v[140:143]
  ds_read_b64_tr_b16 v[196:197], v250 offset:40960
  ds_read_b64_tr_b16 v[198:199], v250 offset:41216
  v_mfma_f32_16x16x32_bf16 v[144:147], v[212:215], a[140:143], v[144:147]
  ds_read_b64_tr_b16 v[200:201], v251 offset:40960
  ds_read_b64_tr_b16 v[202:203], v251 offset:41216
  v_mfma_f32_16x16x32_bf16 v[148:151], v[216:219], a[136:139], v[148:151]
  v_xor_b32 v104, 0x80000000, v104
  v_alignbit_b32 v105, v89, v89, 16
  v_mfma_f32_16x16x32_bf16 v[152:155], v[216:219], a[140:143], v[152:155]
  s_waitcnt lgkmcnt(4)
  v_xor_b32 v105, 0x80000000, v105
  v_mfma_f32_16x16x32_bf16 v[124:127], v[188:191], a[144:147], v[124:127]
  buffer_load_dwordx4 a[216:219], v10, s[44:47], s18 offen sc1
  v_mfma_f32_16x16x32_bf16 v[128:131], v[188:191], a[148:151], v[128:131]
  ds_read_b64_tr_b16 v[204:205], v248 offset:45056
  ds_read_b64_tr_b16 v[206:207], v248 offset:45312
  v_mfma_f32_16x16x32_bf16 v[228:231], v[188:191], v[244:247], v[228:231]
  ds_read_b64_tr_b16 v[208:209], v249 offset:45056
  ds_read_b64_tr_b16 v[210:211], v249 offset:45312
  v_mfma_f32_16x16x32_bf16 v[132:135], v[192:195], a[144:147], v[132:135]
  s_add_u32 s17, s16, 204800
  v_alignbit_b32 v106, v90, v90, 16
  v_mfma_f32_16x16x32_bf16 v[136:139], v[192:195], a[148:151], v[136:139]
  s_waitcnt lgkmcnt(4)
  v_xor_b32 v106, 0x80000000, v106
  v_mfma_f32_16x16x32_bf16 v[140:143], v[196:199], a[144:147], v[140:143]
  ds_read_b64_tr_b16 v[212:213], v250 offset:45056
  ds_read_b64_tr_b16 v[214:215], v250 offset:45312
  v_mfma_f32_16x16x32_bf16 v[144:147], v[196:199], a[148:151], v[144:147]
  ds_read_b64_tr_b16 v[216:217], v251 offset:45056
  ds_read_b64_tr_b16 v[218:219], v251 offset:45312
  v_mfma_f32_16x16x32_bf16 v[148:151], v[200:203], a[144:147], v[148:151]
  buffer_load_dwordx4 a[220:223], v10, s[44:47], s17 offen offset:0 sc1
  v_mfma_f32_16x16x32_bf16 v[152:155], v[200:203], a[148:151], v[152:155]
  s_waitcnt lgkmcnt(4)
  v_alignbit_b32 v107, v91, v91, 16
  v_mfma_f32_16x16x32_bf16 v[124:127], v[204:207], a[152:155], v[124:127]
  v_mfma_f32_16x16x32_bf16 v[128:131], v[204:207], a[156:159], v[128:131]
  v_mfma_f32_16x16x32_bf16 v[228:231], v[204:207], v[244:247], v[228:231]
  v_mfma_f32_16x16x32_bf16 v[132:135], v[208:211], a[152:155], v[132:135]
  v_mfma_f32_16x16x32_bf16 v[136:139], v[208:211], a[156:159], v[136:139]
  s_waitcnt lgkmcnt(0)
  v_mfma_f32_16x16x32_bf16 v[140:143], v[212:215], a[152:155], v[140:143]
  s_nop 3
  ds_write_b128 v2, v[228:231] offset:512
  v_mfma_f32_16x16x32_bf16 v[144:147], v[212:215], a[156:159], v[144:147]
  s_waitcnt lgkmcnt(0)
  s_barrier
  v_mfma_f32_16x16x32_bf16 v[148:151], v[216:219], a[152:155], v[148:151]
  ds_read_b128 v[156:159], v236 offset:512
  ds_read_b128 v[164:167], v238 offset:512
  v_mfma_f32_16x16x32_bf16 v[152:155], v[216:219], a[156:159], v[152:155]
  ds_read_b128 v[160:163], v237 offset:512
  ds_read_b128 v[168:171], v239 offset:512
  s_add_u32 s18, s17, 4096
  buffer_load_dwordx4 a[224:227], v10, s[44:47], s17 offen offset:1024 sc1
  buffer_load_dwordx4 a[228:231], v10, s[44:47], s17 offen offset:2048 sc1
  buffer_load_dwordx4 a[232:235], v10, s[44:47], s17 offen offset:3072 sc1
  buffer_load_dwordx4 a[236:239], v10, s[44:47], s18 offen sc1
  v_xor_b32 v107, 0x80000000, v107
  s_waitcnt vmcnt(9)
  v_cmp_le_u32 s[0:1], 1, v56
  s_nop 0
  s_cmp_eq_u64 s[0:1], exec
  s_cbranch_scc1 L_ok4
  s_mov_b32 s78, 65536
L_spin4:
  s_sleep 4
  buffer_load_dword v56, v4, s[44:47], 0 offen  sc1
  s_waitcnt vmcnt(0)
  v_cmp_le_u32 s[0:1], 1, v56
  s_nop 0
  s_cmp_eq_u64 s[0:1], exec
  s_cbranch_scc1 L_ok4
  s_sub_u32 s78, s78, 1
  s_cmp_lg_u32 s78, 0
  s_cbranch_scc1 L_spin4
L_ok4:
  s_add_u32 s22, s19, 0
  buffer_load_dwordx4 a[80:83], v25, s[44:47], s22 offen offset:0 sc1
  s_waitcnt lgkmcnt(3)
  v_pk_fma_f32 v[124:125], v[156:157], v[20:21], v[124:125] op_sel_hi:[1,0,1]
  v_pk_fma_f32 v[126:127], v[158:159], v[20:21], v[126:127] op_sel_hi:[1,0,1]
  s_waitcnt lgkmcnt(2)
  v_pk_fma_f32 v[140:141], v[164:165], v[20:21], v[140:141] op_sel_hi:[1,0,1]
  v_pk_fma_f32 v[142:143], v[166:167], v[20:21], v[142:143] op_sel_hi:[1,0,1]
  s_waitcnt lgkmcnt(1)
  v_pk_fma_f32 v[132:133], v[160:161], v[20:21], v[132:133] op_sel_hi:[1,0,1]
  v_pk_fma_f32 v[134:135], v[162:163], v[20:21], v[134:135] op_sel_hi:[1,0,1]
  s_waitcnt lgkmcnt(0)
  v_pk_fma_f32 v[148:149], v[168:169], v[20:21], v[148:149] op_sel_hi:[1,0,1]
  v_pk_fma_f32 v[150:151], v[170:171], v[20:21], v[150:151] op_sel_hi:[1,0,1]
  s_add_u32 s23, s22, s12
  buffer_load_dwordx4 a[84:87], v27, s[44:47], s22 offen offset:0 sc1
  v_pk_fma_f32 v[128:129], v[156:157], v[22:23], v[128:129] op_sel_hi:[1,0,1]
  v_pk_fma_f32 v[130:131], v[158:159], v[22:23], v[130:131] op_sel_hi:[1,0,1]
  v_pk_fma_f32 v[144:145], v[164:165], v[22:23], v[144:145] op_sel_hi:[1,0,1]
  v_pk_fma_f32 v[146:147], v[166:167], v[22:23], v[146:147] op_sel_hi:[1,0,1]
  v_pk_fma_f32 v[136:137], v[160:161], v[22:23], v[136:137] op_sel_hi:[1,0,1]
  v_pk_fma_f32 v[138:139], v[162:163], v[22:23], v[138:139] op_sel_hi:[1,0,1]
  v_pk_fma_f32 v[152:153], v[168:169], v[22:23], v[152:153] op_sel_hi:[1,0,1]
  v_pk_fma_f32 v[154:155], v[170:171], v[22:23], v[154:155] op_sel_hi:[1,0,1]
  buffer_load_dwordx4 a[88:91], v25, s[44:47], s23 offen offset:0 sc1
  s_cmp_lg_u32 s25, 0
  s_cbranch_scc1 L_sw5
  v_max_f32 v124, 0, v124
  v_max_f32 v125, 0, v125
  v_max_f32 v126, 0, v126
  v_max_f32 v127, 0, v127
  v_pk_mul_f32 v[140:141], v[140:141], v[24:25] op_sel_hi:[1,0]
  v_pk_mul_f32 v[142:143], v[142:143], v[24:25] op_sel_hi:[1,0]
  v_max_f32 v132, 0, v132
  v_max_f32 v133, 0, v133
  v_max_f32 v134, 0, v134
  v_max_f32 v135, 0, v135
  v_pk_mul_f32 v[148:149], v[148:149], v[24:25] op_sel_hi:[1,0]
  v_pk_mul_f32 v[150:151], v[150:151], v[24:25] op_sel_hi:[1,0]
  v_max_f32 v128, 0, v128
  v_max_f32 v129, 0, v129
  v_max_f32 v130, 0, v130
  v_max_f32 v131, 0, v131
  v_pk_mul_f32 v[144:145], v[144:145], v[26:27] op_sel_hi:[1,0]
  v_pk_mul_f32 v[146:147], v[146:147], v[26:27] op_sel_hi:[1,0]
  v_max_f32 v136, 0, v136
  v_max_f32 v137, 0, v137
  v_max_f32 v138, 0, v138
  v_max_f32 v139, 0, v139
  v_pk_mul_f32 v[152:153], v[152:153], v[26:27] op_sel_hi:[1,0]
  v_pk_mul_f32 v[154:155], v[154:155], v[26:27] op_sel_hi:[1,0]
  s_branch L_sj5
L_sw5:
  v_max_f32 v140, 0, v140
  v_max_f32 v141, 0, v141
  v_max_f32 v142, 0, v142
  v_max_f32 v143, 0, v143
  v_pk_mul_f32 v[124:125], v[124:125], v[24:25] op_sel_hi:[1,0]
  v_pk_mul_f32 v[126:127], v[126:127], v[24:25] op_sel_hi:[1,0]
  v_max_f32 v148, 0, v148
  v_max_f32 v149, 0, v149
  v_max_f32 v150, 0, v150
  v_max_f32 v151, 0, v151
  v_pk_mul_f32 v[132:133], v[132:133], v[24:25] op_sel_hi:[1,0]
  v_pk_mul_f32 v[134:135], v[134:135], v[24:25] op_sel_hi:[1,0]
  v_max_f32 v144, 0, v144
  v_max_f32 v145, 0, v145
  v_max_f32 v146, 0, v146
  v_max_f32 v147, 0, v147
  v_pk_mul_f32 v[128:129], v[128:129], v[26:27] op_sel_hi:[1,0]
  v_pk_mul_f32 v[130:131], v[130:131], v[26:27] op_sel_hi:[1,0]
  v_max_f32 v152, 0, v152
  v_max_f32 v153, 0, v153
  v_max_f32 v154, 0, v154
  v_max_f32 v155, 0, v155
  v_pk_mul_f32 v[136:137], v[136:137], v[26:27] op_sel_hi:[1,0]
  v_pk_mul_f32 v[138:139], v[138:139], v[26:27] op_sel_hi:[1,0]
L_sj5:
  buffer_load_dwordx4 a[92:95], v27, s[44:47], s23 offen offset:0 sc1
  v_pk_mul_f32 v[124:125], v[124:125], v[140:141]
  v_pk_mul_f32 v[126:127], v[126:127], v[142:143]
  v_cvt_pk_bf16_f32 v36, v124, v125
  v_cvt_pk_bf16_f32 v37, v126, v127
  s_add_u32 s22, s19, 2048
  buffer_load_dwordx4 a[96:99], v25, s[44:47], s22 offen offset:0 sc1
  v_pk_mul_f32 v[132:133], v[132:133], v[148:149]
  v_pk_mul_f32 v[134:135], v[134:135], v[150:151]
  v_cvt_pk_bf16_f32 v38, v132, v133
  v_cvt_pk_bf16_f32 v39, v134, v135
  v_pk_mul_f32 v[128:129], v[128:129], v[144:145]
  v_pk_mul_f32 v[130:131], v[130:131], v[146:147]
  v_cvt_pk_bf16_f32 v40, v128, v129
  v_cvt_pk_bf16_f32 v41, v130, v131
  s_add_u32 s23, s22, s12
  buffer_load_dwordx4 a[100:103], v27, s[44:47], s22 offen offset:0 sc1
  v_pk_mul_f32 v[136:137], v[136:137], v[152:153]
  v_pk_mul_f32 v[138:139], v[138:139], v[154:155]
  v_cvt_pk_bf16_f32 v42, v136, v137
  v_cvt_pk_bf16_f32 v43, v138, v139
  s_cmp_eq_u32 s24, 0
  s_cbranch_scc1 L_nosw
  v_swap_b32 v36, v38
  v_swap_b32 v37, v39
  v_swap_b32 v40, v42
  v_swap_b32 v41, v43
L_nosw:
  buffer_store_dwordx4 v[36:39], v10, s[44:47], s74 offen offset:0 sc1
  buffer_store_dwordx4 v[40:43], v10, s[44:47], s74 offen offset:1024 sc1
  s_cmp_ge_u32 s77, 21
  s_cbranch_scc1 L_nop2
  v_mfma_f32_16x16x32_bf16 v[156:159], a[0:3], v[76:79], 0
  ds_read_u16_d16_hi v108, v5 offset:0
  ds_read_u16_d16_hi v60, v5 offset:3072
  v_mfma_f32_16x16x32_bf16 v[172:175], a[0:3], v[92:95], 0
  buffer_load_dwordx4 a[104:107], v25, s[44:47], s23 offen offset:0 sc1
  v_mfma_f32_16x16x32_bf16 v[160:163], a[16:19], v[76:79], 0
  ds_read_u16_d16_hi v109, v5 offset:48
  ds_read_u16_d16_hi v61, v5 offset:3120
  v_mfma_f32_16x16x32_bf16 v[176:179], a[16:19], v[92:95], 0
  ds_read_u16_d16_hi v110, v5 offset:96
  ds_read_u16_d16_hi v62, v5 offset:3168
  v_mfma_f32_16x16x32_bf16 v[164:167], a[32:35], v[76:79], 0
  ds_read_u16_d16_hi v111, v5 offset:144
  ds_read_u16_d16_hi v63, v5 offset:3216
  v_mfma_f32_16x16x32_bf16 v[180:183], a[32:35], v[92:95], 0
  buffer_load_dwordx4 a[108:111], v27, s[44:47], s23 offen offset:0 sc1
  v_mfma_f32_16x16x32_bf16 v[168:171], a[48:51], v[76:79], 0
  ds_read_u16_d16_hi v112, v5 offset:768
  ds_read_u16_d16_hi v64, v5 offset:3840
  v_mfma_f32_16x16x32_bf16 v[184:187], a[48:51], v[92:95], 0
  ds_read_u16_d16_hi v113, v5 offset:816
  ds_read_u16_d16_hi v65, v5 offset:3888
  v_mfma_f32_16x16x32_bf16 v[156:159], a[4:7], v[80:83], v[156:159]
  s_add_u32 s22, s19, 8192
  ds_read_u16_d16_hi v114, v5 offset:864
  v_mfma_f32_16x16x32_bf16 v[172:175], a[4:7], v[96:99], v[172:175]
  buffer_load_dwordx4 a[112:115], v25, s[44:47], s22 offen offset:0 sc1
  v_mfma_f32_16x16x32_bf16 v[160:163], a[20:23], v[80:83], v[160:163]
  ds_read_u16_d16_hi v66, v5 offset:3936
  ds_read_u16_d16_hi v115, v5 offset:912
  v_mfma_f32_16x16x32_bf16 v[176:179], a[20:23], v[96:99], v[176:179]
  ds_read_u16_d16_hi v67, v5 offset:3984
  ds_read_u16_d16_hi v116, v5 offset:1536
  v_mfma_f32_16x16x32_bf16 v[164:167], a[36:39], v[80:83], v[164:167]
  s_add_u32 s23, s22, s12
  ds_read_u16_d16_hi v68, v5 offset:4608
  v_mfma_f32_16x16x32_bf16 v[180:183], a[36:39], v[96:99], v[180:183]
  buffer_load_dwordx4 a[116:119], v27, s[44:47], s22 offen offset:0 sc1
  v_mfma_f32_16x16x32_bf16 v[168:171], a[52:55], v[80:83], v[168:171]
  ds_read_u16_d16_hi v117, v5 offset:1584
  ds_read_u16_d16_hi v69, v5 offset:4656
  v_mfma_f32_16x16x32_bf16 v[184:187], a[52:55], v[96:99], v[184:187]
  ds_read_u16_d16_hi v118, v5 offset:1632
  ds_read_u16_d16_hi v70, v5 offset:4704
  v_mfma_f32_16x16x32_bf16 v[156:159], a[8:11], v[84:87], v[156:159]
  ds_read_u16_d16_hi v119, v5 offset:1680
  ds_read_u16_d16_hi v71, v5 offset:4752
  v_mfma_f32_16x16x32_bf16 v[172:175], a[8:11], v[100:103], v[172:175]
  buffer_load_dwordx4 a[120:123], v25, s[44:47], s23 offen offset:0 sc1
  v_mfma_f32_16x16x32_bf16 v[160:163], a[24:27], v[84:87], v[160:163]
  ds_read_u16_d16_hi v120, v5 offset:2304
  ds_read_u16_d16_hi v72, v5 offset:5376
  v_mfma_f32_16x16x32_bf16 v[176:179], a[24:27], v[100:103], v[176:179]
  ds_read_u16_d16_hi v121, v5 offset:2352
  ds_read_u16_d16_hi v73, v5 offset:5424
  v_mfma_f32_16x16x32_bf16 v[164:167], a[40:43], v[84:87], v[164:167]
  ds_read_u16_d16_hi v122, v5 offset:2400
  ds_read_u16_d16_hi v74, v5 offset:5472
  v_mfma_f32_16x16x32_bf16 v[180:183], a[40:43], v[100:103], v[180:183]
  buffer_load_dwordx4 a[124:127], v27, s[44:47], s23 offen offset:0 sc1
  v_mfma_f32_16x16x32_bf16 v[168:171], a[56:59], v[84:87], v[168:171]
  ds_read_u16_d16_hi v123, v5 offset:2448
  ds_read_u16_d16_hi v75, v5 offset:5520
  v_mfma_f32_16x16x32_bf16 v[184:187], a[56:59], v[100:103], v[184:187]
  v_mfma_f32_16x16x32_bf16 v[156:159], a[12:15], v[88:91], v[156:159]
  s_add_u32 s22, s19, 10240
  v_mfma_f32_16x16x32_bf16 v[172:175], a[12:15], v[104:107], v[172:175]
  buffer_load_dwordx4 a[128:131], v25, s[44:47], s22 offen offset:0 sc1
  v_mfma_f32_16x16x32_bf16 v[160:163], a[28:31], v[88:91], v[160:163]
  v_mfma_f32_16x16x32_bf16 v[176:179], a[28:31], v[104:107], v[176:179]
  v_mfma_f32_16x16x32_bf16 v[164:167], a[44:47], v[88:91], v[164:167]
  s_add_u32 s23, s22, s12
  v_mfma_f32_16x16x32_bf16 v[180:183], a[44:47], v[104:107], v[180:183]
  buffer_load_dwordx4 a[132:135], v27, s[44:47], s22 offen offset:0 sc1
  v_mfma_f32_16x16x32_bf16 v[168:171], a[60:63], v[88:91], v[168:171]
  v_mfma_f32_16x16x32_bf16 v[184:187], a[60:63], v[104:107], v[184:187]
  s_waitcnt lgkmcnt(15)
  v_mul_f32 v28, v156, v108
  v_mul_f32 v29, v156, v60
  v_fma_f32 v28, -v172, v60, v28
  v_fmac_f32 v29, v172, v108
  v_cvt_pk_bf16_f32 v188, v28, -v29
  v_cvt_pk_bf16_f32 v204, v29, v28
  v_mul_f32 v30, v157, v109
  v_mul_f32 v31, v157, v61
  v_fma_f32 v30, -v173, v61, v30
  v_fmac_f32 v31, v173, v109
  v_cvt_pk_bf16_f32 v189, v30, -v31
  v_cvt_pk_bf16_f32 v205, v31, v30
  v_mul_f32 v32, v158, v110
  v_mul_f32 v33, v158, v62
  v_fma_f32 v32, -v174, v62, v32
  v_fmac_f32 v33, v174, v110
  v_cvt_pk_bf16_f32 v190, v32, -v33
  v_cvt_pk_bf16_f32 v206, v33, v32
  v_mul_f32 v34, v159, v111
  v_mul_f32 v35, v159, v63
  v_fma_f32 v34, -v175, v63, v34
  v_fmac_f32 v35, v175, v111
  v_cvt_pk_bf16_f32 v191, v34, -v35
  v_cvt_pk_bf16_f32 v207, v35, v34
  buffer_load_dwordx4 a[136:139], v25, s[44:47], s23 offen offset:0 sc1
  v_mul_f32 v28, v160, v112
  v_mul_f32 v29, v160, v64
  v_fma_f32 v28, -v176, v64, v28
  v_fmac_f32 v29, v176, v112
  v_cvt_pk_bf16_f32 v192, v28, -v29
  v_cvt_pk_bf16_f32 v208, v29, v28
  v_mul_f32 v30, v161, v113
  v_mul_f32 v31, v161, v65
  v_fma_f32 v30, -v177, v65, v30
  v_fmac_f32 v31, v177, v113
  v_cvt_pk_bf16_f32 v193, v30, -v31
  v_cvt_pk_bf16_f32 v209, v31, v30
  v_mul_f32 v32, v162, v114
  v_mul_f32 v33, v162, v66
  v_fma_f32 v32, -v178, v66, v32
  v_fmac_f32 v33, v178, v114
  v_cvt_pk_bf16_f32 v194, v32, -v33
  v_cvt_pk_bf16_f32 v210, v33, v32
  v_mul_f32 v34, v163, v115
  v_mul_f32 v35, v163, v67
  v_fma_f32 v34, -v179, v67, v34
  v_fmac_f32 v35, v179, v115
  v_cvt_pk_bf16_f32 v195, v34, -v35
  v_cvt_pk_bf16_f32 v211, v35, v34
  buffer_load_dwordx4 a[140:143], v27, s[44:47], s23 offen offset:0 sc1
  v_mul_f32 v28, v164, v116
  s_waitcnt lgkmcnt(14)
  v_mul_f32 v29, v164, v68
  v_fma_f32 v28, -v180, v68, v28
  v_fmac_f32 v29, v180, v116
  v_cvt_pk_bf16_f32 v196, v28, -v29
  v_cvt_pk_bf16_f32 v212, v29, v28
  s_waitcnt lgkmcnt(13)
  v_mul_f32 v30, v165, v117
  s_waitcnt lgkmcnt(12)
  v_mul_f32 v31, v165, v69
  v_fma_f32 v30, -v181, v69, v30
  v_fmac_f32 v31, v181, v117
  v_cvt_pk_bf16_f32 v197, v30, -v31
  v_cvt_pk_bf16_f32 v213, v31, v30
  s_waitcnt lgkmcnt(11)
  v_mul_f32 v32, v166, v118
  s_waitcnt lgkmcnt(10)
  v_mul_f32 v33, v166, v70
  v_fma_f32 v32, -v182, v70, v32
  v_fmac_f32 v33, v182, v118
  v_cvt_pk_bf16_f32 v198, v32, -v33
  v_cvt_pk_bf16_f32 v214, v33, v32
  s_waitcnt lgkmcnt(9)
  v_mul_f32 v34, v167, v119
  s_waitcnt lgkmcnt(8)
  v_mul_f32 v35, v167, v71
  v_fma_f32 v34, -v183, v71, v34
  v_fmac_f32 v35, v183, v119
  v_cvt_pk_bf16_f32 v199, v34, -v35
  v_cvt_pk_bf16_f32 v215, v35, v34
  s_add_u32 s22, s19, 12288
  buffer_load_dwordx4 a[144:147], v25, s[44:47], s22 offen offset:0 sc1
  s_waitcnt lgkmcnt(7)
  v_mul_f32 v28, v168, v120
  s_waitcnt lgkmcnt(6)
  v_mul_f32 v29, v168, v72
  v_fma_f32 v28, -v184, v72, v28
  v_fmac_f32 v29, v184, v120
  v_cvt_pk_bf16_f32 v200, v28, -v29
  v_cvt_pk_bf16_f32 v216, v29, v28
  s_waitcnt lgkmcnt(5)
  v_mul_f32 v30, v169, v121
  s_waitcnt lgkmcnt(4)
  v_mul_f32 v31, v169, v73
  v_fma_f32 v30, -v185, v73, v30
  v_fmac_f32 v31, v185, v121
  v_cvt_pk_bf16_f32 v201, v30, -v31
  v_cvt_pk_bf16_f32 v217, v31, v30
  s_waitcnt lgkmcnt(3)
  v_mul_f32 v32, v170, v122
  s_waitcnt lgkmcnt(2)
  v_mul_f32 v33, v170, v74
  v_fma_f32 v32, -v186, v74, v32
  v_fmac_f32 v33, v186, v122
  v_cvt_pk_bf16_f32 v202, v32, -v33
  v_cvt_pk_bf16_f32 v218, v33, v32
  s_waitcnt lgkmcnt(1)
  v_mul_f32 v34, v171, v123
  s_waitcnt lgkmcnt(0)
  v_mul_f32 v35, v171, v75
  v_fma_f32 v34, -v187, v75, v34
  v_fmac_f32 v35, v187, v123
  v_cvt_pk_bf16_f32 v203, v34, -v35
  v_cvt_pk_bf16_f32 v219, v35, v34
  s_add_u32 s23, s22, s12
  buffer_load_dwordx4 a[148:151], v27, s[44:47], s22 offen offset:0 sc1
  s_waitcnt vmcnt(12)
  buffer_store_dword v253, v252, s[44:47], s27 offen sc1
  v_mfma_f32_16x16x32_bf16 v[156:159], a[0:3], v[188:191], 0
  v_and_b32 v36, 15, v0
  v_lshrrev_b32 v37, 4, v0
  v_mfma_f32_16x16x32_bf16 v[172:175], a[0:3], v[204:207], 0
  buffer_load_dwordx4 a[152:155], v25, s[44:47], s23 offen offset:0 sc1
  v_mfma_f32_16x16x32_bf16 v[160:163], a[16:19], v[188:191], 0
  v_lshlrev_b32 v38, 2, v37
  v_lshl_add_u32 v38, v36, 4, v38
  v_mfma_f32_16x16x32_bf16 v[176:179], a[16:19], v[204:207], 0
  s_lshl_b32 s5, s60, 10
  s_add_u32 s5, s5, 90112
  v_mfma_f32_16x16x32_bf16 v[164:167], a[32:35], v[188:191], 0
  v_add_u32 v16, s5, v38
  s_lshl_b32 s5, s60, 12
  v_mfma_f32_16x16x32_bf16 v[180:183], a[32:35], v[204:207], 0
  buffer_load_dwordx4 a[156:159], v27, s[44:47], s23 offen offset:0 sc1
  v_mfma_f32_16x16x32_bf16 v[168:171], a[48:51], v[188:191], 0
  s_add_u32 s5, s5, 90112
  v_add_u32 v7, s5, v10
  v_mfma_f32_16x16x32_bf16 v[184:187], a[48:51], v[204:207], 0
  s_lshl_b32 s5, s60, 4
  v_add_u32 v38, s5, v37
  v_mfma_f32_16x16x32_bf16 v[156:159], a[4:7], v[192:195], v[156:159]
  s_add_u32 s17, s16, 245760
  s_add_u32 m0, s75, 20480
  v_mfma_f32_16x16x32_bf16 v[172:175], a[4:7], v[208:211], v[172:175]
  buffer_load_dwordx4 v10, s[44:47], s17 offen offset:0 sc1 lds
  v_mfma_f32_16x16x32_bf16 v[160:163], a[20:23], v[192:195], v[160:163]
  v_mul_u32_u24 v38, 43008, v38
  v_lshl_add_u32 v17, v36, 4, v38
  v_mfma_f32_16x16x32_bf16 v[176:179], a[20:23], v[208:211], v[176:179]
  s_lshl_b32 s5, s82, 3
  s_add_u32 s5, s5, s81
  v_mfma_f32_16x16x32_bf16 v[164:167], a[36:39], v[192:195], v[164:167]
  s_lshl_b32 s6, s5, 8
  s_add_u32 s70, s6, 3145728
  v_mfma_f32_16x16x32_bf16 v[180:183], a[36:39], v[208:211], v[180:183]
  buffer_load_dwordx4 v10, s[44:47], s17 offen offset:1024 sc1 lds
  v_mfma_f32_16x16x32_bf16 v[168:171], a[52:55], v[192:195], v[168:171]
  s_mul_i32 s6, s60, 168
  s_add_u32 s5, s5, s6
  v_mfma_f32_16x16x32_bf16 v[184:187], a[52:55], v[208:211], v[184:187]
  s_lshl_b32 s5, s5, 2
  s_add_u32 s5, s5, 16263168
  v_mfma_f32_16x16x32_bf16 v[156:159], a[8:11], v[196:199], v[156:159]
  v_cmp_eq_u32 vcc, 0, v0
  v_mov_b32 v38, s5
  v_mfma_f32_16x16x32_bf16 v[172:175], a[8:11], v[212:215], v[172:175]
  buffer_load_dwordx4 v10, s[44:47], s17 offen offset:2048 sc1 lds
  v_mfma_f32_16x16x32_bf16 v[160:163], a[24:27], v[196:199], v[160:163]
  s_nop 0
  v_cndmask_b32 v6, v254, v38, vcc
  v_mfma_f32_16x16x32_bf16 v[176:179], a[24:27], v[212:215], v[176:179]
  v_and_b32 v44, 15, v0
  v_lshrrev_b32 v45, 4, v0
  v_mfma_f32_16x16x32_bf16 v[164:167], a[40:43], v[196:199], v[164:167]
  s_lshl_b32 s5, s79, 1
  s_add_u32 s4, s5, s25
  v_mfma_f32_16x16x32_bf16 v[180:183], a[40:43], v[212:215], v[180:183]
  buffer_load_dwordx4 v10, s[44:47], s17 offen offset:3072 sc1 lds
  v_mfma_f32_16x16x32_bf16 v[168:171], a[56:59], v[196:199], v[168:171]
  v_lshl_add_u32 v46, v44, 6, s4
  v_cvt_f32_u32 v46, v46
  v_mfma_f32_16x16x32_bf16 v[184:187], a[56:59], v[212:215], v[184:187]
  v_mul_f32 v46, 0x3a000000, v46
  s_lshl_b32 s5, s24, 4
  v_mfma_f32_16x16x32_bf16 v[156:159], a[12:15], v[200:203], v[156:159]
  s_add_u32 s17, s16, 249856
  s_add_u32 m0, s75, 24576
  v_mfma_f32_16x16x32_bf16 v[172:175], a[12:15], v[216:219], v[172:175]
  buffer_load_dwordx4 v10, s[44:47], s17 offen offset:0 sc1 lds
  v_mfma_f32_16x16x32_bf16 v[160:163], a[28:31], v[200:203], v[160:163]
  v_lshl_add_u32 v47, v45, 2, s5
  v_cvt_f32_u32 v47, v47
  v_mfma_f32_16x16x32_bf16 v[176:179], a[28:31], v[216:219], v[176:179]
  v_mul_f32 v47, v47, v46
  v_mfma_f32_16x16x32_bf16 v[164:167], a[44:47], v[200:203], v[164:167]
  s_add_u32 s17, s16, 286720
  s_add_u32 m0, s75, 65536
  v_mfma_f32_16x16x32_bf16 v[180:183], a[44:47], v[216:219], v[180:183]
  buffer_load_dwordx4 v10, s[44:47], s17 offen offset:0 sc1 lds
  v_mfma_f32_16x16x32_bf16 v[168:171], a[60:63], v[200:203], v[168:171]
  v_cos_f32 v48, v47
  v_mfma_f32_16x16x32_bf16 v[184:187], a[60:63], v[216:219], v[184:187]
  v_sin_f32 v49, v47
  s_cmp_eq_u32 s82, 20
  s_cbranch_scc1 L_t20
  v_cvt_pk_bf16_f32 v28, v156, v172
  v_cvt_pk_bf16_f32 v29, v157, v173
  v_cvt_pk_bf16_f32 v30, v158, v174
  v_cvt_pk_bf16_f32 v31, v159, v175
  ds_write_b128 v7, v[28:31] offset:0
  v_cvt_pk_bf16_f32 v32, v160, v176
  v_cvt_pk_bf16_f32 v33, v161, v177
  v_cvt_pk_bf16_f32 v34, v162, v178
  v_cvt_pk_bf16_f32 v35, v163, v179
  ds_write_b128 v7, v[32:35] offset:1024
  v_cvt_pk_bf16_f32 v36, v164, v180
  v_cvt_pk_bf16_f32 v37, v165, v181
  v_cvt_pk_bf16_f32 v38, v166, v182
  v_cvt_pk_bf16_f32 v39, v167, v183
  ds_write_b128 v7, v[36:39] offset:2048
  v_cvt_pk_bf16_f32 v40, v168, v184
  v_cvt_pk_bf16_f32 v41, v169, v185
  v_cvt_pk_bf16_f32 v42, v170, v186
  v_cvt_pk_bf16_f32 v43, v171, v187
  ds_write_b128 v7, v[40:43] offset:3072
  s_branch L_t20j
L_t20:
  v_cvt_pk_bf16_f32 v28, -v172, v156
  v_cvt_pk_bf16_f32 v29, -v173, v157
  v_cvt_pk_bf16_f32 v30, -v174, v158
  v_cvt_pk_bf16_f32 v31, -v175, v159
  ds_write_b128 v7, v[28:31] offset:0
  v_cvt_pk_bf16_f32 v32, -v176, v160
  v_cvt_pk_bf16_f32 v33, -v177, v161
  v_cvt_pk_bf16_f32 v34, -v178, v162
  v_cvt_pk_bf16_f32 v35, -v179, v163
  ds_write_b128 v7, v[32:35] offset:1024
  v_cvt_pk_bf16_f32 v36, -v180, v164
  v_cvt_pk_bf16_f32 v37, -v181, v165
  v_cvt_pk_bf16_f32 v38, -v182, v166
  v_cvt_pk_bf16_f32 v39, -v183, v167
  ds_write_b128 v7, v[36:39] offset:2048
  v_cvt_pk_bf16_f32 v40, -v184, v168
  v_cvt_pk_bf16_f32 v41, -v185, v169
  v_cvt_pk_bf16_f32 v42, -v186, v170
  v_cvt_pk_bf16_f32 v43, -v187, v171
  ds_write_b128 v7, v[40:43] offset:3072
L_t20j:
  buffer_load_dwordx4 v10, s[44:47], s17 offen offset:1024 sc1 lds
  buffer_load_dwordx4 v10, s[44:47], s17 offen offset:2048 sc1 lds
  buffer_load_dwordx4 v10, s[44:47], s17 offen offset:3072 sc1 lds
  s_waitcnt lgkmcnt(0)
  s_barrier
  ds_read2st64_b32 v[156:157], v16 offset0:0 offset1:16
  ds_read2st64_b32 v[158:159], v16 offset0:32 offset1:48
  ds_read2st64_b32 v[160:161], v16 offset0:1 offset1:17
  ds_read2st64_b32 v[162:163], v16 offset0:33 offset1:49
  ds_read2st64_b32 v[164:165], v16 offset0:2 offset1:18
  ds_read2st64_b32 v[166:167], v16 offset0:34 offset1:50
  ds_read2st64_b32 v[168:169], v16 offset0:3 offset1:19
  ds_read2st64_b32 v[170:171], v16 offset0:35 offset1:51
  s_add_u32 s17, s16, 290816
  s_add_u32 m0, s75, 69632
  s_nop 0
  buffer_load_dwordx4 v10, s[44:47], s17 offen offset:0 sc1 lds
  s_waitcnt lgkmcnt(6)
  buffer_store_dwordx4 v[156:159], v17, s[44:47], s70 offen sc1
  s_add_u32 s70, s70, 172032
  s_waitcnt lgkmcnt(4)
  buffer_store_dwordx4 v[160:163], v17, s[44:47], s70 offen sc1
  s_add_u32 s70, s70, 172032
  s_waitcnt lgkmcnt(2)
  buffer_store_dwordx4 v[164:167], v17, s[44:47], s70 offen sc1
  s_add_u32 s70, s70, 172032
  s_waitcnt lgkmcnt(0)
  buffer_store_dwordx4 v[168:171], v17, s[44:47], s70 offen sc1
  v_mfma_f32_16x16x32_bf16 v[188:191], a[160:163], a[80:83], 0
  v_add_f32 v47, v47, v46
  v_cvt_pk_bf16_f32 v124, v48, -v49
  v_mfma_f32_16x16x32_bf16 v[192:195], a[164:167], a[80:83], 0
  v_cvt_pk_bf16_f32 v128, v49, v48
  v_cvt_pk_bf16_f32 v132, v48, -v49
  v_mfma_f32_16x16x32_bf16 v[196:199], a[168:171], a[80:83], 0
  v_cvt_pk_bf16_f32 v136, v49, v48
  v_mfma_f32_16x16x32_bf16 v[200:203], a[172:175], a[80:83], 0
  v_cos_f32 v48, v47
  v_mfma_f32_16x16x32_bf16 v[204:207], a[176:179], a[80:83], 0
  v_sin_f32 v49, v47
  v_mfma_f32_16x16x32_bf16 v[60:63], a[160:163], a[84:87], 0
  v_add_f32 v47, v47, v46
  v_cvt_pk_bf16_f32 v125, v48, -v49
  v_mfma_f32_16x16x32_bf16 v[64:67], a[164:167], a[84:87], 0
  v_cvt_pk_bf16_f32 v129, v49, v48
  v_cvt_pk_bf16_f32 v133, -v48, v49
  v_mfma_f32_16x16x32_bf16 v[68:71], a[168:171], a[84:87], 0
  v_mfma_f32_16x16x32_bf16 v[72:75], a[172:175], a[84:87], 0
  v_mfma_f32_16x16x32_bf16 v[76:79], a[176:179], a[84:87], 0
  v_mfma_f32_16x16x32_bf16 v[80:83], a[160:163], a[88:91], 0
  v_mfma_f32_16x16x32_bf16 v[84:87], a[164:167], a[88:91], 0
  v_mfma_f32_16x16x32_bf16 v[88:91], a[168:171], a[88:91], 0
  v_mfma_f32_16x16x32_bf16 v[92:95], a[172:175], a[88:91], 0
  v_mfma_f32_16x16x32_bf16 v[96:99], a[176:179], a[88:91], 0
  v_mfma_f32_16x16x32_bf16 v[100:103], a[160:163], a[92:95], 0
  v_mfma_f32_16x16x32_bf16 v[104:107], a[164:167], a[92:95], 0
  v_mfma_f32_16x16x32_bf16 v[108:111], a[168:171], a[92:95], 0
  v_mfma_f32_16x16x32_bf16 v[112:115], a[172:175], a[92:95], 0
  v_mfma_f32_16x16x32_bf16 v[116:119], a[176:179], a[92:95], 0
  v_mfma_f32_16x16x32_bf16 v[188:191], a[180:183], a[96:99], v[188:191]
  s_add_u32 s22, s19, 14336
  s_waitcnt vmcnt(9)
  v_mfma_f32_16x16x32_bf16 v[192:195], a[184:187], a[96:99], v[192:195]
  ds_read_b128 a[160:163], v1 offset:20480
  ds_read_b128 a[164:167], v1 offset:21504
  v_mfma_f32_16x16x32_bf16 v[196:199], a[188:191], a[96:99], v[196:199]
  ds_read_b128 a[168:171], v1 offset:22528
  ds_read_b128 a[172:175], v1 offset:23552
  v_mfma_f32_16x16x32_bf16 v[200:203], a[192:195], a[96:99], v[200:203]
  ds_read_b128 a[176:179], v1 offset:24576
  v_cvt_pk_bf16_f32 v137, -v49, -v48
  v_mfma_f32_16x16x32_bf16 v[204:207], a[196:199], a[96:99], v[204:207]
  buffer_load_dwordx4 a[80:83], v25, s[44:47], s22 offen offset:0 sc1
  v_mfma_f32_16x16x32_bf16 v[60:63], a[180:183], a[100:103], v[60:63]
  s_add_u32 s23, s22, s12
  v_mfma_f32_16x16x32_bf16 v[64:67], a[184:187], a[100:103], v[64:67]
  v_cos_f32 v48, v47
  v_mfma_f32_16x16x32_bf16 v[68:71], a[188:191], a[100:103], v[68:71]
  v_sin_f32 v49, v47
  v_mfma_f32_16x16x32_bf16 v[72:75], a[192:195], a[100:103], v[72:75]
  buffer_load_dwordx4 a[84:87], v27, s[44:47], s22 offen offset:0 sc1
  v_mfma_f32_16x16x32_bf16 v[76:79], a[196:199], a[100:103], v[76:79]
  v_add_f32 v47, v47, v46
  v_cvt_pk_bf16_f32 v126, v48, -v49
  v_mfma_f32_16x16x32_bf16 v[80:83], a[180:183], a[104:107], v[80:83]
  v_cvt_pk_bf16_f32 v130, v49, v48
  v_cvt_pk_bf16_f32 v134, v48, -v49
  v_mfma_f32_16x16x32_bf16 v[84:87], a[184:187], a[104:107], v[84:87]
  v_cvt_pk_bf16_f32 v138, v49, v48
  v_mfma_f32_16x16x32_bf16 v[88:91], a[188:191], a[104:107], v[88:91]
  buffer_load_dwordx4 a[88:91], v25, s[44:47], s23 offen offset:0 sc1
  v_mfma_f32_16x16x32_bf16 v[92:95], a[192:195], a[104:107], v[92:95]
  v_cos_f32 v48, v47
  v_mfma_f32_16x16x32_bf16 v[96:99], a[196:199], a[104:107], v[96:99]
  v_sin_f32 v49, v47
  v_mfma_f32_16x16x32_bf16 v[100:103], a[180:183], a[108:111], v[100:103]
  v_mfma_f32_16x16x32_bf16 v[104:107], a[184:187], a[108:111], v[104:107]
  buffer_load_dwordx4 a[92:95], v27, s[44:47], s23 offen offset:0 sc1
  v_mfma_f32_16x16x32_bf16 v[108:111], a[188:191], a[108:111], v[108:111]
  v_mfma_f32_16x16x32_bf16 v[112:115], a[192:195], a[108:111], v[112:115]
  v_mfma_f32_16x16x32_bf16 v[116:119], a[196:199], a[108:111], v[116:119]
  s_waitcnt vmcnt(4)
  buffer_store_dword v253, v6, s[44:47], 0 offen sc1
  v_mfma_f32_16x16x32_bf16 v[188:191], a[200:203], a[112:115], v[188:191]
  s_add_u32 s22, s19, 20480
  v_mfma_f32_16x16x32_bf16 v[192:195], a[204:207], a[112:115], v[192:195]
  ds_read_b128 a[180:183], v18 offset:0
  ds_read_b128 a[184:187], v18 offset:1024
  v_mfma_f32_16x16x32_bf16 v[196:199], a[208:211], a[112:115], v[196:199]
  ds_read_b128 a[188:191], v18 offset:2048
  ds_read_b128 a[192:195], v18 offset:3072
  v_mfma_f32_16x16x32_bf16 v[200:203], a[212:215], a[112:115], v[200:203]
  ds_read_b128 a[196:199], v18 offset:4096
  v_add_f32 v47, v47, v46
  v_mfma_f32_16x16x32_bf16 v[204:207], a[216:219], a[112:115], v[204:207]
  buffer_load_dwordx4 a[96:99], v25, s[44:47], s22 offen offset:0 sc1
  v_mfma_f32_16x16x32_bf16 v[60:63], a[200:203], a[116:119], v[60:63]
  s_add_u32 s23, s22, s12
  v_cvt_pk_bf16_f32 v127, v48, -v49
  v_mfma_f32_16x16x32_bf16 v[64:67], a[204:207], a[116:119], v[64:67]
  v_cvt_pk_bf16_f32 v131, v49, v48
  v_cvt_pk_bf16_f32 v135, -v48, v49
  v_mfma_f32_16x16x32_bf16 v[68:71], a[208:211], a[116:119], v[68:71]
  v_cvt_pk_bf16_f32 v139, -v49, -v48
  v_add_u32 v241, s26, v10
  v_mfma_f32_16x16x32_bf16 v[72:75], a[212:215], a[116:119], v[72:75]
  buffer_load_dwordx4 a[100:103], v27, s[44:47], s22 offen offset:0 sc1
  v_mfma_f32_16x16x32_bf16 v[76:79], a[216:219], a[116:119], v[76:79]
  ds_write_b128 v241, v[124:127] offset:0
  v_mfma_f32_16x16x32_bf16 v[80:83], a[200:203], a[120:123], v[80:83]
  ds_write_b128 v241, v[128:131] offset:1024
  v_mfma_f32_16x16x32_bf16 v[84:87], a[204:207], a[120:123], v[84:87]
  ds_write_b128 v241, v[132:135] offset:2048
  v_mfma_f32_16x16x32_bf16 v[88:91], a[208:211], a[120:123], v[88:91]
  buffer_load_dwordx4 a[104:107], v25, s[44:47], s23 offen offset:0 sc1
  v_mfma_f32_16x16x32_bf16 v[92:95], a[212:215], a[120:123], v[92:95]
  ds_write_b128 v241, v[136:139] offset:3072
  v_mfma_f32_16x16x32_bf16 v[96:99], a[216:219], a[120:123], v[96:99]
  v_mfma_f32_16x16x32_bf16 v[100:103], a[200:203], a[124:127], v[100:103]
  v_mfma_f32_16x16x32_bf16 v[104:107], a[204:207], a[124:127], v[104:107]
  buffer_load_dwordx4 a[108:111], v27, s[44:47], s23 offen offset:0 sc1
  v_mfma_f32_16x16x32_bf16 v[108:111], a[208:211], a[124:127], v[108:111]
  v_mfma_f32_16x16x32_bf16 v[112:115], a[212:215], a[124:127], v[112:115]
  v_mfma_f32_16x16x32_bf16 v[116:119], a[216:219], a[124:127], v[116:119]
  s_waitcnt lgkmcnt(0)
  s_barrier
  buffer_load_dword v56, v4, s[44:47], s27 offen  sc1
  v_mfma_f32_16x16x32_bf16 v[188:191], a[220:223], a[128:131], v[188:191]
  s_add_u32 s17, s16, 409600
  s_xor_b32 s5, s25, 0
  v_mfma_f32_16x16x32_bf16 v[192:195], a[224:227], a[128:131], v[192:195]
  s_mul_i32 s5, s5, 12288
  s_lshl_b32 s6, s24, 11
  v_mfma_f32_16x16x32_bf16 v[196:199], a[228:231], a[128:131], v[196:199]
  buffer_load_dwordx4 a[200:203], v10, s[44:47], s17 offen offset:0 sc1
  v_mfma_f32_16x16x32_bf16 v[200:203], a[232:235], a[128:131], v[200:203]
  s_add_u32 s18, s17, 4096
  s_add_u32 s5, s5, s6
  v_mfma_f32_16x16x32_bf16 v[204:207], a[236:239], a[128:131], v[204:207]
  buffer_load_dwordx4 a[204:207], v10, s[44:47], s17 offen offset:1024 sc1
  v_mfma_f32_16x16x32_bf16 v[60:63], a[220:223], a[132:135], v[60:63]
  s_add_u32 s5, s5, 40960
  v_add_u32 v242, s5, v10
  v_mfma_f32_16x16x32_bf16 v[64:67], a[224:227], a[132:135], v[64:67]
  buffer_load_dwordx4 a[208:211], v10, s[44:47], s17 offen offset:2048 sc1
  v_mfma_f32_16x16x32_bf16 v[68:71], a[228:231], a[132:135], v[68:71]
  v_xor_b32 v243, 2048, v242
  s_xor_b32 s5, s25, 1
  v_mfma_f32_16x16x32_bf16 v[72:75], a[232:235], a[132:135], v[72:75]
  buffer_load_dwordx4 a[212:215], v10, s[44:47], s17 offen offset:3072 sc1
  v_mfma_f32_16x16x32_bf16 v[76:79], a[236:239], a[132:135], v[76:79]
  s_mul_i32 s5, s5, 12288
  v_mfma_f32_16x16x32_bf16 v[80:83], a[220:223], a[136:139], v[80:83]
  buffer_load_dwordx4 a[216:219], v10, s[44:47], s18 offen sc1
  v_mfma_f32_16x16x32_bf16 v[84:87], a[224:227], a[136:139], v[84:87]
  s_add_u32 s22, s19, 22528
  v_mfma_f32_16x16x32_bf16 v[88:91], a[228:231], a[136:139], v[88:91]
  buffer_load_dwordx4 a[112:115], v25, s[44:47], s22 offen offset:0 sc1
  v_mfma_f32_16x16x32_bf16 v[92:95], a[232:235], a[136:139], v[92:95]
  s_add_u32 s23, s22, s12
  v_mfma_f32_16x16x32_bf16 v[96:99], a[236:239], a[136:139], v[96:99]
  buffer_load_dwordx4 a[116:119], v27, s[44:47], s22 offen offset:0 sc1
  v_mfma_f32_16x16x32_bf16 v[100:103], a[220:223], a[140:143], v[100:103]
  v_mfma_f32_16x16x32_bf16 v[104:107], a[224:227], a[140:143], v[104:107]
  buffer_load_dwordx4 a[120:123], v25, s[44:47], s23 offen offset:0 sc1
  v_mfma_f32_16x16x32_bf16 v[108:111], a[228:231], a[140:143], v[108:111]
  v_mfma_f32_16x16x32_bf16 v[112:115], a[232:235], a[140:143], v[112:115]
  buffer_load_dwordx4 a[124:127], v27, s[44:47], s23 offen offset:0 sc1
  v_mfma_f32_16x16x32_bf16 v[116:119], a[236:239], a[140:143], v[116:119]
  s_waitcnt vmcnt(9)
  v_cmp_le_u32 s[0:1], 1, v56
  s_nop 0
  s_cmp_eq_u64 s[0:1], exec
  s_cbranch_scc1 L_ok6
  s_mov_b32 s78, 65536
L_spin6:
  s_sleep 4
  buffer_load_dword v56, v4, s[44:47], s27 offen  sc1
  s_waitcnt vmcnt(0)
  v_cmp_le_u32 s[0:1], 1, v56
  s_nop 0
  s_cmp_eq_u64 s[0:1], exec
  s_cbranch_scc1 L_ok6
  s_sub_u32 s78, s78, 1
  s_cmp_lg_u32 s78, 0
  s_cbranch_scc1 L_spin6
L_ok6:
  v_mfma_f32_16x16x32_bf16 v[188:191], a[160:163], a[144:147], v[188:191]
  s_add_u32 s17, s16, 450560
  s_lshl_b32 s6, s24, 11
  v_mfma_f32_16x16x32_bf16 v[192:195], a[164:167], a[144:147], v[192:195]
  s_add_u32 s5, s5, s6
  s_add_u32 s5, s5, 40960
  v_mfma_f32_16x16x32_bf16 v[196:199], a[168:171], a[144:147], v[196:199]
  buffer_load_dwordx4 a[220:223], v10, s[44:47], s17 offen offset:0 sc1
  v_mfma_f32_16x16x32_bf16 v[200:203], a[172:175], a[144:147], v[200:203]
  s_add_u32 s18, s17, 4096
  v_add_u32 v244, s5, v10
  v_mfma_f32_16x16x32_bf16 v[204:207], a[176:179], a[144:147], v[204:207]
  buffer_load_dwordx4 a[224:227], v10, s[44:47], s17 offen offset:1024 sc1
  v_mfma_f32_16x16x32_bf16 v[60:63], a[160:163], a[148:151], v[60:63]
  v_xor_b32 v245, 2048, v244
  v_mul_u32_u24 v46, 81920, v44
  v_mfma_f32_16x16x32_bf16 v[64:67], a[164:167], a[148:151], v[64:67]
  buffer_load_dwordx4 a[228:231], v10, s[44:47], s17 offen offset:2048 sc1
  v_mfma_f32_16x16x32_bf16 v[68:71], a[168:171], a[148:151], v[68:71]
  v_add_u32 v46, s64, v46
  v_lshl_add_u32 v236, v45, 3, v46
  v_mfma_f32_16x16x32_bf16 v[72:75], a[172:175], a[148:151], v[72:75]
  buffer_load_dwordx4 a[232:235], v10, s[44:47], s17 offen offset:3072 sc1
  v_mfma_f32_16x16x32_bf16 v[76:79], a[176:179], a[148:151], v[76:79]
  v_and_b32 v47, 1, v45
  v_mfma_f32_16x16x32_bf16 v[80:83], a[160:163], a[152:155], v[80:83]
  buffer_load_dwordx4 a[236:239], v10, s[44:47], s18 offen sc1
  v_mfma_f32_16x16x32_bf16 v[84:87], a[164:167], a[152:155], v[84:87]
  s_add_u32 s22, s19, 4096
  v_mfma_f32_16x16x32_bf16 v[88:91], a[168:171], a[152:155], v[88:91]
  buffer_load_dwordx4 a[128:131], v25, s[44:47], s22 offen offset:0 sc1
  v_mfma_f32_16x16x32_bf16 v[92:95], a[172:175], a[152:155], v[92:95]
  s_add_u32 s23, s22, s12
  v_mfma_f32_16x16x32_bf16 v[96:99], a[176:179], a[152:155], v[96:99]
  buffer_load_dwordx4 a[132:135], v27, s[44:47], s22 offen offset:0 sc1
  v_mfma_f32_16x16x32_bf16 v[100:103], a[160:163], a[156:159], v[100:103]
  v_mfma_f32_16x16x32_bf16 v[104:107], a[164:167], a[156:159], v[104:107]
  buffer_load_dwordx4 a[136:139], v25, s[44:47], s23 offen offset:0 sc1
  v_mfma_f32_16x16x32_bf16 v[108:111], a[168:171], a[156:159], v[108:111]
  v_mfma_f32_16x16x32_bf16 v[112:115], a[172:175], a[156:159], v[112:115]
  buffer_load_dwordx4 a[140:143], v27, s[44:47], s23 offen offset:0 sc1
  v_mfma_f32_16x16x32_bf16 v[116:119], a[176:179], a[156:159], v[116:119]
  v_mfma_f32_16x16x32_bf16 v[188:191], a[180:183], a[80:83], v[188:191]
  s_add_u32 s17, s16, 81920
  v_lshl_add_u32 v46, v47, 5, v46
  v_mfma_f32_16x16x32_bf16 v[192:195], a[184:187], a[80:83], v[192:195]
  v_lshrrev_b32 v47, 1, v45
  v_lshl_add_u32 v235, v47, 4, v46
  v_mfma_f32_16x16x32_bf16 v[196:199], a[188:191], a[80:83], v[196:199]
  buffer_load_dwordx4 a[160:163], v10, s[44:47], s17 offen offset:0 sc1
  v_mfma_f32_16x16x32_bf16 v[200:203], a[192:195], a[80:83], v[200:203]
  s_add_u32 s18, s17, 4096
  v_lshrrev_b32 v46, 3, v0
  v_mfma_f32_16x16x32_bf16 v[204:207], a[196:199], a[80:83], v[204:207]
  buffer_load_dwordx4 a[164:167], v10, s[44:47], s17 offen offset:1024 sc1
  v_mfma_f32_16x16x32_bf16 v[60:63], a[180:183], a[84:87], v[60:63]
  v_cmp_lt_u32 vcc, 4, v46
  s_mul_i32 s5, s60, 5
  v_mfma_f32_16x16x32_bf16 v[64:67], a[184:187], a[84:87], v[64:67]
  buffer_load_dwordx4 a[168:171], v10, s[44:47], s17 offen offset:2048 sc1
  v_mfma_f32_16x16x32_bf16 v[68:71], a[188:191], a[84:87], v[68:71]
  v_add_u32 v46, s5, v46
  v_and_b32 v47, 7, v0
  v_mfma_f32_16x16x32_bf16 v[72:75], a[192:195], a[84:87], v[72:75]
  buffer_load_dwordx4 a[172:175], v10, s[44:47], s17 offen offset:3072 sc1
  v_mfma_f32_16x16x32_bf16 v[76:79], a[196:199], a[84:87], v[76:79]
  v_cndmask_b32 v46, v46, 20, vcc
  v_mfma_f32_16x16x32_bf16 v[80:83], a[180:183], a[88:91], v[80:83]
  buffer_load_dwordx4 a[176:179], v10, s[44:47], s18 offen sc1
  v_mfma_f32_16x16x32_bf16 v[84:87], a[184:187], a[88:91], v[84:87]
  s_add_u32 s22, s19, 6144
  v_mfma_f32_16x16x32_bf16 v[88:91], a[188:191], a[88:91], v[88:91]
  buffer_load_dwordx4 a[144:147], v25, s[44:47], s22 offen offset:0 sc1
  v_mfma_f32_16x16x32_bf16 v[92:95], a[192:195], a[88:91], v[92:95]
  s_add_u32 s23, s22, s12
  v_mfma_f32_16x16x32_bf16 v[96:99], a[196:199], a[88:91], v[96:99]
  buffer_load_dwordx4 a[148:151], v27, s[44:47], s22 offen offset:0 sc1
  v_mfma_f32_16x16x32_bf16 v[100:103], a[180:183], a[92:95], v[100:103]
  v_mfma_f32_16x16x32_bf16 v[104:107], a[184:187], a[92:95], v[104:107]
  buffer_load_dwordx4 a[152:155], v25, s[44:47], s23 offen offset:0 sc1
  v_mfma_f32_16x16x32_bf16 v[108:111], a[188:191], a[92:95], v[108:111]
  v_mfma_f32_16x16x32_bf16 v[112:115], a[192:195], a[92:95], v[112:115]
  buffer_load_dwordx4 a[156:159], v27, s[44:47], s23 offen offset:0 sc1
  v_mfma_f32_16x16x32_bf16 v[116:119], a[196:199], a[92:95], v[116:119]
  s_waitcnt vmcnt(26)
  v_mfma_f32_16x16x32_bf16 v[188:191], a[200:203], a[96:99], v[188:191]
  s_add_u32 s17, s16, 122880
  s_lshr_b32 s5, s79, 3
  s_waitcnt vmcnt(25)
  v_mfma_f32_16x16x32_bf16 v[192:195], a[204:207], a[96:99], v[192:195]
  s_mul_i32 s5, s5, 672
  s_add_u32 s5, s5, 16263168
  s_waitcnt vmcnt(24)
  v_mfma_f32_16x16x32_bf16 v[196:199], a[208:211], a[96:99], v[196:199]
  v_lshl_add_u32 v46, v46, 3, v47
  v_lshl_add_u32 v240, v46, 2, s5
  s_waitcnt vmcnt(23)
  v_mfma_f32_16x16x32_bf16 v[200:203], a[212:215], a[96:99], v[200:203]
  v_cmp_eq_u32 vcc, 0, v44
  v_add_u32 v46, 40960, v10
  s_waitcnt vmcnt(22)
  v_mfma_f32_16x16x32_bf16 v[204:207], a[216:219], a[96:99], v[204:207]
  buffer_load_dwordx4 a[180:183], v10, s[44:47], s17 offen offset:0 sc1
  v_mfma_f32_16x16x32_bf16 v[60:63], a[200:203], a[100:103], v[60:63]
  s_add_u32 s18, s17, 4096
  v_and_b32 v47, 1, v0
  v_mfma_f32_16x16x32_bf16 v[64:67], a[204:207], a[100:103], v[64:67]
  v_cndmask_b32 v237, v10, v46, vcc
  v_mfma_f32_16x16x32_bf16 v[68:71], a[208:211], a[100:103], v[68:71]
  v_mfma_f32_16x16x32_bf16 v[72:75], a[212:215], a[100:103], v[72:75]
  buffer_load_dwordx4 a[184:187], v10, s[44:47], s17 offen offset:1024 sc1
  v_mfma_f32_16x16x32_bf16 v[76:79], a[216:219], a[100:103], v[76:79]
  v_mfma_f32_16x16x32_bf16 v[80:83], a[200:203], a[104:107], v[80:83]
  v_mfma_f32_16x16x32_bf16 v[84:87], a[204:207], a[104:107], v[84:87]
  v_mfma_f32_16x16x32_bf16 v[88:91], a[208:211], a[104:107], v[88:91]
  buffer_load_dwordx4 a[188:191], v10, s[44:47], s17 offen offset:2048 sc1
  v_mfma_f32_16x16x32_bf16 v[92:95], a[212:215], a[104:107], v[92:95]
  v_mfma_f32_16x16x32_bf16 v[96:99], a[216:219], a[104:107], v[96:99]
  v_mfma_f32_16x16x32_bf16 v[100:103], a[200:203], a[108:111], v[100:103]
  v_mfma_f32_16x16x32_bf16 v[104:107], a[204:207], a[108:111], v[104:107]
  buffer_load_dwordx4 a[192:195], v10, s[44:47], s17 offen offset:3072 sc1
  v_mfma_f32_16x16x32_bf16 v[108:111], a[208:211], a[108:111], v[108:111]
  v_mfma_f32_16x16x32_bf16 v[112:115], a[212:215], a[108:111], v[112:115]
  v_mfma_f32_16x16x32_bf16 v[116:119], a[216:219], a[108:111], v[116:119]
  buffer_load_dwordx4 a[196:199], v10, s[44:47], s18 offen sc1
  buffer_load_dword v57, v240, s[44:47], 0 offen  sc1
  s_waitcnt vmcnt(23)
  v_mfma_f32_16x16x32_bf16 v[188:191], a[220:223], a[112:115], v[188:191]
  s_add_u32 s22, s19, 16384
  v_lshlrev_b32 v47, 4, v47
  s_waitcnt vmcnt(22)
  v_mfma_f32_16x16x32_bf16 v[192:195], a[224:227], a[112:115], v[192:195]
  v_mov_b32 v46, 0x3f80
  v_lshlrev_b32 v46, v47, v46
  s_waitcnt vmcnt(21)
  v_mfma_f32_16x16x32_bf16 v[196:199], a[228:231], a[112:115], v[196:199]
  buffer_load_dwordx4 a[80:83], v25, s[44:47], s22 offen offset:0 sc1
  s_waitcnt vmcnt(21)
  v_mfma_f32_16x16x32_bf16 v[200:203], a[232:235], a[112:115], v[200:203]
  s_add_u32 s23, s22, s12
  v_lshrrev_b32 v47, 1, v44
  s_waitcnt vmcnt(20)
  v_mfma_f32_16x16x32_bf16 v[204:207], a[236:239], a[112:115], v[204:207]
  buffer_load_dwordx4 a[84:87], v27, s[44:47], s22 offen offset:0 sc1
  v_mfma_f32_16x16x32_bf16 v[60:63], a[220:223], a[116:119], v[60:63]
  v_lshlrev_b32 v48, 1, v45
  v_sub_u32 v47, v47, v48
  v_mfma_f32_16x16x32_bf16 v[64:67], a[224:227], a[116:119], v[64:67]
  buffer_load_dwordx4 a[88:91], v25, s[44:47], s23 offen offset:0 sc1
  v_mfma_f32_16x16x32_bf16 v[68:71], a[228:231], a[116:119], v[68:71]
  v_cmp_eq_u32 vcc, 0, v47
  v_mul_u32_u24 v48, 160, v44
  v_mfma_f32_16x16x32_bf16 v[72:75], a[232:235], a[116:119], v[72:75]
  buffer_load_dwordx4 a[92:95], v27, s[44:47], s23 offen offset:0 sc1
  v_mfma_f32_16x16x32_bf16 v[76:79], a[236:239], a[116:119], v[76:79]
  s_add_u32 s17, s16, 327680
  v_add_u32 v48, s72, v48
  v_mfma_f32_16x16x32_bf16 v[80:83], a[220:223], a[120:123], v[80:83]
  buffer_load_dwordx4 a[200:203], v10, s[44:47], s17 offen offset:0 sc1
  v_mfma_f32_16x16x32_bf16 v[84:87], a[224:227], a[120:123], v[84:87]
  s_add_u32 s18, s17, 4096
  v_mfma_f32_16x16x32_bf16 v[88:91], a[228:231], a[120:123], v[88:91]
  buffer_load_dwordx4 a[204:207], v10, s[44:47], s17 offen offset:1024 sc1
  v_mfma_f32_16x16x32_bf16 v[92:95], a[232:235], a[120:123], v[92:95]
  v_mfma_f32_16x16x32_bf16 v[96:99], a[236:239], a[120:123], v[96:99]
  buffer_load_dwordx4 a[208:211], v10, s[44:47], s17 offen offset:2048 sc1
  v_mfma_f32_16x16x32_bf16 v[100:103], a[220:223], a[124:127], v[100:103]
  v_mfma_f32_16x16x32_bf16 v[104:107], a[224:227], a[124:127], v[104:107]
  buffer_load_dwordx4 a[212:215], v10, s[44:47], s17 offen offset:3072 sc1
  v_mfma_f32_16x16x32_bf16 v[108:111], a[228:231], a[124:127], v[108:111]
  v_mfma_f32_16x16x32_bf16 v[112:115], a[232:235], a[124:127], v[112:115]
  buffer_load_dwordx4 a[216:219], v10, s[44:47], s18 offen sc1
  v_mfma_f32_16x16x32_bf16 v[116:119], a[236:239], a[124:127], v[116:119]
  s_waitcnt vmcnt(9)
  v_cmp_le_u32 s[0:1], 1, v57
  s_nop 0
  s_cmp_eq_u64 s[0:1], exec
  s_cbranch_scc1 L_ok7
  s_mov_b32 s78, 65536
L_spin7:
  s_sleep 4
  buffer_load_dword v57, v240, s[44:47], 0 offen  sc1
  s_waitcnt vmcnt(0)
  v_cmp_le_u32 s[0:1], 1, v57
  s_nop 0
  s_cmp_eq_u64 s[0:1], exec
  s_cbranch_scc1 L_ok7
  s_sub_u32 s78, s78, 1
  s_cmp_lg_u32 s78, 0
  s_cbranch_scc1 L_spin7
L_ok7:
  v_mfma_f32_16x16x32_bf16 v[188:191], a[160:163], a[128:131], v[188:191]
  s_add_u32 s22, s20, 0
  v_cndmask_b32 v220, 0, v46, vcc
  v_mfma_f32_16x16x32_bf16 v[192:195], a[164:167], a[128:131], v[192:195]
  v_cndmask_b32 v222, 0, v46, vcc
  v_cmp_eq_u32 vcc, 1, v47
  v_mfma_f32_16x16x32_bf16 v[196:199], a[168:171], a[128:131], v[196:199]
  v_lshl_add_u32 v238, v45, 3, v48
  v_lshlrev_b32 v49, 3, v0
  v_mfma_f32_16x16x32_bf16 v[200:203], a[172:175], a[128:131], v[200:203]
  v_cndmask_b32 v221, 0, v46, vcc
  v_cndmask_b32 v223, 0, v46, vcc
  v_mfma_f32_16x16x32_bf16 v[204:207], a[176:179], a[128:131], v[204:207]
  buffer_load_dwordx4 a[112:115], v10, s[44:47], s22 offen offset:0 sc1
  v_mfma_f32_16x16x32_bf16 v[60:63], a[160:163], a[132:135], v[60:63]
  s_add_u32 s23, s22, s13
  s_mul_i32 s5, s60, 7680
  v_mfma_f32_16x16x32_bf16 v[64:67], a[164:167], a[132:135], v[64:67]
  s_add_u32 s5, s5, 90112
  ds_read_b128 a[0:3], v242 offset:0
  v_mfma_f32_16x16x32_bf16 v[68:71], a[168:171], a[132:135], v[68:71]
  ds_read_b128 a[4:7], v242 offset:6144
  ds_read_b128 a[8:11], v242 offset:1024
  v_mfma_f32_16x16x32_bf16 v[72:75], a[172:175], a[132:135], v[72:75]
  buffer_load_dwordx4 a[116:119], v10, s[44:47], s22 offen offset:1024 sc1
  v_mfma_f32_16x16x32_bf16 v[76:79], a[176:179], a[132:135], v[76:79]
  ds_read_b128 a[12:15], v242 offset:7168
  ds_read_b128 a[16:19], v243 offset:0
  v_mfma_f32_16x16x32_bf16 v[80:83], a[160:163], a[136:139], v[80:83]
  ds_read_b128 a[20:23], v243 offset:6144
  ds_read_b128 a[24:27], v243 offset:1024
  v_mfma_f32_16x16x32_bf16 v[84:87], a[164:167], a[136:139], v[84:87]
  ds_read_b128 a[28:31], v243 offset:7168
  ds_read_b128 a[32:35], v244 offset:0
  v_mfma_f32_16x16x32_bf16 v[88:91], a[168:171], a[136:139], v[88:91]
  buffer_load_dwordx4 a[120:123], v10, s[44:47], s23 offen offset:0 sc1
  v_mfma_f32_16x16x32_bf16 v[92:95], a[172:175], a[136:139], v[92:95]
  ds_read_b128 a[36:39], v244 offset:6144
  ds_read_b128 a[40:43], v244 offset:1024
  v_mfma_f32_16x16x32_bf16 v[96:99], a[176:179], a[136:139], v[96:99]
  ds_read_b128 a[44:47], v244 offset:7168
  ds_read_b128 a[48:51], v245 offset:0
  v_mfma_f32_16x16x32_bf16 v[100:103], a[160:163], a[140:143], v[100:103]
  ds_read_b128 a[52:55], v245 offset:6144
  ds_read_b128 a[56:59], v245 offset:1024
  v_mfma_f32_16x16x32_bf16 v[104:107], a[164:167], a[140:143], v[104:107]
  buffer_load_dwordx4 a[124:127], v10, s[44:47], s23 offen offset:1024 sc1
  v_mfma_f32_16x16x32_bf16 v[108:111], a[168:171], a[140:143], v[108:111]
  ds_read_b128 a[60:63], v245 offset:7168
  v_mfma_f32_16x16x32_bf16 v[112:115], a[172:175], a[140:143], v[112:115]
  v_mfma_f32_16x16x32_bf16 v[116:119], a[176:179], a[140:143], v[116:119]
  s_cmp_lg_u32 s60, 0
  s_cbranch_scc1 L_nl_l
  s_add_u32 s22, s20, 0
  buffer_load_dwordx4 v[28:31], v237, s[44:47], s22 offen offset:0 sc1
  s_add_u32 s23, s22, s13
  buffer_load_dwordx4 v[32:35], v237, s[44:47], s22 offen offset:1024 sc1
  buffer_load_dwordx4 v[36:39], v237, s[44:47], s23 offen offset:0 sc1
  buffer_load_dwordx4 v[40:43], v237, s[44:47], s23 offen offset:1024 sc1
L_nl_l:
  v_mfma_f32_16x16x32_bf16 v[188:191], a[180:183], a[144:147], v[188:191]
  s_add_u32 s22, s19, 18432
  v_add_u32 v231, s5, v49
  v_mfma_f32_16x16x32_bf16 v[192:195], a[184:187], a[144:147], v[192:195]
  s_xor_b32 s5, s60, 1
  s_mul_i32 s5, s5, 7680
  v_mfma_f32_16x16x32_bf16 v[196:199], a[188:191], a[144:147], v[196:199]
  s_add_u32 s5, s5, 90112
  v_add_u32 v228, s5, v49
  v_mfma_f32_16x16x32_bf16 v[200:203], a[192:195], a[144:147], v[200:203]
  s_xor_b32 s5, s60, 2
  s_mul_i32 s5, s5, 7680
  v_mfma_f32_16x16x32_bf16 v[204:207], a[196:199], a[144:147], v[204:207]
  buffer_load_dwordx4 a[96:99], v25, s[44:47], s22 offen offset:0 sc1
  v_mfma_f32_16x16x32_bf16 v[60:63], a[180:183], a[148:151], v[60:63]
  s_add_u32 s23, s22, s12
  s_add_u32 s5, s5, 92672
  v_mfma_f32_16x16x32_bf16 v[64:67], a[184:187], a[148:151], v[64:67]
  v_add_u32 v229, s5, v49
  v_mfma_f32_16x16x32_bf16 v[68:71], a[188:191], a[148:151], v[68:71]
  v_mfma_f32_16x16x32_bf16 v[72:75], a[192:195], a[148:151], v[72:75]
  buffer_load_dwordx4 a[100:103], v27, s[44:47], s22 offen offset:0 sc1
  v_mfma_f32_16x16x32_bf16 v[76:79], a[196:199], a[148:151], v[76:79]
  v_mfma_f32_16x16x32_bf16 v[80:83], a[180:183], a[152:155], v[80:83]
  v_mfma_f32_16x16x32_bf16 v[84:87], a[184:187], a[152:155], v[84:87]
  v_mfma_f32_16x16x32_bf16 v[88:91], a[188:191], a[152:155], v[88:91]
  buffer_load_dwordx4 a[104:107], v25, s[44:47], s23 offen offset:0 sc1
  v_mfma_f32_16x16x32_bf16 v[92:95], a[192:195], a[152:155], v[92:95]
  v_mfma_f32_16x16x32_bf16 v[96:99], a[196:199], a[152:155], v[96:99]
  v_mfma_f32_16x16x32_bf16 v[100:103], a[180:183], a[156:159], v[100:103]
  v_mfma_f32_16x16x32_bf16 v[104:107], a[184:187], a[156:159], v[104:107]
  buffer_load_dwordx4 a[108:111], v27, s[44:47], s23 offen offset:0 sc1
  v_mfma_f32_16x16x32_bf16 v[108:111], a[188:191], a[156:159], v[108:111]
  v_mfma_f32_16x16x32_bf16 v[112:115], a[192:195], a[156:159], v[112:115]
  v_mfma_f32_16x16x32_bf16 v[116:119], a[196:199], a[156:159], v[116:119]
  s_waitcnt vmcnt(12)
  v_mfma_f32_16x16x32_bf16 v[188:191], a[200:203], a[80:83], v[188:191]
  s_add_u32 s17, s16, 368640
  s_xor_b32 s5, s60, 3
  s_waitcnt vmcnt(11)
  v_mfma_f32_16x16x32_bf16 v[192:195], a[204:207], a[80:83], v[192:195]
  s_mul_i32 s5, s5, 7680
  s_add_u32 s5, s5, 95232
  s_waitcnt vmcnt(10)
  v_mfma_f32_16x16x32_bf16 v[196:199], a[208:211], a[80:83], v[196:199]
  buffer_load_dwordx4 a[220:223], v10, s[44:47], s17 offen offset:0 sc1
  s_waitcnt vmcnt(10)
  v_mfma_f32_16x16x32_bf16 v[200:203], a[212:215], a[80:83], v[200:203]
  s_add_u32 s18, s17, 4096
  v_add_u32 v230, s5, v49
  s_waitcnt vmcnt(9)
  v_mfma_f32_16x16x32_bf16 v[204:207], a[216:219], a[80:83], v[204:207]
  buffer_load_dwordx4 a[224:227], v10, s[44:47], s17 offen offset:1024 sc1
  v_mfma_f32_16x16x32_bf16 v[60:63], a[200:203], a[84:87], v[60:63]
  v_mfma_f32_16x16x32_bf16 v[64:67], a[204:207], a[84:87], v[64:67]
  buffer_load_dwordx4 a[228:231], v10, s[44:47], s17 offen offset:2048 sc1
  v_mfma_f32_16x16x32_bf16 v[68:71], a[208:211], a[84:87], v[68:71]
  v_mfma_f32_16x16x32_bf16 v[72:75], a[212:215], a[84:87], v[72:75]
  buffer_load_dwordx4 a[232:235], v10, s[44:47], s17 offen offset:3072 sc1
  v_mfma_f32_16x16x32_bf16 v[76:79], a[216:219], a[84:87], v[76:79]
  v_mfma_f32_16x16x32_bf16 v[80:83], a[200:203], a[88:91], v[80:83]
  buffer_load_dwordx4 a[236:239], v10, s[44:47], s18 offen sc1
  v_mfma_f32_16x16x32_bf16 v[84:87], a[204:207], a[88:91], v[84:87]
  s_add_u32 s22, s20, 2048
  v_mfma_f32_16x16x32_bf16 v[88:91], a[208:211], a[88:91], v[88:91]
  buffer_load_dwordx4 a[128:131], v10, s[44:47], s22 offen offset:0 sc1
  v_mfma_f32_16x16x32_bf16 v[92:95], a[212:215], a[88:91], v[92:95]
  s_add_u32 s23, s22, s13
  v_mfma_f32_16x16x32_bf16 v[96:99], a[216:219], a[88:91], v[96:99]
  buffer_load_dwordx4 a[132:135], v10, s[44:47], s22 offen offset:1024 sc1
  v_mfma_f32_16x16x32_bf16 v[100:103], a[200:203], a[92:95], v[100:103]
  v_mfma_f32_16x16x32_bf16 v[104:107], a[204:207], a[92:95], v[104:107]
  buffer_load_dwordx4 a[136:139], v10, s[44:47], s23 offen offset:0 sc1
  v_mfma_f32_16x16x32_bf16 v[108:111], a[208:211], a[92:95], v[108:111]
  v_mfma_f32_16x16x32_bf16 v[112:115], a[212:215], a[92:95], v[112:115]
  buffer_load_dwordx4 a[140:143], v10, s[44:47], s23 offen offset:1024 sc1
  v_mfma_f32_16x16x32_bf16 v[116:119], a[216:219], a[92:95], v[116:119]
  s_cmp_lg_u32 s60, 0
  s_cbranch_scc1 L_na_l
  s_waitcnt vmcnt(16) lgkmcnt(15)
  v_mfma_f32_16x16x32_bf16 v[124:127], a[112:115], a[0:3], 0
  s_add_u32 s17, s21, 0
  s_waitcnt lgkmcnt(13)
  v_mfma_f32_16x16x32_bf16 v[128:131], v[28:31], a[8:11], 0
  s_waitcnt lgkmcnt(11)
  v_mfma_f32_16x16x32_bf16 v[132:135], a[112:115], a[16:19], 0
  s_waitcnt lgkmcnt(9)
  v_mfma_f32_16x16x32_bf16 v[136:139], v[28:31], a[24:27], 0
  buffer_load_dwordx4 a[160:163], v10, s[44:47], s17 offen offset:0 sc1
  s_waitcnt vmcnt(15) lgkmcnt(7)
  v_mfma_f32_16x16x32_bf16 v[140:143], a[120:123], a[32:35], 0
  s_add_u32 s18, s17, 4096
  s_waitcnt lgkmcnt(5)
  v_mfma_f32_16x16x32_bf16 v[144:147], v[36:39], a[40:43], 0
  s_waitcnt lgkmcnt(3)
  v_mfma_f32_16x16x32_bf16 v[148:151], a[120:123], a[48:51], 0
  buffer_load_dwordx4 a[164:167], v10, s[44:47], s17 offen offset:1024 sc1
  s_waitcnt lgkmcnt(1)
  v_mfma_f32_16x16x32_bf16 v[152:155], v[36:39], a[56:59], 0
  v_mfma_f32_16x16x32_bf16 v[124:127], a[116:119], a[4:7], v[124:127]
  v_mfma_f32_16x16x32_bf16 v[128:131], v[32:35], a[12:15], v[128:131]
  buffer_load_dwordx4 a[168:171], v10, s[44:47], s17 offen offset:2048 sc1
  v_mfma_f32_16x16x32_bf16 v[132:135], a[116:119], a[20:23], v[132:135]
  v_mfma_f32_16x16x32_bf16 v[136:139], v[32:35], a[28:31], v[136:139]
  s_waitcnt vmcnt(16)
  v_mfma_f32_16x16x32_bf16 v[140:143], a[124:127], a[36:39], v[140:143]
  buffer_load_dwordx4 a[172:175], v10, s[44:47], s17 offen offset:3072 sc1
  v_mfma_f32_16x16x32_bf16 v[144:147], v[40:43], a[44:47], v[144:147]
  v_mfma_f32_16x16x32_bf16 v[148:151], a[124:127], a[52:55], v[148:151]
  s_waitcnt lgkmcnt(0)
  v_mfma_f32_16x16x32_bf16 v[152:155], v[40:43], a[60:63], v[152:155]
  buffer_load_dwordx4 a[176:179], v10, s[44:47], s18 offen sc1
  s_branch L_nj_l
L_na_l:
  s_waitcnt vmcnt(16) lgkmcnt(15)
  v_mfma_f32_16x16x32_bf16 v[124:127], a[112:115], a[0:3], 0
  s_add_u32 s17, s21, 0
  s_waitcnt lgkmcnt(13)
  v_mfma_f32_16x16x32_bf16 v[128:131], a[112:115], a[8:11], 0
  s_waitcnt lgkmcnt(11)
  v_mfma_f32_16x16x32_bf16 v[132:135], a[112:115], a[16:19], 0
  s_waitcnt lgkmcnt(9)
  v_mfma_f32_16x16x32_bf16 v[136:139], a[112:115], a[24:27], 0
  buffer_load_dwordx4 a[160:163], v10, s[44:47], s17 offen offset:0 sc1
  s_waitcnt vmcnt(15) lgkmcnt(7)
  v_mfma_f32_16x16x32_bf16 v[140:143], a[120:123], a[32:35], 0
  s_add_u32 s18, s17, 4096
  s_waitcnt lgkmcnt(5)
  v_mfma_f32_16x16x32_bf16 v[144:147], a[120:123], a[40:43], 0
  s_waitcnt lgkmcnt(3)
  v_mfma_f32_16x16x32_bf16 v[148:151], a[120:123], a[48:51], 0
  buffer_load_dwordx4 a[164:167], v10, s[44:47], s17 offen offset:1024 sc1
  s_waitcnt lgkmcnt(1)
  v_mfma_f32_16x16x32_bf16 v[152:155], a[120:123], a[56:59], 0
  v_mfma_f32_16x16x32_bf16 v[124:127], a[116:119], a[4:7], v[124:127]
  v_mfma_f32_16x16x32_bf16 v[128:131], a[116:119], a[12:15], v[128:131]
  buffer_load_dwordx4 a[168:171], v10, s[44:47], s17 offen offset:2048 sc1
  v_mfma_f32_16x16x32_bf16 v[132:135], a[116:119], a[20:23], v[132:135]
  v_mfma_f32_16x16x32_bf16 v[136:139], a[116:119], a[28:31], v[136:139]
  s_waitcnt vmcnt(16)
  v_mfma_f32_16x16x32_bf16 v[140:143], a[124:127], a[36:39], v[140:143]
  buffer_load_dwordx4 a[172:175], v10, s[44:47], s17 offen offset:3072 sc1
  v_mfma_f32_16x16x32_bf16 v[144:147], a[124:127], a[44:47], v[144:147]
  v_mfma_f32_16x16x32_bf16 v[148:151], a[124:127], a[52:55], v[148:151]
  s_waitcnt lgkmcnt(0)
  v_mfma_f32_16x16x32_bf16 v[152:155], a[124:127], a[60:63], v[152:155]
  buffer_load_dwordx4 a[176:179], v10, s[44:47], s18 offen sc1
L_nj_l:
  s_waitcnt vmcnt(8)
  v_mfma_f32_16x16x32_bf16 v[188:191], a[220:223], a[96:99], v[188:191]
  s_add_u32 s22, s20, 4096
  s_waitcnt vmcnt(7)
  v_mfma_f32_16x16x32_bf16 v[192:195], a[224:227], a[96:99], v[192:195]
  s_waitcnt vmcnt(6)
  v_mfma_f32_16x16x32_bf16 v[196:199], a[228:231], a[96:99], v[196:199]
  s_waitcnt vmcnt(5)
  v_mfma_f32_16x16x32_bf16 v[200:203], a[232:235], a[96:99], v[200:203]
  v_cvt_pk_bf16_f32 v156, v124, v128
  v_cvt_pk_bf16_f32 v157, v125, v129
  s_waitcnt vmcnt(4)
  v_mfma_f32_16x16x32_bf16 v[204:207], a[236:239], a[96:99], v[204:207]
  buffer_load_dwordx4 a[144:147], v10, s[44:47], s22 offen offset:0 sc1
  v_mfma_f32_16x16x32_bf16 v[60:63], a[220:223], a[100:103], v[60:63]
  s_add_u32 s23, s22, s13
  v_cvt_pk_bf16_f32 v158, v126, v130
  v_mfma_f32_16x16x32_bf16 v[64:67], a[224:227], a[100:103], v[64:67]
  v_cvt_pk_bf16_f32 v159, v127, v131
  v_cvt_pk_bf16_f32 v160, v132, v136
  v_mfma_f32_16x16x32_bf16 v[68:71], a[228:231], a[100:103], v[68:71]
  v_cvt_pk_bf16_f32 v161, v133, v137
  v_cvt_pk_bf16_f32 v162, v134, v138
  v_mfma_f32_16x16x32_bf16 v[72:75], a[232:235], a[100:103], v[72:75]
  buffer_load_dwordx4 a[148:151], v10, s[44:47], s22 offen offset:1024 sc1
  v_mfma_f32_16x16x32_bf16 v[76:79], a[236:239], a[100:103], v[76:79]
  v_cvt_pk_bf16_f32 v163, v135, v139
  v_cvt_pk_bf16_f32 v164, v140, v144
  v_mfma_f32_16x16x32_bf16 v[80:83], a[220:223], a[104:107], v[80:83]
  v_cvt_pk_bf16_f32 v165, v141, v145
  v_cvt_pk_bf16_f32 v166, v142, v146
  v_mfma_f32_16x16x32_bf16 v[84:87], a[224:227], a[104:107], v[84:87]
  v_cvt_pk_bf16_f32 v167, v143, v147
  v_cvt_pk_bf16_f32 v168, v148, v152
  v_mfma_f32_16x16x32_bf16 v[88:91], a[228:231], a[104:107], v[88:91]
  buffer_load_dwordx4 a[152:155], v10, s[44:47], s23 offen offset:0 sc1
  v_mfma_f32_16x16x32_bf16 v[92:95], a[232:235], a[104:107], v[92:95]
  v_cvt_pk_bf16_f32 v169, v149, v153
  v_cvt_pk_bf16_f32 v170, v150, v154
  v_mfma_f32_16x16x32_bf16 v[96:99], a[236:239], a[104:107], v[96:99]
  v_cvt_pk_bf16_f32 v171, v151, v155
  v_mfma_f32_16x16x32_bf16 v[100:103], a[220:223], a[108:111], v[100:103]
  v_mfma_f32_16x16x32_bf16 v[104:107], a[224:227], a[108:111], v[104:107]
  buffer_load_dwordx4 a[156:159], v10, s[44:47], s23 offen offset:1024 sc1
  v_mfma_f32_16x16x32_bf16 v[108:111], a[228:231], a[108:111], v[108:111]
  v_mfma_f32_16x16x32_bf16 v[112:115], a[232:235], a[108:111], v[112:115]
  v_mfma_f32_16x16x32_bf16 v[116:119], a[236:239], a[108:111], v[116:119]
  s_waitcnt vmcnt(7) lgkmcnt(15)
  v_mfma_f32_16x16x32_bf16 v[124:127], a[128:131], a[0:3], 0
  s_add_u32 s17, s21, 40960
  s_waitcnt lgkmcnt(13)
  v_mfma_f32_16x16x32_bf16 v[128:131], a[128:131], a[8:11], 0
  s_waitcnt lgkmcnt(11)
  v_mfma_f32_16x16x32_bf16 v[132:135], a[128:131], a[16:19], 0
  s_waitcnt lgkmcnt(9)
  v_mfma_f32_16x16x32_bf16 v[136:139], a[128:131], a[24:27], 0
  buffer_load_dwordx4 a[180:183], v10, s[44:47], s17 offen offset:0 sc1
  s_waitcnt vmcnt(6) lgkmcnt(7)
  v_mfma_f32_16x16x32_bf16 v[140:143], a[136:139], a[32:35], 0
  s_add_u32 s18, s17, 4096
  s_waitcnt lgkmcnt(5)
  v_mfma_f32_16x16x32_bf16 v[144:147], a[136:139], a[40:43], 0
  s_waitcnt lgkmcnt(3)
  v_mfma_f32_16x16x32_bf16 v[148:151], a[136:139], a[48:51], 0
  buffer_load_dwordx4 a[184:187], v10, s[44:47], s17 offen offset:1024 sc1
  s_waitcnt lgkmcnt(1)
  v_mfma_f32_16x16x32_bf16 v[152:155], a[136:139], a[56:59], 0
  v_mfma_f32_16x16x32_bf16 v[124:127], a[132:135], a[4:7], v[124:127]
  v_mfma_f32_16x16x32_bf16 v[128:131], a[132:135], a[12:15], v[128:131]
  buffer_load_dwordx4 a[188:191], v10, s[44:47], s17 offen offset:2048 sc1
  v_mfma_f32_16x16x32_bf16 v[132:135], a[132:135], a[20:23], v[132:135]
  v_mfma_f32_16x16x32_bf16 v[136:139], a[132:135], a[28:31], v[136:139]
  s_waitcnt vmcnt(7)
  v_mfma_f32_16x16x32_bf16 v[140:143], a[140:143], a[36:39], v[140:143]
  buffer_load_dwordx4 a[192:195], v10, s[44:47], s17 offen offset:3072 sc1
  v_mfma_f32_16x16x32_bf16 v[144:147], a[140:143], a[44:47], v[144:147]
  v_mfma_f32_16x16x32_bf16 v[148:151], a[140:143], a[52:55], v[148:151]
  s_waitcnt lgkmcnt(0)
  v_mfma_f32_16x16x32_bf16 v[152:155], a[140:143], a[60:63], v[152:155]
  buffer_load_dwordx4 a[196:199], v10, s[44:47], s18 offen sc1
  v_mfma_f32_16x16x32_bf16 v[188:191], a[160:163], v[156:159], v[188:191]
  s_add_u32 s22, s20, 6144
  v_mfma_f32_16x16x32_bf16 v[192:195], a[164:167], v[156:159], v[192:195]
  v_mfma_f32_16x16x32_bf16 v[196:199], a[168:171], v[156:159], v[196:199]
  v_mfma_f32_16x16x32_bf16 v[200:203], a[172:175], v[156:159], v[200:203]
  v_cvt_pk_bf16_f32 v172, v124, v128
  v_cvt_pk_bf16_f32 v173, v125, v129
  v_mfma_f32_16x16x32_bf16 v[204:207], a[176:179], v[156:159], v[204:207]
  buffer_load_dwordx4 a[80:83], v10, s[44:47], s22 offen offset:0 sc1
  v_mfma_f32_16x16x32_bf16 v[60:63], a[160:163], v[160:163], v[60:63]
  s_add_u32 s23, s22, s13
  v_cvt_pk_bf16_f32 v174, v126, v130
  v_mfma_f32_16x16x32_bf16 v[64:67], a[164:167], v[160:163], v[64:67]
  v_cvt_pk_bf16_f32 v175, v127, v131
  v_cvt_pk_bf16_f32 v176, v132, v136
  v_mfma_f32_16x16x32_bf16 v[68:71], a[168:171], v[160:163], v[68:71]
  v_cvt_pk_bf16_f32 v177, v133, v137
  v_cvt_pk_bf16_f32 v178, v134, v138
  v_mfma_f32_16x16x32_bf16 v[72:75], a[172:175], v[160:163], v[72:75]
  buffer_load_dwordx4 a[84:87], v10, s[44:47], s22 offen offset:1024 sc1
  v_mfma_f32_16x16x32_bf16 v[76:79], a[176:179], v[160:163], v[76:79]
  v_cvt_pk_bf16_f32 v179, v135, v139
  v_cvt_pk_bf16_f32 v180, v140, v144
  v_mfma_f32_16x16x32_bf16 v[80:83], a[160:163], v[164:167], v[80:83]
  v_cvt_pk_bf16_f32 v181, v141, v145
  v_cvt_pk_bf16_f32 v182, v142, v146
  v_mfma_f32_16x16x32_bf16 v[84:87], a[164:167], v[164:167], v[84:87]
  v_cvt_pk_bf16_f32 v183, v143, v147
  v_cvt_pk_bf16_f32 v184, v148, v152
  v_mfma_f32_16x16x32_bf16 v[88:91], a[168:171], v[164:167], v[88:91]
  buffer_load_dwordx4 a[88:91], v10, s[44:47], s23 offen offset:0 sc1
  v_mfma_f32_16x16x32_bf16 v[92:95], a[172:175], v[164:167], v[92:95]
  v_cvt_pk_bf16_f32 v185, v149, v153
  v_cvt_pk_bf16_f32 v186, v150, v154
  v_mfma_f32_16x16x32_bf16 v[96:99], a[176:179], v[164:167], v[96:99]
  v_cvt_pk_bf16_f32 v187, v151, v155
  v_mfma_f32_16x16x32_bf16 v[100:103], a[160:163], v[168:171], v[100:103]
  v_mfma_f32_16x16x32_bf16 v[104:107], a[164:167], v[168:171], v[104:107]
  buffer_load_dwordx4 a[92:95], v10, s[44:47], s23 offen offset:1024 sc1
  v_mfma_f32_16x16x32_bf16 v[108:111], a[168:171], v[168:171], v[108:111]
  v_mfma_f32_16x16x32_bf16 v[112:115], a[172:175], v[168:171], v[112:115]
  v_mfma_f32_16x16x32_bf16 v[116:119], a[176:179], v[168:171], v[116:119]
  s_waitcnt vmcnt(12)
  v_mfma_f32_16x16x32_bf16 v[124:127], a[144:147], a[0:3], 0
  s_add_u32 s17, s21, 81920
  v_mfma_f32_16x16x32_bf16 v[128:131], a[144:147], a[8:11], 0
  v_mfma_f32_16x16x32_bf16 v[132:135], a[144:147], a[16:19], 0
  v_mfma_f32_16x16x32_bf16 v[136:139], a[144:147], a[24:27], 0
  buffer_load_dwordx4 a[200:203], v10, s[44:47], s17 offen offset:0 sc1
  s_waitcnt vmcnt(11)
  v_mfma_f32_16x16x32_bf16 v[140:143], a[152:155], a[32:35], 0
  s_add_u32 s18, s17, 4096
  v_mfma_f32_16x16x32_bf16 v[144:147], a[152:155], a[40:43], 0
  v_mfma_f32_16x16x32_bf16 v[148:151], a[152:155], a[48:51], 0
  buffer_load_dwordx4 a[204:207], v10, s[44:47], s17 offen offset:1024 sc1
  v_mfma_f32_16x16x32_bf16 v[152:155], a[152:155], a[56:59], 0
  v_mfma_f32_16x16x32_bf16 v[124:127], a[148:151], a[4:7], v[124:127]
  v_mfma_f32_16x16x32_bf16 v[128:131], a[148:151], a[12:15], v[128:131]
  buffer_load_dwordx4 a[208:211], v10, s[44:47], s17 offen offset:2048 sc1
  v_mfma_f32_16x16x32_bf16 v[132:135], a[148:151], a[20:23], v[132:135]
  v_mfma_f32_16x16x32_bf16 v[136:139], a[148:151], a[28:31], v[136:139]
  s_waitcnt vmcnt(12)
  v_mfma_f32_16x16x32_bf16 v[140:143], a[156:159], a[36:39], v[140:143]
  buffer_load_dwordx4 a[212:215], v10, s[44:47], s17 offen offset:3072 sc1
  v_mfma_f32_16x16x32_bf16 v[144:147], a[156:159], a[44:47], v[144:147]
  v_mfma_f32_16x16x32_bf16 v[148:151], a[156:159], a[52:55], v[148:151]
  v_mfma_f32_16x16x32_bf16 v[152:155], a[156:159], a[60:63], v[152:155]
  buffer_load_dwordx4 a[216:219], v10, s[44:47], s18 offen sc1
  s_waitcnt vmcnt(13)
  v_mfma_f32_16x16x32_bf16 v[188:191], a[180:183], v[172:175], v[188:191]
  s_add_u32 s22, s20, 8192
  s_waitcnt vmcnt(12)
  v_mfma_f32_16x16x32_bf16 v[192:195], a[184:187], v[172:175], v[192:195]
  s_waitcnt vmcnt(11)
  v_mfma_f32_16x16x32_bf16 v[196:199], a[188:191], v[172:175], v[196:199]
  s_waitcnt vmcnt(10)
  v_mfma_f32_16x16x32_bf16 v[200:203], a[192:195], v[172:175], v[200:203]
  v_cvt_pk_bf16_f32 v156, v124, v128
  v_cvt_pk_bf16_f32 v157, v125, v129
  s_waitcnt vmcnt(9)
  v_mfma_f32_16x16x32_bf16 v[204:207], a[196:199], v[172:175], v[204:207]
  buffer_load_dwordx4 a[96:99], v10, s[44:47], s22 offen offset:0 sc1
  v_mfma_f32_16x16x32_bf16 v[60:63], a[180:183], v[176:179], v[60:63]
  s_add_u32 s23, s22, s13
  v_cvt_pk_bf16_f32 v158, v126, v130
  v_mfma_f32_16x16x32_bf16 v[64:67], a[184:187], v[176:179], v[64:67]
  v_cvt_pk_bf16_f32 v159, v127, v131
  v_cvt_pk_bf16_f32 v160, v132, v136
  v_mfma_f32_16x16x32_bf16 v[68:71], a[188:191], v[176:179], v[68:71]
  v_cvt_pk_bf16_f32 v161, v133, v137
  v_cvt_pk_bf16_f32 v162, v134, v138
  v_mfma_f32_16x16x32_bf16 v[72:75], a[192:195], v[176:179], v[72:75]
  buffer_load_dwordx4 a[100:103], v10, s[44:47], s22 offen offset:1024 sc1
  v_mfma_f32_16x16x32_bf16 v[76:79], a[196:199], v[176:179], v[76:79]
  v_cvt_pk_bf16_f32 v163, v135, v139
  v_cvt_pk_bf16_f32 v164, v140, v144
  v_mfma_f32_16x16x32_bf16 v[80:83], a[180:183], v[180:183], v[80:83]
  v_cvt_pk_bf16_f32 v165, v141, v145
  v_cvt_pk_bf16_f32 v166, v142, v146
  v_mfma_f32_16x16x32_bf16 v[84:87], a[184:187], v[180:183], v[84:87]
  v_cvt_pk_bf16_f32 v167, v143, v147
  v_cvt_pk_bf16_f32 v168, v148, v152
  v_mfma_f32_16x16x32_bf16 v[88:91], a[188:191], v[180:183], v[88:91]
  buffer_load_dwordx4 a[104:107], v10, s[44:47], s23 offen offset:0 sc1
  v_mfma_f32_16x16x32_bf16 v[92:95], a[192:195], v[180:183], v[92:95]
  v_cvt_pk_bf16_f32 v169, v149, v153
  v_cvt_pk_bf16_f32 v170, v150, v154
  v_mfma_f32_16x16x32_bf16 v[96:99], a[196:199], v[180:183], v[96:99]
  v_cvt_pk_bf16_f32 v171, v151, v155
  v_mfma_f32_16x16x32_bf16 v[100:103], a[180:183], v[184:187], v[100:103]
  v_mfma_f32_16x16x32_bf16 v[104:107], a[184:187], v[184:187], v[104:107]
  buffer_load_dwordx4 a[108:111], v10, s[44:47], s23 offen offset:1024 sc1
  v_mfma_f32_16x16x32_bf16 v[108:111], a[188:191], v[184:187], v[108:111]
  v_mfma_f32_16x16x32_bf16 v[112:115], a[192:195], v[184:187], v[112:115]
  v_mfma_f32_16x16x32_bf16 v[116:119], a[196:199], v[184:187], v[116:119]
  s_waitcnt vmcnt(12)
  v_mfma_f32_16x16x32_bf16 v[124:127], a[80:83], a[0:3], 0
  s_add_u32 s17, s21, 122880
  v_mfma_f32_16x16x32_bf16 v[128:131], a[80:83], a[8:11], 0
  v_mfma_f32_16x16x32_bf16 v[132:135], a[80:83], a[16:19], 0
  v_mfma_f32_16x16x32_bf16 v[136:139], a[80:83], a[24:27], 0
  buffer_load_dwordx4 a[220:223], v10, s[44:47], s17 offen offset:0 sc1
  s_waitcnt vmcnt(11)
  v_mfma_f32_16x16x32_bf16 v[140:143], a[88:91], a[32:35], 0
  s_add_u32 s18, s17, 4096
  v_mfma_f32_16x16x32_bf16 v[144:147], a[88:91], a[40:43], 0
  v_mfma_f32_16x16x32_bf16 v[148:151], a[88:91], a[48:51], 0
  buffer_load_dwordx4 a[224:227], v10, s[44:47], s17 offen offset:1024 sc1
  v_mfma_f32_16x16x32_bf16 v[152:155], a[88:91], a[56:59], 0
  v_mfma_f32_16x16x32_bf16 v[124:127], a[84:87], a[4:7], v[124:127]
  v_mfma_f32_16x16x32_bf16 v[128:131], a[84:87], a[12:15], v[128:131]
  buffer_load_dwordx4 a[228:231], v10, s[44:47], s17 offen offset:2048 sc1
  v_mfma_f32_16x16x32_bf16 v[132:135], a[84:87], a[20:23], v[132:135]
  v_mfma_f32_16x16x32_bf16 v[136:139], a[84:87], a[28:31], v[136:139]
  s_waitcnt vmcnt(12)
  v_mfma_f32_16x16x32_bf16 v[140:143], a[92:95], a[36:39], v[140:143]
  buffer_load_dwordx4 a[232:235], v10, s[44:47], s17 offen offset:3072 sc1
  v_mfma_f32_16x16x32_bf16 v[144:147], a[92:95], a[44:47], v[144:147]
  v_mfma_f32_16x16x32_bf16 v[148:151], a[92:95], a[52:55], v[148:151]
  v_mfma_f32_16x16x32_bf16 v[152:155], a[92:95], a[60:63], v[152:155]
  buffer_load_dwordx4 a[236:239], v10, s[44:47], s18 offen sc1
  s_waitcnt vmcnt(13)
  v_mfma_f32_16x16x32_bf16 v[188:191], a[200:203], v[156:159], v[188:191]
  s_add_u32 s17, s21, 163840
  s_waitcnt vmcnt(12)
  v_mfma_f32_16x16x32_bf16 v[192:195], a[204:207], v[156:159], v[192:195]
  s_waitcnt vmcnt(11)
  v_mfma_f32_16x16x32_bf16 v[196:199], a[208:211], v[156:159], v[196:199]
  s_waitcnt vmcnt(10)
  v_mfma_f32_16x16x32_bf16 v[200:203], a[212:215], v[156:159], v[200:203]
  v_cvt_pk_bf16_f32 v32, v124, v128
  v_cvt_pk_bf16_f32 v33, v125, v129
  s_waitcnt vmcnt(9)
  v_mfma_f32_16x16x32_bf16 v[204:207], a[216:219], v[156:159], v[204:207]
  buffer_load_dwordx4 a[160:163], v10, s[44:47], s17 offen offset:0 sc1
  v_mfma_f32_16x16x32_bf16 v[60:63], a[200:203], v[160:163], v[60:63]
  s_add_u32 s18, s17, 4096
  v_cvt_pk_bf16_f32 v34, v126, v130
  v_mfma_f32_16x16x32_bf16 v[64:67], a[204:207], v[160:163], v[64:67]
  v_cvt_pk_bf16_f32 v35, v127, v131
  v_cvt_pk_bf16_f32 v176, v132, v136
  v_mfma_f32_16x16x32_bf16 v[68:71], a[208:211], v[160:163], v[68:71]
  v_cvt_pk_bf16_f32 v177, v133, v137
  v_cvt_pk_bf16_f32 v178, v134, v138
  v_mfma_f32_16x16x32_bf16 v[72:75], a[212:215], v[160:163], v[72:75]
  buffer_load_dwordx4 a[164:167], v10, s[44:47], s17 offen offset:1024 sc1
  v_mfma_f32_16x16x32_bf16 v[76:79], a[216:219], v[160:163], v[76:79]
  v_cvt_pk_bf16_f32 v179, v135, v139
  v_cvt_pk_bf16_f32 v180, v140, v144
  v_mfma_f32_16x16x32_bf16 v[80:83], a[200:203], v[164:167], v[80:83]
  v_cvt_pk_bf16_f32 v181, v141, v145
  v_cvt_pk_bf16_f32 v182, v142, v146
  v_mfma_f32_16x16x32_bf16 v[84:87], a[204:207], v[164:167], v[84:87]
  v_cvt_pk_bf16_f32 v183, v143, v147
  v_cvt_pk_bf16_f32 v184, v148, v152
  v_mfma_f32_16x16x32_bf16 v[88:91], a[208:211], v[164:167], v[88:91]
  buffer_load_dwordx4 a[168:171], v10, s[44:47], s17 offen offset:2048 sc1
  v_mfma_f32_16x16x32_bf16 v[92:95], a[212:215], v[164:167], v[92:95]
  v_cvt_pk_bf16_f32 v185, v149, v153
  v_cvt_pk_bf16_f32 v186, v150, v154
  v_mfma_f32_16x16x32_bf16 v[96:99], a[216:219], v[164:167], v[96:99]
  v_cvt_pk_bf16_f32 v187, v151, v155
  v_mfma_f32_16x16x32_bf16 v[100:103], a[200:203], v[168:171], v[100:103]
  v_mfma_f32_16x16x32_bf16 v[104:107], a[204:207], v[168:171], v[104:107]
  buffer_load_dwordx4 a[172:175], v10, s[44:47], s17 offen offset:3072 sc1
  v_mfma_f32_16x16x32_bf16 v[108:111], a[208:211], v[168:171], v[108:111]
  v_mfma_f32_16x16x32_bf16 v[112:115], a[212:215], v[168:171], v[112:115]
  v_mfma_f32_16x16x32_bf16 v[116:119], a[216:219], v[168:171], v[116:119]
  buffer_load_dwordx4 a[176:179], v10, s[44:47], s18 offen sc1
  s_waitcnt vmcnt(13)
  v_mfma_f32_16x16x32_bf16 v[132:135], a[96:99], a[16:19], 0
  v_mfma_f32_16x16x32_bf16 v[136:139], a[96:99], a[24:27], 0
  s_waitcnt vmcnt(11)
  v_mfma_f32_16x16x32_bf16 v[140:143], a[104:107], a[32:35], 0
  v_mfma_f32_16x16x32_bf16 v[144:147], a[104:107], a[40:43], 0
  v_mfma_f32_16x16x32_bf16 v[132:135], a[100:103], a[20:23], v[132:135]
  v_mfma_f32_16x16x32_bf16 v[136:139], a[100:103], a[28:31], v[136:139]
  s_waitcnt vmcnt(10)
  v_mfma_f32_16x16x32_bf16 v[140:143], a[108:111], a[36:39], v[140:143]
  v_mfma_f32_16x16x32_bf16 v[144:147], a[108:111], a[44:47], v[144:147]
  v_mfma_f32_16x16x32_bf16 v[148:151], a[104:107], a[48:51], 0
  v_mfma_f32_16x16x32_bf16 v[152:155], a[104:107], a[56:59], 0
  v_mfma_f32_16x16x32_bf16 v[124:127], a[96:99], a[0:3], 0
  s_nop 1
  v_cvt_pk_bf16_f32 v160, v132, v136
  v_cvt_pk_bf16_f32 v161, v133, v137
  v_mfma_f32_16x16x32_bf16 v[128:131], a[96:99], a[8:11], 0
  v_cvt_pk_bf16_f32 v162, v134, v138
  v_cvt_pk_bf16_f32 v163, v135, v139
  v_mfma_f32_16x16x32_bf16 v[148:151], a[108:111], a[52:55], v[148:151]
  v_cvt_pk_bf16_f32 v164, v140, v144
  v_cvt_pk_bf16_f32 v165, v141, v145
  v_mfma_f32_16x16x32_bf16 v[152:155], a[108:111], a[60:63], v[152:155]
  v_cvt_pk_bf16_f32 v166, v142, v146
  v_cvt_pk_bf16_f32 v167, v143, v147
  v_mfma_f32_16x16x32_bf16 v[124:127], a[100:103], a[4:7], v[124:127]
  v_mfma_f32_16x16x32_bf16 v[128:131], a[100:103], a[12:15], v[128:131]
  ds_read_b64 v[210:211], v238 offset:0
  ds_read_b64 v[214:215], v238 offset:32
  ds_read_b64 v[218:219], v238 offset:64
  ds_read_b64 v[226:227], v238 offset:96
  ds_read_b64 v[122:123], v238 offset:128
  s_waitcnt vmcnt(9)
  v_mfma_f32_16x16x32_bf16 v[60:63], a[220:223], v[176:179], v[60:63]
  v_mfma_f32_16x16x32_bf16 v[80:83], a[220:223], v[180:183], v[80:83]
  v_cvt_pk_bf16_f32 v168, v148, v152
  v_cvt_pk_bf16_f32 v169, v149, v153
  v_mfma_f32_16x16x32_bf16 v[100:103], a[220:223], v[184:187], v[100:103]
  v_cvt_pk_bf16_f32 v170, v150, v154
  v_cvt_pk_bf16_f32 v171, v151, v155
  s_waitcnt vmcnt(4)
  v_mfma_f32_16x16x32_bf16 v[60:63], a[160:163], v[160:163], v[60:63]
  v_cvt_pk_bf16_f32 v28, v124, v128
  v_cvt_pk_bf16_f32 v29, v125, v129
  v_mfma_f32_16x16x32_bf16 v[80:83], a[160:163], v[164:167], v[80:83]
  v_cvt_pk_bf16_f32 v30, v126, v130
  v_cvt_pk_bf16_f32 v31, v127, v131
  v_mfma_f32_16x16x32_bf16 v[100:103], a[160:163], v[168:171], v[100:103]
  v_mfma_f32_16x16x32_bf16 v[64:67], a[224:227], v[176:179], v[64:67]
  v_mfma_f32_16x16x32_bf16 v[84:87], a[224:227], v[180:183], v[84:87]
  v_cvt_pk_bf16_f32 v60, v60, v61
  v_cvt_pk_bf16_f32 v61, v62, v63
  v_mfma_f32_16x16x32_bf16 v[104:107], a[224:227], v[184:187], v[104:107]
  ds_write_b64 v228, v[60:61] offset:0
  s_waitcnt vmcnt(3)
  v_mfma_f32_16x16x32_bf16 v[64:67], a[164:167], v[160:163], v[64:67]
  v_cvt_pk_bf16_f32 v80, v80, v81
  v_cvt_pk_bf16_f32 v81, v82, v83
  v_mfma_f32_16x16x32_bf16 v[84:87], a[164:167], v[164:167], v[84:87]
  ds_write_b64 v229, v[80:81] offset:0
  v_mfma_f32_16x16x32_bf16 v[104:107], a[164:167], v[168:171], v[104:107]
  v_cvt_pk_bf16_f32 v100, v100, v101
  v_cvt_pk_bf16_f32 v101, v102, v103
  v_mfma_f32_16x16x32_bf16 v[68:71], a[228:231], v[176:179], v[68:71]
  ds_write_b64 v230, v[100:101] offset:0
  v_mfma_f32_16x16x32_bf16 v[88:91], a[228:231], v[180:183], v[88:91]
  v_cvt_pk_bf16_f32 v64, v64, v65
  v_cvt_pk_bf16_f32 v65, v66, v67
  v_mfma_f32_16x16x32_bf16 v[108:111], a[228:231], v[184:187], v[108:111]
  ds_write_b64 v228, v[64:65] offset:512
  s_waitcnt vmcnt(2)
  v_mfma_f32_16x16x32_bf16 v[68:71], a[168:171], v[160:163], v[68:71]
  v_cvt_pk_bf16_f32 v84, v84, v85
  v_cvt_pk_bf16_f32 v85, v86, v87
  v_mfma_f32_16x16x32_bf16 v[88:91], a[168:171], v[164:167], v[88:91]
  ds_write_b64 v229, v[84:85] offset:512
  v_mfma_f32_16x16x32_bf16 v[108:111], a[168:171], v[168:171], v[108:111]
  v_cvt_pk_bf16_f32 v104, v104, v105
  v_cvt_pk_bf16_f32 v105, v106, v107
  v_mfma_f32_16x16x32_bf16 v[72:75], a[232:235], v[176:179], v[72:75]
  ds_write_b64 v230, v[104:105] offset:512
  v_mfma_f32_16x16x32_bf16 v[92:95], a[232:235], v[180:183], v[92:95]
  v_cvt_pk_bf16_f32 v68, v68, v69
  v_cvt_pk_bf16_f32 v69, v70, v71
  v_mfma_f32_16x16x32_bf16 v[112:115], a[232:235], v[184:187], v[112:115]
  ds_write_b64 v228, v[68:69] offset:1024
  s_waitcnt vmcnt(1)
  v_mfma_f32_16x16x32_bf16 v[72:75], a[172:175], v[160:163], v[72:75]
  v_cvt_pk_bf16_f32 v88, v88, v89
  v_cvt_pk_bf16_f32 v89, v90, v91
  v_mfma_f32_16x16x32_bf16 v[92:95], a[172:175], v[164:167], v[92:95]
  ds_write_b64 v229, v[88:89] offset:1024
  v_mfma_f32_16x16x32_bf16 v[112:115], a[172:175], v[168:171], v[112:115]
  v_cvt_pk_bf16_f32 v108, v108, v109
  v_cvt_pk_bf16_f32 v109, v110, v111
  v_mfma_f32_16x16x32_bf16 v[76:79], a[236:239], v[176:179], v[76:79]
  ds_write_b64 v230, v[108:109] offset:1024
  v_mfma_f32_16x16x32_bf16 v[96:99], a[236:239], v[180:183], v[96:99]
  v_cvt_pk_bf16_f32 v72, v72, v73
  v_cvt_pk_bf16_f32 v73, v74, v75
  v_mfma_f32_16x16x32_bf16 v[116:119], a[236:239], v[184:187], v[116:119]
  ds_write_b64 v228, v[72:73] offset:1536
  s_waitcnt vmcnt(0)
  v_mfma_f32_16x16x32_bf16 v[76:79], a[176:179], v[160:163], v[76:79]
  v_cvt_pk_bf16_f32 v92, v92, v93
  v_cvt_pk_bf16_f32 v93, v94, v95
  v_mfma_f32_16x16x32_bf16 v[96:99], a[176:179], v[164:167], v[96:99]
  ds_write_b64 v229, v[92:93] offset:1536
  v_mfma_f32_16x16x32_bf16 v[116:119], a[176:179], v[168:171], v[116:119]
  v_cvt_pk_bf16_f32 v112, v112, v113
  v_cvt_pk_bf16_f32 v113, v114, v115
  v_mfma_f32_16x16x32_bf16 v[188:191], a[220:223], v[32:35], v[188:191]
  ds_write_b64 v230, v[112:113] offset:1536
  v_mfma_f32_16x16x32_bf16 v[192:195], a[224:227], v[32:35], v[192:195]
  v_cvt_pk_bf16_f32 v76, v76, v77
  v_cvt_pk_bf16_f32 v77, v78, v79
  v_mfma_f32_16x16x32_bf16 v[196:199], a[228:231], v[32:35], v[196:199]
  ds_write_b64 v228, v[76:77] offset:2048
  v_mfma_f32_16x16x32_bf16 v[200:203], a[232:235], v[32:35], v[200:203]
  v_cvt_pk_bf16_f32 v96, v96, v97
  v_cvt_pk_bf16_f32 v97, v98, v99
  v_mfma_f32_16x16x32_bf16 v[204:207], a[236:239], v[32:35], v[204:207]
  ds_write_b64 v229, v[96:97] offset:2048
  v_mfma_f32_16x16x32_bf16 v[188:191], a[160:163], v[28:31], v[188:191]
  v_cvt_pk_bf16_f32 v116, v116, v117
  v_cvt_pk_bf16_f32 v117, v118, v119
  v_mfma_f32_16x16x32_bf16 v[192:195], a[164:167], v[28:31], v[192:195]
  ds_write_b64 v230, v[116:117] offset:2048
  s_waitcnt lgkmcnt(0)
  s_barrier
  ds_read2st64_b64 v[156:159], v231 offset0:0 offset1:5
  ds_read_b64 v[208:209], v231 offset:5120
  v_mfma_f32_16x16x32_bf16 v[196:199], a[168:171], v[28:31], v[196:199]
  ds_read2st64_b64 v[160:163], v231 offset0:1 offset1:6
  ds_read_b64 v[212:213], v231 offset:5632
  v_mfma_f32_16x16x32_bf16 v[200:203], a[172:175], v[28:31], v[200:203]
  ds_read2st64_b64 v[164:167], v231 offset0:2 offset1:7
  ds_read_b64 v[216:217], v231 offset:6144
  v_mfma_f32_16x16x32_bf16 v[204:207], a[176:179], v[28:31], v[204:207]
  ds_read2st64_b64 v[168:171], v231 offset0:3 offset1:8
  ds_read_b64 v[224:225], v231 offset:6656
  ds_read2st64_b64 v[172:175], v231 offset0:4 offset1:9
  ds_read_b64 v[120:121], v231 offset:7168
  s_waitcnt lgkmcnt(9)
  v_mfma_f32_16x16x32_bf16 v[188:191], v[220:223], v[156:159], v[188:191]
  s_waitcnt lgkmcnt(7)
  v_mfma_f32_16x16x32_bf16 v[192:195], v[220:223], v[160:163], v[192:195]
  s_waitcnt lgkmcnt(5)
  v_mfma_f32_16x16x32_bf16 v[196:199], v[220:223], v[164:167], v[196:199]
  v_mfma_f32_16x16x32_bf16 v[188:191], v[220:223], v[208:211], v[188:191]
  s_waitcnt lgkmcnt(3)
  v_mfma_f32_16x16x32_bf16 v[200:203], v[220:223], v[168:171], v[200:203]
  v_mfma_f32_16x16x32_bf16 v[192:195], v[220:223], v[212:215], v[192:195]
  s_waitcnt lgkmcnt(1)
  v_mfma_f32_16x16x32_bf16 v[204:207], v[220:223], v[172:175], v[204:207]
  v_mfma_f32_16x16x32_bf16 v[196:199], v[220:223], v[216:219], v[196:199]
  v_mfma_f32_16x16x32_bf16 v[200:203], v[220:223], v[224:227], v[200:203]
  s_waitcnt lgkmcnt(0)
  v_mfma_f32_16x16x32_bf16 v[204:207], v[220:223], v[120:123], v[204:207]
  v_cvt_pk_bf16_f32 v124, v188, v189
  v_cvt_pk_bf16_f32 v125, v190, v191
  v_cvt_pk_bf16_f32 v126, v192, v193
  v_cvt_pk_bf16_f32 v127, v194, v195
  s_nop 0
  v_permlane16_swap_b32 v124, v126
  v_permlane16_swap_b32 v125, v127
  buffer_store_dwordx4 v[124:127], v235, s[48:51], 0 offen offset:0
  v_cvt_pk_bf16_f32 v128, v196, v197
  v_cvt_pk_bf16_f32 v129, v198, v199
  v_cvt_pk_bf16_f32 v130, v200, v201
  v_cvt_pk_bf16_f32 v131, v202, v203
  s_nop 0
  v_permlane16_swap_b32 v128, v130
  v_permlane16_swap_b32 v129, v131
  buffer_store_dwordx4 v[128:131], v235, s[48:51], 0 offen offset:64
  v_cvt_pk_bf16_f32 v132, v204, v205
  v_cvt_pk_bf16_f32 v133, v206, v207
  buffer_store_dwordx2 v[132:133], v236, s[48:51], 0 offen offset:128
  s_endpgm
L_nop2:
  buffer_load_dwordx4 a[104:107], v25, s[44:47], s23 offen offset:0 sc1
  v_and_b32 v44, 15, v0
  v_lshrrev_b32 v45, 4, v0
  s_lshl_b32 s5, s79, 1
  s_add_u32 s4, s5, s25
  v_lshl_add_u32 v46, v44, 6, s4
  v_cvt_f32_u32 v46, v46
  v_mul_f32 v46, 0x3a000000, v46
  s_lshl_b32 s5, s24, 4
  v_lshl_add_u32 v47, v45, 2, s5
  v_cvt_f32_u32 v47, v47
  v_mul_f32 v47, v47, v46
  v_cos_f32 v48, v47
  v_sin_f32 v49, v47
  v_add_f32 v47, v47, v46
  v_cvt_pk_bf16_f32 v124, v48, -v49
  v_cvt_pk_bf16_f32 v128, v49, v48
  v_cvt_pk_bf16_f32 v132, v48, -v49
  v_cvt_pk_bf16_f32 v136, v49, v48
  v_cos_f32 v48, v47
  v_sin_f32 v49, v47
  v_add_f32 v47, v47, v46
  v_cvt_pk_bf16_f32 v125, v48, -v49
  v_cvt_pk_bf16_f32 v129, v49, v48
  v_cvt_pk_bf16_f32 v133, -v48, v49
  v_cvt_pk_bf16_f32 v137, -v49, -v48
  buffer_load_dwordx4 a[108:111], v27, s[44:47], s23 offen offset:0 sc1
  v_cos_f32 v48, v47
  v_sin_f32 v49, v47
  v_add_f32 v47, v47, v46
  v_cvt_pk_bf16_f32 v126, v48, -v49
  v_cvt_pk_bf16_f32 v130, v49, v48
  v_cvt_pk_bf16_f32 v134, v48, -v49
  v_cvt_pk_bf16_f32 v138, v49, v48
  v_cos_f32 v48, v47
  v_sin_f32 v49, v47
  v_add_f32 v47, v47, v46
  v_cvt_pk_bf16_f32 v127, v48, -v49
  v_cvt_pk_bf16_f32 v131, v49, v48
  v_cvt_pk_bf16_f32 v135, -v48, v49
  v_cvt_pk_bf16_f32 v139, -v49, -v48
  v_add_u32 v241, s26, v10
  ds_write_b128 v241, v[124:127] offset:0
  ds_write_b128 v241, v[128:131] offset:1024
  ds_write_b128 v241, v[132:135] offset:2048
  ds_write_b128 v241, v[136:139] offset:3072
  s_xor_b32 s5, s25, 0
  s_mul_i32 s5, s5, 12288
  s_lshl_b32 s6, s24, 11
  s_add_u32 s5, s5, s6
  s_add_u32 s5, s5, 40960
  v_add_u32 v242, s5, v10
  s_waitcnt vmcnt(9)
  v_mfma_f32_16x16x32_bf16 v[188:191], a[160:163], a[80:83], 0
  s_add_u32 s22, s19, 8192
  v_xor_b32 v243, 2048, v242
  v_mfma_f32_16x16x32_bf16 v[192:195], a[164:167], a[80:83], 0
  s_xor_b32 s5, s25, 1
  s_mul_i32 s5, s5, 12288
  v_mfma_f32_16x16x32_bf16 v[196:199], a[168:171], a[80:83], 0
  buffer_load_dwordx4 a[112:115], v25, s[44:47], s22 offen offset:0 sc1
  v_mfma_f32_16x16x32_bf16 v[200:203], a[172:175], a[80:83], 0
  s_add_u32 s23, s22, s12
  s_lshl_b32 s6, s24, 11
  v_mfma_f32_16x16x32_bf16 v[204:207], a[176:179], a[80:83], 0
  buffer_load_dwordx4 a[116:119], v27, s[44:47], s22 offen offset:0 sc1
  s_waitcnt vmcnt(10)
  v_mfma_f32_16x16x32_bf16 v[60:63], a[160:163], a[84:87], 0
  s_add_u32 s5, s5, s6
  s_add_u32 s5, s5, 40960
  v_mfma_f32_16x16x32_bf16 v[64:67], a[164:167], a[84:87], 0
  buffer_load_dwordx4 a[120:123], v25, s[44:47], s23 offen offset:0 sc1
  v_mfma_f32_16x16x32_bf16 v[68:71], a[168:171], a[84:87], 0
  v_add_u32 v244, s5, v10
  v_xor_b32 v245, 2048, v244
  v_mfma_f32_16x16x32_bf16 v[72:75], a[172:175], a[84:87], 0
  buffer_load_dwordx4 a[124:127], v27, s[44:47], s23 offen offset:0 sc1
  v_mfma_f32_16x16x32_bf16 v[76:79], a[176:179], a[84:87], 0
  s_add_u32 s22, s19, 10240
  s_waitcnt vmcnt(11)
  v_mfma_f32_16x16x32_bf16 v[80:83], a[160:163], a[88:91], 0
  buffer_load_dwordx4 a[128:131], v25, s[44:47], s22 offen offset:0 sc1
  v_mfma_f32_16x16x32_bf16 v[84:87], a[164:167], a[88:91], 0
  s_add_u32 s23, s22, s12
  v_mfma_f32_16x16x32_bf16 v[88:91], a[168:171], a[88:91], 0
  buffer_load_dwordx4 a[132:135], v27, s[44:47], s22 offen offset:0 sc1
  v_mfma_f32_16x16x32_bf16 v[92:95], a[172:175], a[88:91], 0
  v_mfma_f32_16x16x32_bf16 v[96:99], a[176:179], a[88:91], 0
  buffer_load_dwordx4 a[136:139], v25, s[44:47], s23 offen offset:0 sc1
  s_waitcnt vmcnt(13)
  v_mfma_f32_16x16x32_bf16 v[100:103], a[160:163], a[92:95], 0
  v_mfma_f32_16x16x32_bf16 v[104:107], a[164:167], a[92:95], 0
  buffer_load_dwordx4 a[140:143], v27, s[44:47], s23 offen offset:0 sc1
  v_mfma_f32_16x16x32_bf16 v[108:111], a[168:171], a[92:95], 0
  v_mfma_f32_16x16x32_bf16 v[112:115], a[172:175], a[92:95], 0
  v_mfma_f32_16x16x32_bf16 v[116:119], a[176:179], a[92:95], 0
  s_waitcnt vmcnt(10)
  buffer_store_dword v253, v252, s[44:47], s27 offen sc1
  v_mfma_f32_16x16x32_bf16 v[188:191], a[180:183], a[96:99], v[188:191]
  s_add_u32 s22, s19, 12288
  v_mul_u32_u24 v46, 81920, v44
  v_mfma_f32_16x16x32_bf16 v[192:195], a[184:187], a[96:99], v[192:195]
  v_add_u32 v46, s64, v46
  v_lshl_add_u32 v236, v45, 3, v46
  v_mfma_f32_16x16x32_bf16 v[196:199], a[188:191], a[96:99], v[196:199]
  buffer_load_dwordx4 a[144:147], v25, s[44:47], s22 offen offset:0 sc1
  v_mfma_f32_16x16x32_bf16 v[200:203], a[192:195], a[96:99], v[200:203]
  s_add_u32 s23, s22, s12
  v_and_b32 v47, 1, v45
  v_mfma_f32_16x16x32_bf16 v[204:207], a[196:199], a[96:99], v[204:207]
  buffer_load_dwordx4 a[148:151], v27, s[44:47], s22 offen offset:0 sc1
  v_mfma_f32_16x16x32_bf16 v[60:63], a[180:183], a[100:103], v[60:63]
  v_lshl_add_u32 v46, v47, 5, v46
  v_lshrrev_b32 v47, 1, v45
  v_mfma_f32_16x16x32_bf16 v[64:67], a[184:187], a[100:103], v[64:67]
  buffer_load_dwordx4 a[152:155], v25, s[44:47], s23 offen offset:0 sc1
  v_mfma_f32_16x16x32_bf16 v[68:71], a[188:191], a[100:103], v[68:71]
  v_lshl_add_u32 v235, v47, 4, v46
  v_lshrrev_b32 v46, 3, v0
  v_mfma_f32_16x16x32_bf16 v[72:75], a[192:195], a[100:103], v[72:75]
  buffer_load_dwordx4 a[156:159], v27, s[44:47], s23 offen offset:0 sc1
  v_mfma_f32_16x16x32_bf16 v[76:79], a[196:199], a[100:103], v[76:79]
  s_add_u32 s17, s16, 245760
  s_waitcnt vmcnt(14)
  v_mfma_f32_16x16x32_bf16 v[80:83], a[180:183], a[104:107], v[80:83]
  buffer_load_dwordx4 a[160:163], v10, s[44:47], s17 offen offset:0 sc1
  v_mfma_f32_16x16x32_bf16 v[84:87], a[184:187], a[104:107], v[84:87]
  s_add_u32 s18, s17, 4096
  v_mfma_f32_16x16x32_bf16 v[88:91], a[188:191], a[104:107], v[88:91]
  buffer_load_dwordx4 a[164:167], v10, s[44:47], s17 offen offset:1024 sc1
  v_mfma_f32_16x16x32_bf16 v[92:95], a[192:195], a[104:107], v[92:95]
  v_mfma_f32_16x16x32_bf16 v[96:99], a[196:199], a[104:107], v[96:99]
  buffer_load_dwordx4 a[168:171], v10, s[44:47], s17 offen offset:2048 sc1
  s_waitcnt vmcnt(16)
  v_mfma_f32_16x16x32_bf16 v[100:103], a[180:183], a[108:111], v[100:103]
  v_mfma_f32_16x16x32_bf16 v[104:107], a[184:187], a[108:111], v[104:107]
  buffer_load_dwordx4 a[172:175], v10, s[44:47], s17 offen offset:3072 sc1
  v_mfma_f32_16x16x32_bf16 v[108:111], a[188:191], a[108:111], v[108:111]
  v_mfma_f32_16x16x32_bf16 v[112:115], a[192:195], a[108:111], v[112:115]
  buffer_load_dwordx4 a[176:179], v10, s[44:47], s18 offen sc1
  v_mfma_f32_16x16x32_bf16 v[116:119], a[196:199], a[108:111], v[116:119]
  s_waitcnt vmcnt(17)
  v_mfma_f32_16x16x32_bf16 v[188:191], a[200:203], a[112:115], v[188:191]
  s_add_u32 s22, s19, 14336
  v_cmp_lt_u32 vcc, 4, v46
  v_mfma_f32_16x16x32_bf16 v[192:195], a[204:207], a[112:115], v[192:195]
  s_mul_i32 s5, s60, 5
  v_add_u32 v46, s5, v46
  v_mfma_f32_16x16x32_bf16 v[196:199], a[208:211], a[112:115], v[196:199]
  buffer_load_dwordx4 a[80:83], v25, s[44:47], s22 offen offset:0 sc1
  v_mfma_f32_16x16x32_bf16 v[200:203], a[212:215], a[112:115], v[200:203]
  s_add_u32 s23, s22, s12
  v_and_b32 v47, 7, v0
  v_mfma_f32_16x16x32_bf16 v[204:207], a[216:219], a[112:115], v[204:207]
  buffer_load_dwordx4 a[84:87], v27, s[44:47], s22 offen offset:0 sc1
  s_waitcnt vmcnt(18)
  v_mfma_f32_16x16x32_bf16 v[60:63], a[200:203], a[116:119], v[60:63]
  v_cndmask_b32 v46, v46, 20, vcc
  s_lshr_b32 s5, s79, 3
  v_mfma_f32_16x16x32_bf16 v[64:67], a[204:207], a[116:119], v[64:67]
  buffer_load_dwordx4 a[88:91], v25, s[44:47], s23 offen offset:0 sc1
  v_mfma_f32_16x16x32_bf16 v[68:71], a[208:211], a[116:119], v[68:71]
  s_mul_i32 s5, s5, 672
  s_add_u32 s5, s5, 16263168
  v_mfma_f32_16x16x32_bf16 v[72:75], a[212:215], a[116:119], v[72:75]
  buffer_load_dwordx4 a[92:95], v27, s[44:47], s23 offen offset:0 sc1
  v_mfma_f32_16x16x32_bf16 v[76:79], a[216:219], a[116:119], v[76:79]
  s_add_u32 s17, s16, 286720
  s_waitcnt vmcnt(19)
  v_mfma_f32_16x16x32_bf16 v[80:83], a[200:203], a[120:123], v[80:83]
  buffer_load_dwordx4 a[180:183], v10, s[44:47], s17 offen offset:0 sc1
  v_mfma_f32_16x16x32_bf16 v[84:87], a[204:207], a[120:123], v[84:87]
  s_add_u32 s18, s17, 4096
  v_mfma_f32_16x16x32_bf16 v[88:91], a[208:211], a[120:123], v[88:91]
  buffer_load_dwordx4 a[184:187], v10, s[44:47], s17 offen offset:1024 sc1
  v_mfma_f32_16x16x32_bf16 v[92:95], a[212:215], a[120:123], v[92:95]
  v_mfma_f32_16x16x32_bf16 v[96:99], a[216:219], a[120:123], v[96:99]
  buffer_load_dwordx4 a[188:191], v10, s[44:47], s17 offen offset:2048 sc1
  s_waitcnt vmcnt(21)
  v_mfma_f32_16x16x32_bf16 v[100:103], a[200:203], a[124:127], v[100:103]
  v_mfma_f32_16x16x32_bf16 v[104:107], a[204:207], a[124:127], v[104:107]
  buffer_load_dwordx4 a[192:195], v10, s[44:47], s17 offen offset:3072 sc1
  v_mfma_f32_16x16x32_bf16 v[108:111], a[208:211], a[124:127], v[108:111]
  v_mfma_f32_16x16x32_bf16 v[112:115], a[212:215], a[124:127], v[112:115]
  buffer_load_dwordx4 a[196:199], v10, s[44:47], s18 offen sc1
  v_mfma_f32_16x16x32_bf16 v[116:119], a[216:219], a[124:127], v[116:119]
  s_waitcnt lgkmcnt(0)
  s_barrier
  s_waitcnt vmcnt(22)
  v_mfma_f32_16x16x32_bf16 v[188:191], a[220:223], a[128:131], v[188:191]
  s_add_u32 s22, s19, 20480
  v_lshl_add_u32 v46, v46, 3, v47
  v_mfma_f32_16x16x32_bf16 v[192:195], a[224:227], a[128:131], v[192:195]
  v_lshl_add_u32 v240, v46, 2, s5
  v_cmp_eq_u32 vcc, 0, v44
  v_mfma_f32_16x16x32_bf16 v[196:199], a[228:231], a[128:131], v[196:199]
  buffer_load_dwordx4 a[96:99], v25, s[44:47], s22 offen offset:0 sc1
  v_mfma_f32_16x16x32_bf16 v[200:203], a[232:235], a[128:131], v[200:203]
  s_add_u32 s23, s22, s12
  v_add_u32 v46, 40960, v10
  v_mfma_f32_16x16x32_bf16 v[204:207], a[236:239], a[128:131], v[204:207]
  buffer_load_dwordx4 a[100:103], v27, s[44:47], s22 offen offset:0 sc1
  s_waitcnt vmcnt(23)
  v_mfma_f32_16x16x32_bf16 v[60:63], a[220:223], a[132:135], v[60:63]
  v_and_b32 v47, 1, v0
  v_cndmask_b32 v237, v10, v46, vcc
  v_mfma_f32_16x16x32_bf16 v[64:67], a[224:227], a[132:135], v[64:67]
  buffer_load_dwordx4 a[104:107], v25, s[44:47], s23 offen offset:0 sc1
  v_mfma_f32_16x16x32_bf16 v[68:71], a[228:231], a[132:135], v[68:71]
  v_lshlrev_b32 v47, 4, v47
  v_mov_b32 v46, 0x3f80
  v_mfma_f32_16x16x32_bf16 v[72:75], a[232:235], a[132:135], v[72:75]
  buffer_load_dwordx4 a[108:111], v27, s[44:47], s23 offen offset:0 sc1
  v_mfma_f32_16x16x32_bf16 v[76:79], a[236:239], a[132:135], v[76:79]
  s_add_u32 s17, s16, 409600
  s_waitcnt vmcnt(24)
  v_mfma_f32_16x16x32_bf16 v[80:83], a[220:223], a[136:139], v[80:83]
  buffer_load_dwordx4 a[200:203], v10, s[44:47], s17 offen offset:0 sc1
  v_mfma_f32_16x16x32_bf16 v[84:87], a[224:227], a[136:139], v[84:87]
  s_add_u32 s18, s17, 4096
  v_mfma_f32_16x16x32_bf16 v[88:91], a[228:231], a[136:139], v[88:91]
  buffer_load_dwordx4 a[204:207], v10, s[44:47], s17 offen offset:1024 sc1
  v_mfma_f32_16x16x32_bf16 v[92:95], a[232:235], a[136:139], v[92:95]
  v_mfma_f32_16x16x32_bf16 v[96:99], a[236:239], a[136:139], v[96:99]
  buffer_load_dwordx4 a[208:211], v10, s[44:47], s17 offen offset:2048 sc1
  s_waitcnt vmcnt(26)
  v_mfma_f32_16x16x32_bf16 v[100:103], a[220:223], a[140:143], v[100:103]
  v_mfma_f32_16x16x32_bf16 v[104:107], a[224:227], a[140:143], v[104:107]
  buffer_load_dwordx4 a[212:215], v10, s[44:47], s17 offen offset:3072 sc1
  v_mfma_f32_16x16x32_bf16 v[108:111], a[228:231], a[140:143], v[108:111]
  v_mfma_f32_16x16x32_bf16 v[112:115], a[232:235], a[140:143], v[112:115]
  buffer_load_dwordx4 a[216:219], v10, s[44:47], s18 offen sc1
  v_mfma_f32_16x16x32_bf16 v[116:119], a[236:239], a[140:143], v[116:119]
  buffer_load_dword v56, v4, s[44:47], s27 offen  sc1
  s_waitcnt vmcnt(23)
  v_mfma_f32_16x16x32_bf16 v[188:191], a[160:163], a[144:147], v[188:191]
  s_add_u32 s22, s19, 22528
  v_lshlrev_b32 v46, v47, v46
  s_waitcnt vmcnt(22)
  v_mfma_f32_16x16x32_bf16 v[192:195], a[164:167], a[144:147], v[192:195]
  v_lshrrev_b32 v47, 1, v44
  v_lshlrev_b32 v48, 1, v45
  s_waitcnt vmcnt(21)
  v_mfma_f32_16x16x32_bf16 v[196:199], a[168:171], a[144:147], v[196:199]
  buffer_load_dwordx4 a[112:115], v25, s[44:47], s22 offen offset:0 sc1
  s_waitcnt vmcnt(21)
  v_mfma_f32_16x16x32_bf16 v[200:203], a[172:175], a[144:147], v[200:203]
  s_add_u32 s23, s22, s12
  v_sub_u32 v47, v47, v48
  s_waitcnt vmcnt(20)
  v_mfma_f32_16x16x32_bf16 v[204:207], a[176:179], a[144:147], v[204:207]
  buffer_load_dwordx4 a[116:119], v27, s[44:47], s22 offen offset:0 sc1
  v_mfma_f32_16x16x32_bf16 v[60:63], a[160:163], a[148:151], v[60:63]
  v_cmp_eq_u32 vcc, 0, v47
  v_mul_u32_u24 v48, 160, v44
  v_mfma_f32_16x16x32_bf16 v[64:67], a[164:167], a[148:151], v[64:67]
  buffer_load_dwordx4 a[120:123], v25, s[44:47], s23 offen offset:0 sc1
  v_mfma_f32_16x16x32_bf16 v[68:71], a[168:171], a[148:151], v[68:71]
  v_add_u32 v48, s72, v48
  v_cndmask_b32 v220, 0, v46, vcc
  v_mfma_f32_16x16x32_bf16 v[72:75], a[172:175], a[148:151], v[72:75]
  buffer_load_dwordx4 a[124:127], v27, s[44:47], s23 offen offset:0 sc1
  v_mfma_f32_16x16x32_bf16 v[76:79], a[176:179], a[148:151], v[76:79]
  s_add_u32 s17, s16, 450560
  v_mfma_f32_16x16x32_bf16 v[80:83], a[160:163], a[152:155], v[80:83]
  buffer_load_dwordx4 a[220:223], v10, s[44:47], s17 offen offset:0 sc1
  v_mfma_f32_16x16x32_bf16 v[84:87], a[164:167], a[152:155], v[84:87]
  s_add_u32 s18, s17, 4096
  v_mfma_f32_16x16x32_bf16 v[88:91], a[168:171], a[152:155], v[88:91]
  buffer_load_dwordx4 a[224:227], v10, s[44:47], s17 offen offset:1024 sc1
  v_mfma_f32_16x16x32_bf16 v[92:95], a[172:175], a[152:155], v[92:95]
  v_mfma_f32_16x16x32_bf16 v[96:99], a[176:179], a[152:155], v[96:99]
  buffer_load_dwordx4 a[228:231], v10, s[44:47], s17 offen offset:2048 sc1
  v_mfma_f32_16x16x32_bf16 v[100:103], a[160:163], a[156:159], v[100:103]
  v_mfma_f32_16x16x32_bf16 v[104:107], a[164:167], a[156:159], v[104:107]
  buffer_load_dwordx4 a[232:235], v10, s[44:47], s17 offen offset:3072 sc1
  v_mfma_f32_16x16x32_bf16 v[108:111], a[168:171], a[156:159], v[108:111]
  v_mfma_f32_16x16x32_bf16 v[112:115], a[172:175], a[156:159], v[112:115]
  buffer_load_dwordx4 a[236:239], v10, s[44:47], s18 offen sc1
  v_mfma_f32_16x16x32_bf16 v[116:119], a[176:179], a[156:159], v[116:119]
  s_waitcnt vmcnt(9)
  v_cmp_le_u32 s[0:1], 1, v56
  s_nop 0
  s_cmp_eq_u64 s[0:1], exec
  s_cbranch_scc1 L_ok8
  s_mov_b32 s78, 65536
L_spin8:
  s_sleep 4
  buffer_load_dword v56, v4, s[44:47], s27 offen  sc1
  s_waitcnt vmcnt(0)
  v_cmp_le_u32 s[0:1], 1, v56
  s_nop 0
  s_cmp_eq_u64 s[0:1], exec
  s_cbranch_scc1 L_ok8
  s_sub_u32 s78, s78, 1
  s_cmp_lg_u32 s78, 0
  s_cbranch_scc1 L_spin8
L_ok8:
  v_mfma_f32_16x16x32_bf16 v[188:191], a[180:183], a[80:83], v[188:191]
  s_add_u32 s22, s19, 4096
  v_cndmask_b32 v222, 0, v46, vcc
  v_mfma_f32_16x16x32_bf16 v[192:195], a[184:187], a[80:83], v[192:195]
  v_cmp_eq_u32 vcc, 1, v47
  v_lshl_add_u32 v238, v45, 3, v48
  v_mfma_f32_16x16x32_bf16 v[196:199], a[188:191], a[80:83], v[196:199]
  v_lshlrev_b32 v49, 3, v0
  v_cndmask_b32 v221, 0, v46, vcc
  v_mfma_f32_16x16x32_bf16 v[200:203], a[192:195], a[80:83], v[200:203]
  v_cndmask_b32 v223, 0, v46, vcc
  s_mul_i32 s5, s60, 7680
  v_mfma_f32_16x16x32_bf16 v[204:207], a[196:199], a[80:83], v[204:207]
  buffer_load_dwordx4 a[128:131], v25, s[44:47], s22 offen offset:0 sc1
  v_mfma_f32_16x16x32_bf16 v[60:63], a[180:183], a[84:87], v[60:63]
  s_add_u32 s23, s22, s12
  s_add_u32 s5, s5, 90112
  v_mfma_f32_16x16x32_bf16 v[64:67], a[184:187], a[84:87], v[64:67]
  v_mfma_f32_16x16x32_bf16 v[68:71], a[188:191], a[84:87], v[68:71]
  v_mfma_f32_16x16x32_bf16 v[72:75], a[192:195], a[84:87], v[72:75]
  buffer_load_dwordx4 a[132:135], v27, s[44:47], s22 offen offset:0 sc1
  v_mfma_f32_16x16x32_bf16 v[76:79], a[196:199], a[84:87], v[76:79]
  v_mfma_f32_16x16x32_bf16 v[80:83], a[180:183], a[88:91], v[80:83]
  v_mfma_f32_16x16x32_bf16 v[84:87], a[184:187], a[88:91], v[84:87]
  v_mfma_f32_16x16x32_bf16 v[88:91], a[188:191], a[88:91], v[88:91]
  buffer_load_dwordx4 a[136:139], v25, s[44:47], s23 offen offset:0 sc1
  v_mfma_f32_16x16x32_bf16 v[92:95], a[192:195], a[88:91], v[92:95]
  v_mfma_f32_16x16x32_bf16 v[96:99], a[196:199], a[88:91], v[96:99]
  v_mfma_f32_16x16x32_bf16 v[100:103], a[180:183], a[92:95], v[100:103]
  v_mfma_f32_16x16x32_bf16 v[104:107], a[184:187], a[92:95], v[104:107]
  buffer_load_dwordx4 a[140:143], v27, s[44:47], s23 offen offset:0 sc1
  v_mfma_f32_16x16x32_bf16 v[108:111], a[188:191], a[92:95], v[108:111]
  v_mfma_f32_16x16x32_bf16 v[112:115], a[192:195], a[92:95], v[112:115]
  v_mfma_f32_16x16x32_bf16 v[116:119], a[196:199], a[92:95], v[116:119]
  v_mfma_f32_16x16x32_bf16 v[188:191], a[200:203], a[96:99], v[188:191]
  s_add_u32 s17, s16, 81920
  v_add_u32 v231, s5, v49
  v_mfma_f32_16x16x32_bf16 v[192:195], a[204:207], a[96:99], v[192:195]
  s_xor_b32 s5, s60, 1
  s_mul_i32 s5, s5, 7680
  v_mfma_f32_16x16x32_bf16 v[196:199], a[208:211], a[96:99], v[196:199]
  buffer_load_dwordx4 a[160:163], v10, s[44:47], s17 offen offset:0 sc1
  v_mfma_f32_16x16x32_bf16 v[200:203], a[212:215], a[96:99], v[200:203]
  s_add_u32 s18, s17, 4096
  s_add_u32 s5, s5, 90112
  v_mfma_f32_16x16x32_bf16 v[204:207], a[216:219], a[96:99], v[204:207]
  buffer_load_dwordx4 a[164:167], v10, s[44:47], s17 offen offset:1024 sc1
  v_mfma_f32_16x16x32_bf16 v[60:63], a[200:203], a[100:103], v[60:63]
  v_add_u32 v228, s5, v49
  s_xor_b32 s5, s60, 2
  v_mfma_f32_16x16x32_bf16 v[64:67], a[204:207], a[100:103], v[64:67]
  buffer_load_dwordx4 a[168:171], v10, s[44:47], s17 offen offset:2048 sc1
  v_mfma_f32_16x16x32_bf16 v[68:71], a[208:211], a[100:103], v[68:71]
  s_mul_i32 s5, s5, 7680
  s_add_u32 s5, s5, 92672
  v_mfma_f32_16x16x32_bf16 v[72:75], a[212:215], a[100:103], v[72:75]
  buffer_load_dwordx4 a[172:175], v10, s[44:47], s17 offen offset:3072 sc1
  v_mfma_f32_16x16x32_bf16 v[76:79], a[216:219], a[100:103], v[76:79]
  v_mfma_f32_16x16x32_bf16 v[80:83], a[200:203], a[104:107], v[80:83]
  buffer_load_dwordx4 a[176:179], v10, s[44:47], s18 offen sc1
  v_mfma_f32_16x16x32_bf16 v[84:87], a[204:207], a[104:107], v[84:87]
  s_add_u32 s22, s19, 6144
  v_mfma_f32_16x16x32_bf16 v[88:91], a[208:211], a[104:107], v[88:91]
  buffer_load_dwordx4 a[144:147], v25, s[44:47], s22 offen offset:0 sc1
  v_mfma_f32_16x16x32_bf16 v[92:95], a[212:215], a[104:107], v[92:95]
  s_add_u32 s23, s22, s12
  v_mfma_f32_16x16x32_bf16 v[96:99], a[216:219], a[104:107], v[96:99]
  buffer_load_dwordx4 a[148:151], v27, s[44:47], s22 offen offset:0 sc1
  v_mfma_f32_16x16x32_bf16 v[100:103], a[200:203], a[108:111], v[100:103]
  v_mfma_f32_16x16x32_bf16 v[104:107], a[204:207], a[108:111], v[104:107]
  buffer_load_dwordx4 a[152:155], v25, s[44:47], s23 offen offset:0 sc1
  v_mfma_f32_16x16x32_bf16 v[108:111], a[208:211], a[108:111], v[108:111]
  v_mfma_f32_16x16x32_bf16 v[112:115], a[212:215], a[108:111], v[112:115]
  buffer_load_dwordx4 a[156:159], v27, s[44:47], s23 offen offset:0 sc1
  v_mfma_f32_16x16x32_bf16 v[116:119], a[216:219], a[108:111], v[116:119]
  buffer_load_dword v57, v240, s[44:47], 0 offen  sc1
  s_waitcnt vmcnt(18)
  v_mfma_f32_16x16x32_bf16 v[188:191], a[220:223], a[112:115], v[188:191]
  s_add_u32 s17, s16, 122880
  v_add_u32 v229, s5, v49
  s_waitcnt vmcnt(17)
  v_mfma_f32_16x16x32_bf16 v[192:195], a[224:227], a[112:115], v[192:195]
  s_xor_b32 s5, s60, 3
  s_mul_i32 s5, s5, 7680
  s_waitcnt vmcnt(16)
  v_mfma_f32_16x16x32_bf16 v[196:199], a[228:231], a[112:115], v[196:199]
  buffer_load_dwordx4 a[180:183], v10, s[44:47], s17 offen offset:0 sc1
  s_waitcnt vmcnt(16)
  v_mfma_f32_16x16x32_bf16 v[200:203], a[232:235], a[112:115], v[200:203]
  s_add_u32 s18, s17, 4096
  s_add_u32 s5, s5, 95232
  s_waitcnt vmcnt(15)
  v_mfma_f32_16x16x32_bf16 v[204:207], a[236:239], a[112:115], v[204:207]
  buffer_load_dwordx4 a[184:187], v10, s[44:47], s17 offen offset:1024 sc1
  v_mfma_f32_16x16x32_bf16 v[60:63], a[220:223], a[116:119], v[60:63]
  v_add_u32 v230, s5, v49
  v_mfma_f32_16x16x32_bf16 v[64:67], a[224:227], a[116:119], v[64:67]
  buffer_load_dwordx4 a[188:191], v10, s[44:47], s17 offen offset:2048 sc1
  v_mfma_f32_16x16x32_bf16 v[68:71], a[228:231], a[116:119], v[68:71]
  v_mfma_f32_16x16x32_bf16 v[72:75], a[232:235], a[116:119], v[72:75]
  buffer_load_dwordx4 a[192:195], v10, s[44:47], s17 offen offset:3072 sc1
  v_mfma_f32_16x16x32_bf16 v[76:79], a[236:239], a[116:119], v[76:79]
  v_mfma_f32_16x16x32_bf16 v[80:83], a[220:223], a[120:123], v[80:83]
  buffer_load_dwordx4 a[196:199], v10, s[44:47], s18 offen sc1
  v_mfma_f32_16x16x32_bf16 v[84:87], a[224:227], a[120:123], v[84:87]
  s_add_u32 s22, s19, 16384
  v_mfma_f32_16x16x32_bf16 v[88:91], a[228:231], a[120:123], v[88:91]
  buffer_load_dwordx4 a[80:83], v25, s[44:47], s22 offen offset:0 sc1
  v_mfma_f32_16x16x32_bf16 v[92:95], a[232:235], a[120:123], v[92:95]
  s_add_u32 s23, s22, s12
  v_mfma_f32_16x16x32_bf16 v[96:99], a[236:239], a[120:123], v[96:99]
  buffer_load_dwordx4 a[84:87], v27, s[44:47], s22 offen offset:0 sc1
  v_mfma_f32_16x16x32_bf16 v[100:103], a[220:223], a[124:127], v[100:103]
  v_mfma_f32_16x16x32_bf16 v[104:107], a[224:227], a[124:127], v[104:107]
  buffer_load_dwordx4 a[88:91], v25, s[44:47], s23 offen offset:0 sc1
  v_mfma_f32_16x16x32_bf16 v[108:111], a[228:231], a[124:127], v[108:111]
  v_mfma_f32_16x16x32_bf16 v[112:115], a[232:235], a[124:127], v[112:115]
  buffer_load_dwordx4 a[92:95], v27, s[44:47], s23 offen offset:0 sc1
  v_mfma_f32_16x16x32_bf16 v[116:119], a[236:239], a[124:127], v[116:119]
  s_waitcnt vmcnt(9)
  v_cmp_le_u32 s[0:1], 1, v57
  s_nop 0
  s_cmp_eq_u64 s[0:1], exec
  s_cbranch_scc1 L_ok9
  s_mov_b32 s78, 65536
L_spin9:
  s_sleep 4
  buffer_load_dword v57, v240, s[44:47], 0 offen  sc1
  s_waitcnt vmcnt(0)
  v_cmp_le_u32 s[0:1], 1, v57
  s_nop 0
  s_cmp_eq_u64 s[0:1], exec
  s_cbranch_scc1 L_ok9
  s_sub_u32 s78, s78, 1
  s_cmp_lg_u32 s78, 0
  s_cbranch_scc1 L_spin9
L_ok9:
  v_mfma_f32_16x16x32_bf16 v[188:191], a[160:163], a[128:131], v[188:191]
  s_add_u32 s17, s16, 327680
  ds_read_b128 a[0:3], v242 offset:0
  v_mfma_f32_16x16x32_bf16 v[192:195], a[164:167], a[128:131], v[192:195]
  ds_read_b128 a[4:7], v242 offset:6144
  ds_read_b128 a[8:11], v242 offset:1024
  v_mfma_f32_16x16x32_bf16 v[196:199], a[168:171], a[128:131], v[196:199]
  buffer_load_dwordx4 a[200:203], v10, s[44:47], s17 offen offset:0 sc1
  v_mfma_f32_16x16x32_bf16 v[200:203], a[172:175], a[128:131], v[200:203]
  s_add_u32 s18, s17, 4096
  ds_read_b128 a[12:15], v242 offset:7168
  v_mfma_f32_16x16x32_bf16 v[204:207], a[176:179], a[128:131], v[204:207]
  buffer_load_dwordx4 a[204:207], v10, s[44:47], s17 offen offset:1024 sc1
  v_mfma_f32_16x16x32_bf16 v[60:63], a[160:163], a[132:135], v[60:63]
  ds_read_b128 a[16:19], v243 offset:0
  ds_read_b128 a[20:23], v243 offset:6144
  v_mfma_f32_16x16x32_bf16 v[64:67], a[164:167], a[132:135], v[64:67]
  buffer_load_dwordx4 a[208:211], v10, s[44:47], s17 offen offset:2048 sc1
  v_mfma_f32_16x16x32_bf16 v[68:71], a[168:171], a[132:135], v[68:71]
  ds_read_b128 a[24:27], v243 offset:1024
  ds_read_b128 a[28:31], v243 offset:7168
  v_mfma_f32_16x16x32_bf16 v[72:75], a[172:175], a[132:135], v[72:75]
  buffer_load_dwordx4 a[212:215], v10, s[44:47], s17 offen offset:3072 sc1
  v_mfma_f32_16x16x32_bf16 v[76:79], a[176:179], a[132:135], v[76:79]
  ds_read_b128 a[32:35], v244 offset:0
  ds_read_b128 a[36:39], v244 offset:6144
  v_mfma_f32_16x16x32_bf16 v[80:83], a[160:163], a[136:139], v[80:83]
  buffer_load_dwordx4 a[216:219], v10, s[44:47], s18 offen sc1
  v_mfma_f32_16x16x32_bf16 v[84:87], a[164:167], a[136:139], v[84:87]
  s_add_u32 s22, s20, 0
  ds_read_b128 a[40:43], v244 offset:1024
  v_mfma_f32_16x16x32_bf16 v[88:91], a[168:171], a[136:139], v[88:91]
  buffer_load_dwordx4 a[112:115], v10, s[44:47], s22 offen offset:0 sc1
  v_mfma_f32_16x16x32_bf16 v[92:95], a[172:175], a[136:139], v[92:95]
  s_add_u32 s23, s22, s13
  ds_read_b128 a[44:47], v244 offset:7168
  v_mfma_f32_16x16x32_bf16 v[96:99], a[176:179], a[136:139], v[96:99]
  buffer_load_dwordx4 a[116:119], v10, s[44:47], s22 offen offset:1024 sc1
  v_mfma_f32_16x16x32_bf16 v[100:103], a[160:163], a[140:143], v[100:103]
  ds_read_b128 a[48:51], v245 offset:0
  ds_read_b128 a[52:55], v245 offset:6144
  v_mfma_f32_16x16x32_bf16 v[104:107], a[164:167], a[140:143], v[104:107]
  buffer_load_dwordx4 a[120:123], v10, s[44:47], s23 offen offset:0 sc1
  v_mfma_f32_16x16x32_bf16 v[108:111], a[168:171], a[140:143], v[108:111]
  ds_read_b128 a[56:59], v245 offset:1024
  ds_read_b128 a[60:63], v245 offset:7168
  v_mfma_f32_16x16x32_bf16 v[112:115], a[172:175], a[140:143], v[112:115]
  buffer_load_dwordx4 a[124:127], v10, s[44:47], s23 offen offset:1024 sc1
  v_mfma_f32_16x16x32_bf16 v[116:119], a[176:179], a[140:143], v[116:119]
  s_cmp_lg_u32 s60, 0
  s_cbranch_scc1 L_nl_h
  s_add_u32 s22, s20, 0
  buffer_load_dwordx4 v[28:31], v237, s[44:47], s22 offen offset:0 sc1
  s_add_u32 s23, s22, s13
  buffer_load_dwordx4 v[32:35], v237, s[44:47], s22 offen offset:1024 sc1
  buffer_load_dwordx4 v[36:39], v237, s[44:47], s23 offen offset:0 sc1
  buffer_load_dwordx4 v[40:43], v237, s[44:47], s23 offen offset:1024 sc1
L_nl_h:
  s_waitcnt vmcnt(17)
  v_mfma_f32_16x16x32_bf16 v[188:191], a[180:183], a[144:147], v[188:191]
  s_add_u32 s22, s19, 18432
  s_waitcnt vmcnt(16)
  v_mfma_f32_16x16x32_bf16 v[192:195], a[184:187], a[144:147], v[192:195]
  s_waitcnt vmcnt(15)
  v_mfma_f32_16x16x32_bf16 v[196:199], a[188:191], a[144:147], v[196:199]
  buffer_load_dwordx4 a[96:99], v25, s[44:47], s22 offen offset:0 sc1
  s_waitcnt vmcnt(15)
  v_mfma_f32_16x16x32_bf16 v[200:203], a[192:195], a[144:147], v[200:203]
  s_add_u32 s23, s22, s12
  s_waitcnt vmcnt(14)
  v_mfma_f32_16x16x32_bf16 v[204:207], a[196:199], a[144:147], v[204:207]
  buffer_load_dwordx4 a[100:103], v27, s[44:47], s22 offen offset:0 sc1
  v_mfma_f32_16x16x32_bf16 v[60:63], a[180:183], a[148:151], v[60:63]
  v_mfma_f32_16x16x32_bf16 v[64:67], a[184:187], a[148:151], v[64:67]
  buffer_load_dwordx4 a[104:107], v25, s[44:47], s23 offen offset:0 sc1
  v_mfma_f32_16x16x32_bf16 v[68:71], a[188:191], a[148:151], v[68:71]
  v_mfma_f32_16x16x32_bf16 v[72:75], a[192:195], a[148:151], v[72:75]
  buffer_load_dwordx4 a[108:111], v27, s[44:47], s23 offen offset:0 sc1
  v_mfma_f32_16x16x32_bf16 v[76:79], a[196:199], a[148:151], v[76:79]
  s_add_u32 s17, s16, 368640
  v_mfma_f32_16x16x32_bf16 v[80:83], a[180:183], a[152:155], v[80:83]
  buffer_load_dwordx4 a[220:223], v10, s[44:47], s17 offen offset:0 sc1
  v_mfma_f32_16x16x32_bf16 v[84:87], a[184:187], a[152:155], v[84:87]
  s_add_u32 s18, s17, 4096
  v_mfma_f32_16x16x32_bf16 v[88:91], a[188:191], a[152:155], v[88:91]
  buffer_load_dwordx4 a[224:227], v10, s[44:47], s17 offen offset:1024 sc1
  v_mfma_f32_16x16x32_bf16 v[92:95], a[192:195], a[152:155], v[92:95]
  v_mfma_f32_16x16x32_bf16 v[96:99], a[196:199], a[152:155], v[96:99]
  buffer_load_dwordx4 a[228:231], v10, s[44:47], s17 offen offset:2048 sc1
  v_mfma_f32_16x16x32_bf16 v[100:103], a[180:183], a[156:159], v[100:103]
  v_mfma_f32_16x16x32_bf16 v[104:107], a[184:187], a[156:159], v[104:107]
  buffer_load_dwordx4 a[232:235], v10, s[44:47], s17 offen offset:3072 sc1
  v_mfma_f32_16x16x32_bf16 v[108:111], a[188:191], a[156:159], v[108:111]
  v_mfma_f32_16x16x32_bf16 v[112:115], a[192:195], a[156:159], v[112:115]
  buffer_load_dwordx4 a[236:239], v10, s[44:47], s18 offen sc1
  v_mfma_f32_16x16x32_bf16 v[116:119], a[196:199], a[156:159], v[116:119]
  s_waitcnt vmcnt(17)
  v_mfma_f32_16x16x32_bf16 v[188:191], a[200:203], a[80:83], v[188:191]
  s_add_u32 s22, s20, 2048
  s_waitcnt vmcnt(16)
  v_mfma_f32_16x16x32_bf16 v[192:195], a[204:207], a[80:83], v[192:195]
  s_waitcnt vmcnt(15)
  v_mfma_f32_16x16x32_bf16 v[196:199], a[208:211], a[80:83], v[196:199]
  buffer_load_dwordx4 a[128:131], v10, s[44:47], s22 offen offset:0 sc1
  s_waitcnt vmcnt(15)
  v_mfma_f32_16x16x32_bf16 v[200:203], a[212:215], a[80:83], v[200:203]
  s_add_u32 s23, s22, s13
  s_waitcnt vmcnt(14)
  v_mfma_f32_16x16x32_bf16 v[204:207], a[216:219], a[80:83], v[204:207]
  buffer_load_dwordx4 a[132:135], v10, s[44:47], s22 offen offset:1024 sc1
  v_mfma_f32_16x16x32_bf16 v[60:63], a[200:203], a[84:87], v[60:63]
  v_mfma_f32_16x16x32_bf16 v[64:67], a[204:207], a[84:87], v[64:67]
  buffer_load_dwordx4 a[136:139], v10, s[44:47], s23 offen offset:0 sc1
  v_mfma_f32_16x16x32_bf16 v[68:71], a[208:211], a[84:87], v[68:71]
  v_mfma_f32_16x16x32_bf16 v[72:75], a[212:215], a[84:87], v[72:75]
  buffer_load_dwordx4 a[140:143], v10, s[44:47], s23 offen offset:1024 sc1
  v_mfma_f32_16x16x32_bf16 v[76:79], a[216:219], a[84:87], v[76:79]
  s_add_u32 s17, s21, 0
  v_mfma_f32_16x16x32_bf16 v[80:83], a[200:203], a[88:91], v[80:83]
  buffer_load_dwordx4 a[160:163], v10, s[44:47], s17 offen offset:0 sc1
  v_mfma_f32_16x16x32_bf16 v[84:87], a[204:207], a[88:91], v[84:87]
  s_add_u32 s18, s17, 4096
  v_mfma_f32_16x16x32_bf16 v[88:91], a[208:211], a[88:91], v[88:91]
  buffer_load_dwordx4 a[164:167], v10, s[44:47], s17 offen offset:1024 sc1
  v_mfma_f32_16x16x32_bf16 v[92:95], a[212:215], a[88:91], v[92:95]
  v_mfma_f32_16x16x32_bf16 v[96:99], a[216:219], a[88:91], v[96:99]
  buffer_load_dwordx4 a[168:171], v10, s[44:47], s17 offen offset:2048 sc1
  v_mfma_f32_16x16x32_bf16 v[100:103], a[200:203], a[92:95], v[100:103]
  v_mfma_f32_16x16x32_bf16 v[104:107], a[204:207], a[92:95], v[104:107]
  buffer_load_dwordx4 a[172:175], v10, s[44:47], s17 offen offset:3072 sc1
  v_mfma_f32_16x16x32_bf16 v[108:111], a[208:211], a[92:95], v[108:111]
  v_mfma_f32_16x16x32_bf16 v[112:115], a[212:215], a[92:95], v[112:115]
  buffer_load_dwordx4 a[176:179], v10, s[44:47], s18 offen sc1
  v_mfma_f32_16x16x32_bf16 v[116:119], a[216:219], a[92:95], v[116:119]
  s_cmp_lg_u32 s60, 0
  s_cbranch_scc1 L_na_h
  s_waitcnt vmcnt(21) lgkmcnt(15)
  v_mfma_f32_16x16x32_bf16 v[124:127], a[112:115], a[0:3], 0
  s_add_u32 s22, s20, 4096
  s_waitcnt lgkmcnt(13)
  v_mfma_f32_16x16x32_bf16 v[128:131], v[28:31], a[8:11], 0
  s_waitcnt lgkmcnt(11)
  v_mfma_f32_16x16x32_bf16 v[132:135], a[112:115], a[16:19], 0
  s_waitcnt lgkmcnt(9)
  v_mfma_f32_16x16x32_bf16 v[136:139], v[28:31], a[24:27], 0
  s_waitcnt vmcnt(19) lgkmcnt(7)
  v_mfma_f32_16x16x32_bf16 v[140:143], a[120:123], a[32:35], 0
  buffer_load_dwordx4 a[144:147], v10, s[44:47], s22 offen offset:0 sc1
  s_waitcnt lgkmcnt(5)
  v_mfma_f32_16x16x32_bf16 v[144:147], v[36:39], a[40:43], 0
  s_add_u32 s23, s22, s13
  s_waitcnt lgkmcnt(3)
  v_mfma_f32_16x16x32_bf16 v[148:151], a[120:123], a[48:51], 0
  s_waitcnt lgkmcnt(1)
  v_mfma_f32_16x16x32_bf16 v[152:155], v[36:39], a[56:59], 0
  v_mfma_f32_16x16x32_bf16 v[124:127], a[116:119], a[4:7], v[124:127]
  buffer_load_dwordx4 a[148:151], v10, s[44:47], s22 offen offset:1024 sc1
  v_mfma_f32_16x16x32_bf16 v[128:131], v[32:35], a[12:15], v[128:131]
  v_mfma_f32_16x16x32_bf16 v[132:135], a[116:119], a[20:23], v[132:135]
  v_mfma_f32_16x16x32_bf16 v[136:139], v[32:35], a[28:31], v[136:139]
  s_waitcnt vmcnt(20)
  v_mfma_f32_16x16x32_bf16 v[140:143], a[124:127], a[36:39], v[140:143]
  buffer_load_dwordx4 a[152:155], v10, s[44:47], s23 offen offset:0 sc1
  v_mfma_f32_16x16x32_bf16 v[144:147], v[40:43], a[44:47], v[144:147]
  v_mfma_f32_16x16x32_bf16 v[148:151], a[124:127], a[52:55], v[148:151]
  s_waitcnt lgkmcnt(0)
  v_mfma_f32_16x16x32_bf16 v[152:155], v[40:43], a[60:63], v[152:155]
  buffer_load_dwordx4 a[156:159], v10, s[44:47], s23 offen offset:1024 sc1
  s_branch L_nj_h
L_na_h:
  s_waitcnt vmcnt(21) lgkmcnt(15)
  v_mfma_f32_16x16x32_bf16 v[124:127], a[112:115], a[0:3], 0
  s_add_u32 s22, s20, 4096
  s_waitcnt lgkmcnt(13)
  v_mfma_f32_16x16x32_bf16 v[128:131], a[112:115], a[8:11], 0
  s_waitcnt lgkmcnt(11)
  v_mfma_f32_16x16x32_bf16 v[132:135], a[112:115], a[16:19], 0
  s_waitcnt lgkmcnt(9)
  v_mfma_f32_16x16x32_bf16 v[136:139], a[112:115], a[24:27], 0
  s_waitcnt vmcnt(19) lgkmcnt(7)
  v_mfma_f32_16x16x32_bf16 v[140:143], a[120:123], a[32:35], 0
  buffer_load_dwordx4 a[144:147], v10, s[44:47], s22 offen offset:0 sc1
  s_waitcnt lgkmcnt(5)
  v_mfma_f32_16x16x32_bf16 v[144:147], a[120:123], a[40:43], 0
  s_add_u32 s23, s22, s13
  s_waitcnt lgkmcnt(3)
  v_mfma_f32_16x16x32_bf16 v[148:151], a[120:123], a[48:51], 0
  s_waitcnt lgkmcnt(1)
  v_mfma_f32_16x16x32_bf16 v[152:155], a[120:123], a[56:59], 0
  v_mfma_f32_16x16x32_bf16 v[124:127], a[116:119], a[4:7], v[124:127]
  buffer_load_dwordx4 a[148:151], v10, s[44:47], s22 offen offset:1024 sc1
  v_mfma_f32_16x16x32_bf16 v[128:131], a[116:119], a[12:15], v[128:131]
  v_mfma_f32_16x16x32_bf16 v[132:135], a[116:119], a[20:23], v[132:135]
  v_mfma_f32_16x16x32_bf16 v[136:139], a[116:119], a[28:31], v[136:139]
  s_waitcnt vmcnt(20)
  v_mfma_f32_16x16x32_bf16 v[140:143], a[124:127], a[36:39], v[140:143]
  buffer_load_dwordx4 a[152:155], v10, s[44:47], s23 offen offset:0 sc1
  v_mfma_f32_16x16x32_bf16 v[144:147], a[124:127], a[44:47], v[144:147]
  v_mfma_f32_16x16x32_bf16 v[148:151], a[124:127], a[52:55], v[148:151]
  s_waitcnt lgkmcnt(0)
  v_mfma_f32_16x16x32_bf16 v[152:155], a[124:127], a[60:63], v[152:155]
  buffer_load_dwordx4 a[156:159], v10, s[44:47], s23 offen offset:1024 sc1
L_nj_h:
  s_waitcnt vmcnt(13)
  v_mfma_f32_16x16x32_bf16 v[188:191], a[220:223], a[96:99], v[188:191]
  s_add_u32 s17, s21, 40960
  s_waitcnt vmcnt(12)
  v_mfma_f32_16x16x32_bf16 v[192:195], a[224:227], a[96:99], v[192:195]
  s_waitcnt vmcnt(11)
  v_mfma_f32_16x16x32_bf16 v[196:199], a[228:231], a[96:99], v[196:199]
  s_waitcnt vmcnt(10)
  v_mfma_f32_16x16x32_bf16 v[200:203], a[232:235], a[96:99], v[200:203]
  v_cvt_pk_bf16_f32 v156, v124, v128
  v_cvt_pk_bf16_f32 v157, v125, v129
  s_waitcnt vmcnt(9)
  v_mfma_f32_16x16x32_bf16 v[204:207], a[236:239], a[96:99], v[204:207]
  buffer_load_dwordx4 a[180:183], v10, s[44:47], s17 offen offset:0 sc1
  v_mfma_f32_16x16x32_bf16 v[60:63], a[220:223], a[100:103], v[60:63]
  s_add_u32 s18, s17, 4096
  v_cvt_pk_bf16_f32 v158, v126, v130
  v_mfma_f32_16x16x32_bf16 v[64:67], a[224:227], a[100:103], v[64:67]
  v_cvt_pk_bf16_f32 v159, v127, v131
  v_cvt_pk_bf16_f32 v160, v132, v136
  v_mfma_f32_16x16x32_bf16 v[68:71], a[228:231], a[100:103], v[68:71]
  v_cvt_pk_bf16_f32 v161, v133, v137
  v_cvt_pk_bf16_f32 v162, v134, v138
  v_mfma_f32_16x16x32_bf16 v[72:75], a[232:235], a[100:103], v[72:75]
  buffer_load_dwordx4 a[184:187], v10, s[44:47], s17 offen offset:1024 sc1
  v_mfma_f32_16x16x32_bf16 v[76:79], a[236:239], a[100:103], v[76:79]
  v_cvt_pk_bf16_f32 v163, v135, v139
  v_cvt_pk_bf16_f32 v164, v140, v144
  v_mfma_f32_16x16x32_bf16 v[80:83], a[220:223], a[104:107], v[80:83]
  v_cvt_pk_bf16_f32 v165, v141, v145
  v_cvt_pk_bf16_f32 v166, v142, v146
  v_mfma_f32_16x16x32_bf16 v[84:87], a[224:227], a[104:107], v[84:87]
  v_cvt_pk_bf16_f32 v167, v143, v147
  v_cvt_pk_bf16_f32 v168, v148, v152
  v_mfma_f32_16x16x32_bf16 v[88:91], a[228:231], a[104:107], v[88:91]
  buffer_load_dwordx4 a[188:191], v10, s[44:47], s17 offen offset:2048 sc1
  v_mfma_f32_16x16x32_bf16 v[92:95], a[232:235], a[104:107], v[92:95]
  v_cvt_pk_bf16_f32 v169, v149, v153
  v_cvt_pk_bf16_f32 v170, v150, v154
  v_mfma_f32_16x16x32_bf16 v[96:99], a[236:239], a[104:107], v[96:99]
  v_cvt_pk_bf16_f32 v171, v151, v155
  v_mfma_f32_16x16x32_bf16 v[100:103], a[220:223], a[108:111], v[100:103]
  v_mfma_f32_16x16x32_bf16 v[104:107], a[224:227], a[108:111], v[104:107]
  buffer_load_dwordx4 a[192:195], v10, s[44:47], s17 offen offset:3072 sc1
  v_mfma_f32_16x16x32_bf16 v[108:111], a[228:231], a[108:111], v[108:111]
  v_mfma_f32_16x16x32_bf16 v[112:115], a[232:235], a[108:111], v[112:115]
  v_mfma_f32_16x16x32_bf16 v[116:119], a[236:239], a[108:111], v[116:119]
  buffer_load_dwordx4 a[196:199], v10, s[44:47], s18 offen sc1
  s_waitcnt vmcnt(13) lgkmcnt(15)
  v_mfma_f32_16x16x32_bf16 v[124:127], a[128:131], a[0:3], 0
  s_add_u32 s22, s20, 6144
  s_waitcnt lgkmcnt(13)
  v_mfma_f32_16x16x32_bf16 v[128:131], a[128:131], a[8:11], 0
  s_waitcnt lgkmcnt(11)
  v_mfma_f32_16x16x32_bf16 v[132:135], a[128:131], a[16:19], 0
  s_waitcnt lgkmcnt(9)
  v_mfma_f32_16x16x32_bf16 v[136:139], a[128:131], a[24:27], 0
  s_waitcnt vmcnt(11) lgkmcnt(7)
  v_mfma_f32_16x16x32_bf16 v[140:143], a[136:139], a[32:35], 0
  buffer_load_dwordx4 a[80:83], v10, s[44:47], s22 offen offset:0 sc1
  s_waitcnt lgkmcnt(5)
  v_mfma_f32_16x16x32_bf16 v[144:147], a[136:139], a[40:43], 0
  s_add_u32 s23, s22, s13
  s_waitcnt lgkmcnt(3)
  v_mfma_f32_16x16x32_bf16 v[148:151], a[136:139], a[48:51], 0
  s_waitcnt lgkmcnt(1)
  v_mfma_f32_16x16x32_bf16 v[152:155], a[136:139], a[56:59], 0
  v_mfma_f32_16x16x32_bf16 v[124:127], a[132:135], a[4:7], v[124:127]
  buffer_load_dwordx4 a[84:87], v10, s[44:47], s22 offen offset:1024 sc1
  v_mfma_f32_16x16x32_bf16 v[128:131], a[132:135], a[12:15], v[128:131]
  v_mfma_f32_16x16x32_bf16 v[132:135], a[132:135], a[20:23], v[132:135]
  v_mfma_f32_16x16x32_bf16 v[136:139], a[132:135], a[28:31], v[136:139]
  s_waitcnt vmcnt(12)
  v_mfma_f32_16x16x32_bf16 v[140:143], a[140:143], a[36:39], v[140:143]
  buffer_load_dwordx4 a[88:91], v10, s[44:47], s23 offen offset:0 sc1
  v_mfma_f32_16x16x32_bf16 v[144:147], a[140:143], a[44:47], v[144:147]
  v_mfma_f32_16x16x32_bf16 v[148:151], a[140:143], a[52:55], v[148:151]
  s_waitcnt lgkmcnt(0)
  v_mfma_f32_16x16x32_bf16 v[152:155], a[140:143], a[60:63], v[152:155]
  buffer_load_dwordx4 a[92:95], v10, s[44:47], s23 offen offset:1024 sc1
  s_waitcnt vmcnt(13)
  v_mfma_f32_16x16x32_bf16 v[188:191], a[160:163], v[156:159], v[188:191]
  s_add_u32 s17, s21, 81920
  s_waitcnt vmcnt(12)
  v_mfma_f32_16x16x32_bf16 v[192:195], a[164:167], v[156:159], v[192:195]
  s_waitcnt vmcnt(11)
  v_mfma_f32_16x16x32_bf16 v[196:199], a[168:171], v[156:159], v[196:199]
  s_waitcnt vmcnt(10)
  v_mfma_f32_16x16x32_bf16 v[200:203], a[172:175], v[156:159], v[200:203]
  v_cvt_pk_bf16_f32 v172, v124, v128
  v_cvt_pk_bf16_f32 v173, v125, v129
  s_waitcnt vmcnt(9)
  v_mfma_f32_16x16x32_bf16 v[204:207], a[176:179], v[156:159], v[204:207]
  buffer_load_dwordx4 a[200:203], v10, s[44:47], s17 offen offset:0 sc1
  v_mfma_f32_16x16x32_bf16 v[60:63], a[160:163], v[160:163], v[60:63]
  s_add_u32 s18, s17, 4096
  v_cvt_pk_bf16_f32 v174, v126, v130
  v_mfma_f32_16x16x32_bf16 v[64:67], a[164:167], v[160:163], v[64:67]
  v_cvt_pk_bf16_f32 v175, v127, v131
  v_cvt_pk_bf16_f32 v176, v132, v136
  v_mfma_f32_16x16x32_bf16 v[68:71], a[168:171], v[160:163], v[68:71]
  v_cvt_pk_bf16_f32 v177, v133, v137
  v_cvt_pk_bf16_f32 v178, v134, v138
  v_mfma_f32_16x16x32_bf16 v[72:75], a[172:175], v[160:163], v[72:75]
  buffer_load_dwordx4 a[204:207], v10, s[44:47], s17 offen offset:1024 sc1
  v_mfma_f32_16x16x32_bf16 v[76:79], a[176:179], v[160:163], v[76:79]
  v_cvt_pk_bf16_f32 v179, v135, v139
  v_cvt_pk_bf16_f32 v180, v140, v144
  v_mfma_f32_16x16x32_bf16 v[80:83], a[160:163], v[164:167], v[80:83]
  v_cvt_pk_bf16_f32 v181, v141, v145
  v_cvt_pk_bf16_f32 v182, v142, v146
  v_mfma_f32_16x16x32_bf16 v[84:87], a[164:167], v[164:167], v[84:87]
  v_cvt_pk_bf16_f32 v183, v143, v147
  v_cvt_pk_bf16_f32 v184, v148, v152
  v_mfma_f32_16x16x32_bf16 v[88:91], a[168:171], v[164:167], v[88:91]
  buffer_load_dwordx4 a[208:211], v10, s[44:47], s17 offen offset:2048 sc1
  v_mfma_f32_16x16x32_bf16 v[92:95], a[172:175], v[164:167], v[92:95]
  v_cvt_pk_bf16_f32 v185, v149, v153
  v_cvt_pk_bf16_f32 v186, v150, v154
  v_mfma_f32_16x16x32_bf16 v[96:99], a[176:179], v[164:167], v[96:99]
  v_cvt_pk_bf16_f32 v187, v151, v155
  v_mfma_f32_16x16x32_bf16 v[100:103], a[160:163], v[168:171], v[100:103]
  v_mfma_f32_16x16x32_bf16 v[104:107], a[164:167], v[168:171], v[104:107]
  buffer_load_dwordx4 a[212:215], v10, s[44:47], s17 offen offset:3072 sc1
  v_mfma_f32_16x16x32_bf16 v[108:111], a[168:171], v[168:171], v[108:111]
  v_mfma_f32_16x16x32_bf16 v[112:115], a[172:175], v[168:171], v[112:115]
  v_mfma_f32_16x16x32_bf16 v[116:119], a[176:179], v[168:171], v[116:119]
  buffer_load_dwordx4 a[216:219], v10, s[44:47], s18 offen sc1
  v_mfma_f32_16x16x32_bf16 v[124:127], a[144:147], a[0:3], 0
  s_add_u32 s22, s20, 8192
  v_mfma_f32_16x16x32_bf16 v[128:131], a[144:147], a[8:11], 0
  v_mfma_f32_16x16x32_bf16 v[132:135], a[144:147], a[16:19], 0
  v_mfma_f32_16x16x32_bf16 v[136:139], a[144:147], a[24:27], 0
  v_mfma_f32_16x16x32_bf16 v[140:143], a[152:155], a[32:35], 0
  buffer_load_dwordx4 a[96:99], v10, s[44:47], s22 offen offset:0 sc1
  v_mfma_f32_16x16x32_bf16 v[144:147], a[152:155], a[40:43], 0
  s_add_u32 s23, s22, s13
  v_mfma_f32_16x16x32_bf16 v[148:151], a[152:155], a[48:51], 0
  v_mfma_f32_16x16x32_bf16 v[152:155], a[152:155], a[56:59], 0
  v_mfma_f32_16x16x32_bf16 v[124:127], a[148:151], a[4:7], v[124:127]
  buffer_load_dwordx4 a[100:103], v10, s[44:47], s22 offen offset:1024 sc1
  v_mfma_f32_16x16x32_bf16 v[128:131], a[148:151], a[12:15], v[128:131]
  v_mfma_f32_16x16x32_bf16 v[132:135], a[148:151], a[20:23], v[132:135]
  v_mfma_f32_16x16x32_bf16 v[136:139], a[148:151], a[28:31], v[136:139]
  v_mfma_f32_16x16x32_bf16 v[140:143], a[156:159], a[36:39], v[140:143]
  buffer_load_dwordx4 a[104:107], v10, s[44:47], s23 offen offset:0 sc1
  v_mfma_f32_16x16x32_bf16 v[144:147], a[156:159], a[44:47], v[144:147]
  v_mfma_f32_16x16x32_bf16 v[148:151], a[156:159], a[52:55], v[148:151]
  v_mfma_f32_16x16x32_bf16 v[152:155], a[156:159], a[60:63], v[152:155]
  buffer_load_dwordx4 a[108:111], v10, s[44:47], s23 offen offset:1024 sc1
  s_waitcnt vmcnt(17)
  v_mfma_f32_16x16x32_bf16 v[188:191], a[180:183], v[172:175], v[188:191]
  s_add_u32 s17, s21, 122880
  s_waitcnt vmcnt(16)
  v_mfma_f32_16x16x32_bf16 v[192:195], a[184:187], v[172:175], v[192:195]
  s_waitcnt vmcnt(15)
  v_mfma_f32_16x16x32_bf16 v[196:199], a[188:191], v[172:175], v[196:199]
  s_waitcnt vmcnt(14)
  v_mfma_f32_16x16x32_bf16 v[200:203], a[192:195], v[172:175], v[200:203]
  v_cvt_pk_bf16_f32 v156, v124, v128
  v_cvt_pk_bf16_f32 v157, v125, v129
  s_waitcnt vmcnt(13)
  v_mfma_f32_16x16x32_bf16 v[204:207], a[196:199], v[172:175], v[204:207]
  buffer_load_dwordx4 a[220:223], v10, s[44:47], s17 offen offset:0 sc1
  v_mfma_f32_16x16x32_bf16 v[60:63], a[180:183], v[176:179], v[60:63]
  s_add_u32 s18, s17, 4096
  v_cvt_pk_bf16_f32 v158, v126, v130
  v_mfma_f32_16x16x32_bf16 v[64:67], a[184:187], v[176:179], v[64:67]
  v_cvt_pk_bf16_f32 v159, v127, v131
  v_cvt_pk_bf16_f32 v160, v132, v136
  v_mfma_f32_16x16x32_bf16 v[68:71], a[188:191], v[176:179], v[68:71]
  v_cvt_pk_bf16_f32 v161, v133, v137
  v_cvt_pk_bf16_f32 v162, v134, v138
  v_mfma_f32_16x16x32_bf16 v[72:75], a[192:195], v[176:179], v[72:75]
  buffer_load_dwordx4 a[224:227], v10, s[44:47], s17 offen offset:1024 sc1
  v_mfma_f32_16x16x32_bf16 v[76:79], a[196:199], v[176:179], v[76:79]
  v_cvt_pk_bf16_f32 v163, v135, v139
  v_cvt_pk_bf16_f32 v164, v140, v144
  v_mfma_f32_16x16x32_bf16 v[80:83], a[180:183], v[180:183], v[80:83]
  v_cvt_pk_bf16_f32 v165, v141, v145
  v_cvt_pk_bf16_f32 v166, v142, v146
  v_mfma_f32_16x16x32_bf16 v[84:87], a[184:187], v[180:183], v[84:87]
  v_cvt_pk_bf16_f32 v167, v143, v147
  v_cvt_pk_bf16_f32 v168, v148, v152
  v_mfma_f32_16x16x32_bf16 v[88:91], a[188:191], v[180:183], v[88:91]
  buffer_load_dwordx4 a[228:231], v10, s[44:47], s17 offen offset:2048 sc1
  v_mfma_f32_16x16x32_bf16 v[92:95], a[192:195], v[180:183], v[92:95]
  v_cvt_pk_bf16_f32 v169, v149, v153
  v_cvt_pk_bf16_f32 v170, v150, v154
  v_mfma_f32_16x16x32_bf16 v[96:99], a[196:199], v[180:183], v[96:99]
  v_cvt_pk_bf16_f32 v171, v151, v155
  v_mfma_f32_16x16x32_bf16 v[100:103], a[180:183], v[184:187], v[100:103]
  v_mfma_f32_16x16x32_bf16 v[104:107], a[184:187], v[184:187], v[104:107]
  buffer_load_dwordx4 a[232:235], v10, s[44:47], s17 offen offset:3072 sc1
  v_mfma_f32_16x16x32_bf16 v[108:111], a[188:191], v[184:187], v[108:111]
  v_mfma_f32_16x16x32_bf16 v[112:115], a[192:195], v[184:187], v[112:115]
  v_mfma_f32_16x16x32_bf16 v[116:119], a[196:199], v[184:187], v[116:119]
  buffer_load_dwordx4 a[236:239], v10, s[44:47], s18 offen sc1
  s_waitcnt vmcnt(17)
  v_mfma_f32_16x16x32_bf16 v[124:127], a[80:83], a[0:3], 0
  s_add_u32 s17, s21, 163840
  v_mfma_f32_16x16x32_bf16 v[128:131], a[80:83], a[8:11], 0
  v_mfma_f32_16x16x32_bf16 v[132:135], a[80:83], a[16:19], 0
  v_mfma_f32_16x16x32_bf16 v[136:139], a[80:83], a[24:27], 0
  buffer_load_dwordx4 a[160:163], v10, s[44:47], s17 offen offset:0 sc1
  s_waitcnt vmcnt(16)
  v_mfma_f32_16x16x32_bf16 v[140:143], a[88:91], a[32:35], 0
  s_add_u32 s18, s17, 4096
  v_mfma_f32_16x16x32_bf16 v[144:147], a[88:91], a[40:43], 0
  v_mfma_f32_16x16x32_bf16 v[148:151], a[88:91], a[48:51], 0
  buffer_load_dwordx4 a[164:167], v10, s[44:47], s17 offen offset:1024 sc1
  v_mfma_f32_16x16x32_bf16 v[152:155], a[88:91], a[56:59], 0
  v_mfma_f32_16x16x32_bf16 v[124:127], a[84:87], a[4:7], v[124:127]
  v_mfma_f32_16x16x32_bf16 v[128:131], a[84:87], a[12:15], v[128:131]
  buffer_load_dwordx4 a[168:171], v10, s[44:47], s17 offen offset:2048 sc1
  v_mfma_f32_16x16x32_bf16 v[132:135], a[84:87], a[20:23], v[132:135]
  v_mfma_f32_16x16x32_bf16 v[136:139], a[84:87], a[28:31], v[136:139]
  s_waitcnt vmcnt(17)
  v_mfma_f32_16x16x32_bf16 v[140:143], a[92:95], a[36:39], v[140:143]
  buffer_load_dwordx4 a[172:175], v10, s[44:47], s17 offen offset:3072 sc1
  v_mfma_f32_16x16x32_bf16 v[144:147], a[92:95], a[44:47], v[144:147]
  v_mfma_f32_16x16x32_bf16 v[148:151], a[92:95], a[52:55], v[148:151]
  v_mfma_f32_16x16x32_bf16 v[152:155], a[92:95], a[60:63], v[152:155]
  buffer_load_dwordx4 a[176:179], v10, s[44:47], s18 offen sc1
  s_waitcnt vmcnt(18)
  v_mfma_f32_16x16x32_bf16 v[188:191], a[200:203], v[156:159], v[188:191]
  s_waitcnt vmcnt(17)
  v_mfma_f32_16x16x32_bf16 v[192:195], a[204:207], v[156:159], v[192:195]
  s_waitcnt vmcnt(16)
  v_mfma_f32_16x16x32_bf16 v[196:199], a[208:211], v[156:159], v[196:199]
  s_waitcnt vmcnt(15)
  v_mfma_f32_16x16x32_bf16 v[200:203], a[212:215], v[156:159], v[200:203]
  v_cvt_pk_bf16_f32 v32, v124, v128
  v_cvt_pk_bf16_f32 v33, v125, v129
  s_waitcnt vmcnt(14)
  v_mfma_f32_16x16x32_bf16 v[204:207], a[216:219], v[156:159], v[204:207]
  v_cvt_pk_bf16_f32 v34, v126, v130
  v_cvt_pk_bf16_f32 v35, v127, v131
  v_mfma_f32_16x16x32_bf16 v[60:63], a[200:203], v[160:163], v[60:63]
  v_cvt_pk_bf16_f32 v176, v132, v136
  v_cvt_pk_bf16_f32 v177, v133, v137
  v_mfma_f32_16x16x32_bf16 v[64:67], a[204:207], v[160:163], v[64:67]
  v_cvt_pk_bf16_f32 v178, v134, v138
  v_cvt_pk_bf16_f32 v179, v135, v139
  v_mfma_f32_16x16x32_bf16 v[68:71], a[208:211], v[160:163], v[68:71]
  v_cvt_pk_bf16_f32 v180, v140, v144
  v_cvt_pk_bf16_f32 v181, v141, v145
  v_mfma_f32_16x16x32_bf16 v[72:75], a[212:215], v[160:163], v[72:75]
  v_cvt_pk_bf16_f32 v182, v142, v146
  v_cvt_pk_bf16_f32 v183, v143, v147
  v_mfma_f32_16x16x32_bf16 v[76:79], a[216:219], v[160:163], v[76:79]
  v_cvt_pk_bf16_f32 v184, v148, v152
  v_cvt_pk_bf16_f32 v185, v149, v153
  v_mfma_f32_16x16x32_bf16 v[80:83], a[200:203], v[164:167], v[80:83]
  v_cvt_pk_bf16_f32 v186, v150, v154
  v_cvt_pk_bf16_f32 v187, v151, v155
  v_mfma_f32_16x16x32_bf16 v[84:87], a[204:207], v[164:167], v[84:87]
  v_mfma_f32_16x16x32_bf16 v[88:91], a[208:211], v[164:167], v[88:91]
  v_mfma_f32_16x16x32_bf16 v[92:95], a[212:215], v[164:167], v[92:95]
  v_mfma_f32_16x16x32_bf16 v[96:99], a[216:219], v[164:167], v[96:99]
  v_mfma_f32_16x16x32_bf16 v[100:103], a[200:203], v[168:171], v[100:103]
  v_mfma_f32_16x16x32_bf16 v[104:107], a[204:207], v[168:171], v[104:107]
  v_mfma_f32_16x16x32_bf16 v[108:111], a[208:211], v[168:171], v[108:111]
  v_mfma_f32_16x16x32_bf16 v[112:115], a[212:215], v[168:171], v[112:115]
  v_mfma_f32_16x16x32_bf16 v[116:119], a[216:219], v[168:171], v[116:119]
  s_waitcnt vmcnt(13)
  v_mfma_f32_16x16x32_bf16 v[132:135], a[96:99], a[16:19], 0
  v_mfma_f32_16x16x32_bf16 v[136:139], a[96:99], a[24:27], 0
  s_waitcnt vmcnt(11)
  v_mfma_f32_16x16x32_bf16 v[140:143], a[104:107], a[32:35], 0
  v_mfma_f32_16x16x32_bf16 v[144:147], a[104:107], a[40:43], 0
  v_mfma_f32_16x16x32_bf16 v[132:135], a[100:103], a[20:23], v[132:135]
  v_mfma_f32_16x16x32_bf16 v[136:139], a[100:103], a[28:31], v[136:139]
  s_waitcnt vmcnt(10)
  v_mfma_f32_16x16x32_bf16 v[140:143], a[108:111], a[36:39], v[140:143]
  v_mfma_f32_16x16x32_bf16 v[144:147], a[108:111], a[44:47], v[144:147]
  v_mfma_f32_16x16x32_bf16 v[148:151], a[104:107], a[48:51], 0
  v_mfma_f32_16x16x32_bf16 v[152:155], a[104:107], a[56:59], 0
  v_mfma_f32_16x16x32_bf16 v[124:127], a[96:99], a[0:3], 0
  s_nop 1
  v_cvt_pk_bf16_f32 v160, v132, v136
  v_cvt_pk_bf16_f32 v161, v133, v137
  v_mfma_f32_16x16x32_bf16 v[128:131], a[96:99], a[8:11], 0
  v_cvt_pk_bf16_f32 v162, v134, v138
  v_cvt_pk_bf16_f32 v163, v135, v139
  v_mfma_f32_16x16x32_bf16 v[148:151], a[108:111], a[52:55], v[148:151]
  v_cvt_pk_bf16_f32 v164, v140, v144
  v_cvt_pk_bf16_f32 v165, v141, v145
  v_mfma_f32_16x16x32_bf16 v[152:155], a[108:111], a[60:63], v[152:155]
  v_cvt_pk_bf16_f32 v166, v142, v146
  v_cvt_pk_bf16_f32 v167, v143, v147
  v_mfma_f32_16x16x32_bf16 v[124:127], a[100:103], a[4:7], v[124:127]
  v_mfma_f32_16x16x32_bf16 v[128:131], a[100:103], a[12:15], v[128:131]
  ds_read_b64 v[210:211], v238 offset:0
  ds_read_b64 v[214:215], v238 offset:32
  ds_read_b64 v[218:219], v238 offset:64
  ds_read_b64 v[226:227], v238 offset:96
  ds_read_b64 v[122:123], v238 offset:128
  s_waitcnt vmcnt(9)
  v_mfma_f32_16x16x32_bf16 v[60:63], a[220:223], v[176:179], v[60:63]
  v_mfma_f32_16x16x32_bf16 v[80:83], a[220:223], v[180:183], v[80:83]
  v_cvt_pk_bf16_f32 v168, v148, v152
  v_cvt_pk_bf16_f32 v169, v149, v153
  v_mfma_f32_16x16x32_bf16 v[100:103], a[220:223], v[184:187], v[100:103]
  v_cvt_pk_bf16_f32 v170, v150, v154
  v_cvt_pk_bf16_f32 v171, v151, v155
  s_waitcnt vmcnt(4)
  v_mfma_f32_16x16x32_bf16 v[60:63], a[160:163], v[160:163], v[60:63]
  v_cvt_pk_bf16_f32 v28, v124, v128
  v_cvt_pk_bf16_f32 v29, v125, v129
  v_mfma_f32_16x16x32_bf16 v[80:83], a[160:163], v[164:167], v[80:83]
  v_cvt_pk_bf16_f32 v30, v126, v130
  v_cvt_pk_bf16_f32 v31, v127, v131
  v_mfma_f32_16x16x32_bf16 v[100:103], a[160:163], v[168:171], v[100:103]
  v_mfma_f32_16x16x32_bf16 v[64:67], a[224:227], v[176:179], v[64:67]
  v_mfma_f32_16x16x32_bf16 v[84:87], a[224:227], v[180:183], v[84:87]
  v_cvt_pk_bf16_f32 v60, v60, v61
  v_cvt_pk_bf16_f32 v61, v62, v63
  v_mfma_f32_16x16x32_bf16 v[104:107], a[224:227], v[184:187], v[104:107]
  ds_write_b64 v228, v[60:61] offset:0
  s_waitcnt vmcnt(3)
  v_mfma_f32_16x16x32_bf16 v[64:67], a[164:167], v[160:163], v[64:67]
  v_cvt_pk_bf16_f32 v80, v80, v81
  v_cvt_pk_bf16_f32 v81, v82, v83
  v_mfma_f32_16x16x32_bf16 v[84:87], a[164:167], v[164:167], v[84:87]
  ds_write_b64 v229, v[80:81] offset:0
  v_mfma_f32_16x16x32_bf16 v[104:107], a[164:167], v[168:171], v[104:107]
  v_cvt_pk_bf16_f32 v100, v100, v101
  v_cvt_pk_bf16_f32 v101, v102, v103
  v_mfma_f32_16x16x32_bf16 v[68:71], a[228:231], v[176:179], v[68:71]
  ds_write_b64 v230, v[100:101] offset:0
  v_mfma_f32_16x16x32_bf16 v[88:91], a[228:231], v[180:183], v[88:91]
  v_cvt_pk_bf16_f32 v64, v64, v65
  v_cvt_pk_bf16_f32 v65, v66, v67
  v_mfma_f32_16x16x32_bf16 v[108:111], a[228:231], v[184:187], v[108:111]
  ds_write_b64 v228, v[64:65] offset:512
  s_waitcnt vmcnt(2)
  v_mfma_f32_16x16x32_bf16 v[68:71], a[168:171], v[160:163], v[68:71]
  v_cvt_pk_bf16_f32 v84, v84, v85
  v_cvt_pk_bf16_f32 v85, v86, v87
  v_mfma_f32_16x16x32_bf16 v[88:91], a[168:171], v[164:167], v[88:91]
  ds_write_b64 v229, v[84:85] offset:512
  v_mfma_f32_16x16x32_bf16 v[108:111], a[168:171], v[168:171], v[108:111]
  v_cvt_pk_bf16_f32 v104, v104, v105
  v_cvt_pk_bf16_f32 v105, v106, v107
  v_mfma_f32_16x16x32_bf16 v[72:75], a[232:235], v[176:179], v[72:75]
  ds_write_b64 v230, v[104:105] offset:512
  v_mfma_f32_16x16x32_bf16 v[92:95], a[232:235], v[180:183], v[92:95]
  v_cvt_pk_bf16_f32 v68, v68, v69
  v_cvt_pk_bf16_f32 v69, v70, v71
  v_mfma_f32_16x16x32_bf16 v[112:115], a[232:235], v[184:187], v[112:115]
  ds_write_b64 v228, v[68:69] offset:1024
  s_waitcnt vmcnt(1)
  v_mfma_f32_16x16x32_bf16 v[72:75], a[172:175], v[160:163], v[72:75]
  v_cvt_pk_bf16_f32 v88, v88, v89
  v_cvt_pk_bf16_f32 v89, v90, v91
  v_mfma_f32_16x16x32_bf16 v[92:95], a[172:175], v[164:167], v[92:95]
  ds_write_b64 v229, v[88:89] offset:1024
  v_mfma_f32_16x16x32_bf16 v[112:115], a[172:175], v[168:171], v[112:115]
  v_cvt_pk_bf16_f32 v108, v108, v109
  v_cvt_pk_bf16_f32 v109, v110, v111
  v_mfma_f32_16x16x32_bf16 v[76:79], a[236:239], v[176:179], v[76:79]
  ds_write_b64 v230, v[108:109] offset:1024
  v_mfma_f32_16x16x32_bf16 v[96:99], a[236:239], v[180:183], v[96:99]
  v_cvt_pk_bf16_f32 v72, v72, v73
  v_cvt_pk_bf16_f32 v73, v74, v75
  v_mfma_f32_16x16x32_bf16 v[116:119], a[236:239], v[184:187], v[116:119]
  ds_write_b64 v228, v[72:73] offset:1536
  s_waitcnt vmcnt(0)
  v_mfma_f32_16x16x32_bf16 v[76:79], a[176:179], v[160:163], v[76:79]
  v_cvt_pk_bf16_f32 v92, v92, v93
  v_cvt_pk_bf16_f32 v93, v94, v95
  v_mfma_f32_16x16x32_bf16 v[96:99], a[176:179], v[164:167], v[96:99]
  ds_write_b64 v229, v[92:93] offset:1536
  v_mfma_f32_16x16x32_bf16 v[116:119], a[176:179], v[168:171], v[116:119]
  v_cvt_pk_bf16_f32 v112, v112, v113
  v_cvt_pk_bf16_f32 v113, v114, v115
  v_mfma_f32_16x16x32_bf16 v[188:191], a[220:223], v[32:35], v[188:191]
  ds_write_b64 v230, v[112:113] offset:1536
  v_mfma_f32_16x16x32_bf16 v[192:195], a[224:227], v[32:35], v[192:195]
  v_cvt_pk_bf16_f32 v76, v76, v77
  v_cvt_pk_bf16_f32 v77, v78, v79
  v_mfma_f32_16x16x32_bf16 v[196:199], a[228:231], v[32:35], v[196:199]
  ds_write_b64 v228, v[76:77] offset:2048
  v_mfma_f32_16x16x32_bf16 v[200:203], a[232:235], v[32:35], v[200:203]
  v_cvt_pk_bf16_f32 v96, v96, v97
  v_cvt_pk_bf16_f32 v97, v98, v99
  v_mfma_f32_16x16x32_bf16 v[204:207], a[236:239], v[32:35], v[204:207]
  ds_write_b64 v229, v[96:97] offset:2048
  v_mfma_f32_16x16x32_bf16 v[188:191], a[160:163], v[28:31], v[188:191]
  v_cvt_pk_bf16_f32 v116, v116, v117
  v_cvt_pk_bf16_f32 v117, v118, v119
  v_mfma_f32_16x16x32_bf16 v[192:195], a[164:167], v[28:31], v[192:195]
  ds_write_b64 v230, v[116:117] offset:2048
  s_waitcnt lgkmcnt(0)
  s_barrier
  ds_read2st64_b64 v[156:159], v231 offset0:0 offset1:5
  ds_read_b64 v[208:209], v231 offset:5120
  v_mfma_f32_16x16x32_bf16 v[196:199], a[168:171], v[28:31], v[196:199]
  ds_read2st64_b64 v[160:163], v231 offset0:1 offset1:6
  ds_read_b64 v[212:213], v231 offset:5632
  v_mfma_f32_16x16x32_bf16 v[200:203], a[172:175], v[28:31], v[200:203]
  ds_read2st64_b64 v[164:167], v231 offset0:2 offset1:7
  ds_read_b64 v[216:217], v231 offset:6144
  v_mfma_f32_16x16x32_bf16 v[204:207], a[176:179], v[28:31], v[204:207]
  ds_read2st64_b64 v[168:171], v231 offset0:3 offset1:8
  ds_read_b64 v[224:225], v231 offset:6656
  ds_read2st64_b64 v[172:175], v231 offset0:4 offset1:9
  ds_read_b64 v[120:121], v231 offset:7168
  s_waitcnt lgkmcnt(9)
  v_mfma_f32_16x16x32_bf16 v[188:191], v[220:223], v[156:159], v[188:191]
  s_waitcnt lgkmcnt(7)
  v_mfma_f32_16x16x32_bf16 v[192:195], v[220:223], v[160:163], v[192:195]
  s_waitcnt lgkmcnt(5)
  v_mfma_f32_16x16x32_bf16 v[196:199], v[220:223], v[164:167], v[196:199]
  v_mfma_f32_16x16x32_bf16 v[188:191], v[220:223], v[208:211], v[188:191]
  s_waitcnt lgkmcnt(3)
  v_mfma_f32_16x16x32_bf16 v[200:203], v[220:223], v[168:171], v[200:203]
  v_mfma_f32_16x16x32_bf16 v[192:195], v[220:223], v[212:215], v[192:195]
  s_waitcnt lgkmcnt(1)
  v_mfma_f32_16x16x32_bf16 v[204:207], v[220:223], v[172:175], v[204:207]
  v_mfma_f32_16x16x32_bf16 v[196:199], v[220:223], v[216:219], v[196:199]
  v_mfma_f32_16x16x32_bf16 v[200:203], v[220:223], v[224:227], v[200:203]
  s_waitcnt lgkmcnt(0)
  v_mfma_f32_16x16x32_bf16 v[204:207], v[220:223], v[120:123], v[204:207]
  v_cvt_pk_bf16_f32 v124, v188, v189
  v_cvt_pk_bf16_f32 v125, v190, v191
  v_cvt_pk_bf16_f32 v126, v192, v193
  v_cvt_pk_bf16_f32 v127, v194, v195
  s_nop 0
  v_permlane16_swap_b32 v124, v126
  v_permlane16_swap_b32 v125, v127
  buffer_store_dwordx4 v[124:127], v235, s[48:51], 0 offen offset:0
  v_cvt_pk_bf16_f32 v128, v196, v197
  v_cvt_pk_bf16_f32 v129, v198, v199
  v_cvt_pk_bf16_f32 v130, v200, v201
  v_cvt_pk_bf16_f32 v131, v202, v203
  s_nop 0
  v_permlane16_swap_b32 v128, v130
  v_permlane16_swap_b32 v129, v131
  buffer_store_dwordx4 v[128:131], v235, s[48:51], 0 offen offset:64
  v_cvt_pk_bf16_f32 v132, v204, v205
  v_cvt_pk_bf16_f32 v133, v206, v207
  buffer_store_dwordx2 v[132:133], v236, s[48:51], 0 offen offset:128
  s_endpgm
L_end:
  s_endpgm

.section .rodata,"a"
.p2align 6
.amdhsa_kernel parallel_sum__spectral_gfnet__glu_gated_reglu__prompt_kernel
  .amdhsa_next_free_vgpr 512
  .amdhsa_next_free_sgpr 102
  .amdhsa_accum_offset 256
  .amdhsa_group_segment_fixed_size 0
  .amdhsa_kernarg_size 80
  .amdhsa_user_sgpr_count 2
  .amdhsa_user_sgpr_kernarg_segment_ptr 1
  .amdhsa_system_sgpr_workgroup_id_x 1
.end_amdhsa_kernel
```
